```python
import torch

def _softmax(x, axis=-1):
    return torch.softmax(x, dim=axis)
def _gelu(x):
    return torch.nn.functional.gelu(x, approximate="tanh")
def _silu(x):
    return torch.nn.functional.silu(x)
def _sigmoid(x):
    return torch.sigmoid(x)
def _layernorm(x, axis=-1, eps=1e-5):
    m = x.mean(dim=axis, keepdim=True)
    v = x.var(dim=axis, keepdim=True, unbiased=False)
    return (x - m) / torch.sqrt(v + eps)
def _scatter_add(tgt, idx, src, axis=0):
    return tgt.clone().index_add_(axis, idx, src)
def _segment_sum(src, seg, n):
    out = torch.zeros((n,) + src.shape[1:], dtype=src.dtype)
    return out.index_add_(0, seg, src)
def _pad(x, pw):
    flat = tuple(v for pair in reversed(pw) for v in pair)
    return torch.nn.functional.pad(x, flat)

kernel_name = 'recurrent_scan__mha_block_cached__dense_activation_squared_relu__prompt'

def setup_inputs():

    _w = (lambda a: (lambda t: t.to(torch.bfloat16) if t.is_floating_point() else t)(torch.as_tensor(a)))
    def _A_setup():
        B, Sq, D = 1, 2048, 640
        H, Sk, Dh = 32, 2048, 192
        return {
            "x": _w((lambda *s: torch.randn(*s, dtype=torch.bfloat16) * 0.05)(B, Sq, D)),
            "k_cache": _w((lambda *s: torch.randn(*s, dtype=torch.bfloat16) * 0.8)(B, H, Sk, Dh)),
            "v_cache": _w((lambda *s: torch.randn(*s, dtype=torch.bfloat16) * 0.2)(B, H, Sk, Dh)),
            "wq": _w((lambda *s: torch.randn(*s, dtype=torch.bfloat16) * 0.8)(D, H * Dh) * (D ** -0.5)),
            "wo": _w((lambda *s: torch.randn(*s, dtype=torch.bfloat16) * 0.2)(H * Dh, D) * ((H * Dh) ** -0.5)),
        }
    _A_in = _A_setup()

    def _B_setup():
        B, S, D, F = 1, 2048, 640, 1536
        return {
            "x": _w((lambda *s: torch.randn(*s, dtype=torch.bfloat16) * 0.05)(B, S, D)),
            "w1": _w((lambda *s: torch.randn(*s, dtype=torch.bfloat16) * 0.1)(D, F)),
            "b1": _w((lambda *s: torch.randn(*s, dtype=torch.bfloat16) * 0.8)(F)),
            "w2": _w((lambda *s: torch.randn(*s, dtype=torch.bfloat16) * 0.1)(F, D)),
            "b2": _w((lambda *s: torch.randn(*s, dtype=torch.bfloat16) * 12.8)(D)),
        }
    _B_in = _B_setup()

    return {
        "A_x": _A_in["x"],
        "A_k_cache": _A_in["k_cache"],
        "A_v_cache": _A_in["v_cache"],
        "A_wq": _A_in["wq"],
        "A_wo": _A_in["wo"],
        "B_x": _B_in["x"],
        "B_w1": _B_in["w1"],
        "B_b1": _B_in["b1"],
        "B_w2": _B_in["w2"],
        "B_b2": _B_in["b2"],
    }

def reference(A_x, A_k_cache, A_v_cache, A_wq, A_wo, B_x, B_w1, B_b1, B_w2, B_b2):
    def _A_ref(x, k_cache, v_cache, wq, wo):
        B, Sq, D = x.shape
        H, Dh = 32, 192
        q = (lambda x, *d: x.permute(*d))((x @ wq).reshape(B, Sq, H, Dh), 0, 2, 1, 3)
        scores = torch.einsum("bhqd,bhkd->bhqk", q, k_cache) * (Dh ** -0.5)
        p = _softmax(scores, axis=-1)
        o = torch.einsum("bhqk,bhkd->bhqd", p, v_cache)
        return (lambda x, *d: x.permute(*d))(o, 0, 2, 1, 3).reshape(B, Sq, H * Dh) @ wo

    def _B_ref(x, w1, b1, w2, b2):
        h = torch.einsum("bsd,df->bsf", x, w1) + b1
        zero = torch.zeros_like(h)
        r = torch.where(h > zero, h, zero)
        h = r * r
        out = torch.einsum("bsf,fd->bsd", h, w2) + b2
        return out

    x = A_x
    xn = _layernorm(x, axis=-1)
    s = _A_ref(xn, A_k_cache, A_v_cache, A_wq, A_wo)
    g = _silu(_B_ref(xn, B_w1, B_b1, B_w2, B_b2))
    return x + s * g
```

```asm
; @launch kernel=ln_kernel grid=(128,1,1) block=(256,1,1) lds=0
; @launch kernel=attn_kernel grid=(256,1,1) block=(512,1,1) lds=147456
; @launch kernel=gemm_kernel grid=(256,1,1) block=(512,1,1) lds=147456
; @launch kernel=recurrent_scan__mha_block_cached__dense_activation_squared_relu__prompt_kernel grid=(640,1,1) block=(256,1,1) lds=0
.amdgcn_target "amdgcn-amd-amdhsa--gfx950"
.text
.globl ln_kernel
.p2align 8
.type ln_kernel,@function
ln_kernel:
  s_cmp_ge_u32 s2, 128
  s_cbranch_scc1 L_ln_end
  s_load_dwordx2 s[4:5], s[0:1], 0
  s_load_dwordx2 s[6:7], s[0:1], 96
  v_and_b32 v1, 63, v0
  v_lshrrev_b32 v2, 6, v0
  v_lshrrev_b32 v3, 4, v1
  v_and_b32 v4, 15, v1
  s_lshl_b32 s3, s2, 4
  v_lshlrev_b32 v5, 2, v2
  v_add3_u32 v5, v5, v3, s3
  s_movk_i32 s16, 1280
  v_mul_lo_u32 v6, v5, s16
  v_lshl_add_u32 v6, v4, 4, v6
  v_lshrrev_b32 v7, 4, v5
  v_lshlrev_b32 v7, 10, v7
  v_lshrrev_b32 v3, 2, v4
  v_lshl_add_u32 v7, v3, 17, v7
  v_and_b32 v3, 1, v4
  v_lshl_add_u32 v7, v3, 9, v7
  v_and_b32 v3, 15, v5
  v_lshl_add_u32 v7, v3, 4, v7
  v_bfe_u32 v3, v4, 1, 1
  v_lshl_add_u32 v7, v3, 3, v7
  s_waitcnt lgkmcnt(0)
  s_mov_b32 s8, s4
  s_and_b32 s9, s5, 0xffff
  s_mov_b32 s10, 2621440
  s_mov_b32 s11, 0x00020000
  s_mov_b32 s12, s6
  s_and_b32 s13, s7, 0xffff
  s_mov_b32 s14, 2621440
  s_mov_b32 s15, 0x00020000
  buffer_load_dwordx4 v[8:11], v6, s[8:11], 0 offen offset:0
  buffer_load_dwordx4 v[12:15], v6, s[8:11], 0 offen offset:256
  buffer_load_dwordx4 v[16:19], v6, s[8:11], 0 offen offset:512
  buffer_load_dwordx4 v[20:23], v6, s[8:11], 0 offen offset:768
  buffer_load_dwordx4 v[24:27], v6, s[8:11], 0 offen offset:1024
  s_mov_b32 s18, 0xffff0000
  s_waitcnt vmcnt(0)
  v_lshlrev_b32 v32, 16, v8
  v_and_b32 v33, s18, v8
  v_lshlrev_b32 v34, 16, v9
  v_and_b32 v35, s18, v9
  v_lshlrev_b32 v36, 16, v10
  v_and_b32 v37, s18, v10
  v_lshlrev_b32 v38, 16, v11
  v_and_b32 v39, s18, v11
  v_lshlrev_b32 v40, 16, v12
  v_and_b32 v41, s18, v12
  v_lshlrev_b32 v42, 16, v13
  v_and_b32 v43, s18, v13
  v_lshlrev_b32 v44, 16, v14
  v_and_b32 v45, s18, v14
  v_lshlrev_b32 v46, 16, v15
  v_and_b32 v47, s18, v15
  v_lshlrev_b32 v48, 16, v16
  v_and_b32 v49, s18, v16
  v_lshlrev_b32 v50, 16, v17
  v_and_b32 v51, s18, v17
  v_lshlrev_b32 v52, 16, v18
  v_and_b32 v53, s18, v18
  v_lshlrev_b32 v54, 16, v19
  v_and_b32 v55, s18, v19
  v_lshlrev_b32 v56, 16, v20
  v_and_b32 v57, s18, v20
  v_lshlrev_b32 v58, 16, v21
  v_and_b32 v59, s18, v21
  v_lshlrev_b32 v60, 16, v22
  v_and_b32 v61, s18, v22
  v_lshlrev_b32 v62, 16, v23
  v_and_b32 v63, s18, v23
  v_lshlrev_b32 v64, 16, v24
  v_and_b32 v65, s18, v24
  v_lshlrev_b32 v66, 16, v25
  v_and_b32 v67, s18, v25
  v_lshlrev_b32 v68, 16, v26
  v_and_b32 v69, s18, v26
  v_lshlrev_b32 v70, 16, v27
  v_and_b32 v71, s18, v27
  v_add_f32 v72, v32, v33
  v_add_f32 v73, v34, v35
  v_add_f32 v72, v72, v36
  v_add_f32 v73, v73, v37
  v_add_f32 v72, v72, v38
  v_add_f32 v73, v73, v39
  v_add_f32 v72, v72, v40
  v_add_f32 v73, v73, v41
  v_add_f32 v72, v72, v42
  v_add_f32 v73, v73, v43
  v_add_f32 v72, v72, v44
  v_add_f32 v73, v73, v45
  v_add_f32 v72, v72, v46
  v_add_f32 v73, v73, v47
  v_add_f32 v72, v72, v48
  v_add_f32 v73, v73, v49
  v_add_f32 v72, v72, v50
  v_add_f32 v73, v73, v51
  v_add_f32 v72, v72, v52
  v_add_f32 v73, v73, v53
  v_add_f32 v72, v72, v54
  v_add_f32 v73, v73, v55
  v_add_f32 v72, v72, v56
  v_add_f32 v73, v73, v57
  v_add_f32 v72, v72, v58
  v_add_f32 v73, v73, v59
  v_add_f32 v72, v72, v60
  v_add_f32 v73, v73, v61
  v_add_f32 v72, v72, v62
  v_add_f32 v73, v73, v63
  v_add_f32 v72, v72, v64
  v_add_f32 v73, v73, v65
  v_add_f32 v72, v72, v66
  v_add_f32 v73, v73, v67
  v_add_f32 v72, v72, v68
  v_add_f32 v73, v73, v69
  v_add_f32 v72, v72, v70
  v_add_f32 v73, v73, v71
  v_add_f32 v72, v72, v73
  ds_swizzle_b32 v73, v72 offset:1055
  s_waitcnt lgkmcnt(0)
  v_add_f32 v72, v72, v73
  ds_swizzle_b32 v73, v72 offset:2079
  s_waitcnt lgkmcnt(0)
  v_add_f32 v72, v72, v73
  ds_swizzle_b32 v73, v72 offset:4127
  s_waitcnt lgkmcnt(0)
  v_add_f32 v72, v72, v73
  ds_swizzle_b32 v73, v72 offset:8223
  s_waitcnt lgkmcnt(0)
  v_add_f32 v72, v72, v73
  s_mov_b32 s19, 0x3acccccd
  v_mul_f32 v72, s19, v72
  v_mov_b32 v74, 0
  v_mov_b32 v75, 0
  v_sub_f32 v76, v32, v72
  v_sub_f32 v77, v33, v72
  v_fmac_f32 v74, v76, v76
  v_fmac_f32 v75, v77, v77
  v_sub_f32 v76, v34, v72
  v_sub_f32 v77, v35, v72
  v_fmac_f32 v74, v76, v76
  v_fmac_f32 v75, v77, v77
  v_sub_f32 v76, v36, v72
  v_sub_f32 v77, v37, v72
  v_fmac_f32 v74, v76, v76
  v_fmac_f32 v75, v77, v77
  v_sub_f32 v76, v38, v72
  v_sub_f32 v77, v39, v72
  v_fmac_f32 v74, v76, v76
  v_fmac_f32 v75, v77, v77
  v_sub_f32 v76, v40, v72
  v_sub_f32 v77, v41, v72
  v_fmac_f32 v74, v76, v76
  v_fmac_f32 v75, v77, v77
  v_sub_f32 v76, v42, v72
  v_sub_f32 v77, v43, v72
  v_fmac_f32 v74, v76, v76
  v_fmac_f32 v75, v77, v77
  v_sub_f32 v76, v44, v72
  v_sub_f32 v77, v45, v72
  v_fmac_f32 v74, v76, v76
  v_fmac_f32 v75, v77, v77
  v_sub_f32 v76, v46, v72
  v_sub_f32 v77, v47, v72
  v_fmac_f32 v74, v76, v76
  v_fmac_f32 v75, v77, v77
  v_sub_f32 v76, v48, v72
  v_sub_f32 v77, v49, v72
  v_fmac_f32 v74, v76, v76
  v_fmac_f32 v75, v77, v77
  v_sub_f32 v76, v50, v72
  v_sub_f32 v77, v51, v72
  v_fmac_f32 v74, v76, v76
  v_fmac_f32 v75, v77, v77
  v_sub_f32 v76, v52, v72
  v_sub_f32 v77, v53, v72
  v_fmac_f32 v74, v76, v76
  v_fmac_f32 v75, v77, v77
  v_sub_f32 v76, v54, v72
  v_sub_f32 v77, v55, v72
  v_fmac_f32 v74, v76, v76
  v_fmac_f32 v75, v77, v77
  v_sub_f32 v76, v56, v72
  v_sub_f32 v77, v57, v72
  v_fmac_f32 v74, v76, v76
  v_fmac_f32 v75, v77, v77
  v_sub_f32 v76, v58, v72
  v_sub_f32 v77, v59, v72
  v_fmac_f32 v74, v76, v76
  v_fmac_f32 v75, v77, v77
  v_sub_f32 v76, v60, v72
  v_sub_f32 v77, v61, v72
  v_fmac_f32 v74, v76, v76
  v_fmac_f32 v75, v77, v77
  v_sub_f32 v76, v62, v72
  v_sub_f32 v77, v63, v72
  v_fmac_f32 v74, v76, v76
  v_fmac_f32 v75, v77, v77
  v_sub_f32 v76, v64, v72
  v_sub_f32 v77, v65, v72
  v_fmac_f32 v74, v76, v76
  v_fmac_f32 v75, v77, v77
  v_sub_f32 v76, v66, v72
  v_sub_f32 v77, v67, v72
  v_fmac_f32 v74, v76, v76
  v_fmac_f32 v75, v77, v77
  v_sub_f32 v76, v68, v72
  v_sub_f32 v77, v69, v72
  v_fmac_f32 v74, v76, v76
  v_fmac_f32 v75, v77, v77
  v_sub_f32 v76, v70, v72
  v_sub_f32 v77, v71, v72
  v_fmac_f32 v74, v76, v76
  v_fmac_f32 v75, v77, v77
  v_add_f32 v74, v74, v75
  ds_swizzle_b32 v75, v74 offset:1055
  s_waitcnt lgkmcnt(0)
  v_add_f32 v74, v74, v75
  ds_swizzle_b32 v75, v74 offset:2079
  s_waitcnt lgkmcnt(0)
  v_add_f32 v74, v74, v75
  ds_swizzle_b32 v75, v74 offset:4127
  s_waitcnt lgkmcnt(0)
  v_add_f32 v74, v74, v75
  ds_swizzle_b32 v75, v74 offset:8223
  s_waitcnt lgkmcnt(0)
  v_add_f32 v74, v74, v75
  v_mul_f32 v74, s19, v74
  v_cvt_pk_bf16_f32 v75, v72, v74
  v_lshlrev_b32 v72, 16, v75
  v_and_b32 v74, s18, v75
  v_add_f32 v74, 0x3727c5ac, v74
  v_cvt_pk_bf16_f32 v75, v74, v74
  v_lshlrev_b32 v74, 16, v75
  v_sqrt_f32 v74, v74
  s_nop 0
  v_cvt_pk_bf16_f32 v75, v74, v74
  v_lshlrev_b32 v74, 16, v75
  v_rcp_f32 v75, v74
  s_nop 0
  v_sub_f32 v76, v32, v72
  v_sub_f32 v77, v33, v72
  v_cvt_pk_bf16_f32 v78, v76, v77
  v_lshlrev_b32 v76, 16, v78
  v_and_b32 v77, s18, v78
  v_mul_f32 v78, v76, v75
  v_mul_f32 v79, v77, v75
  v_fma_f32 v76, -v78, v74, v76
  v_fma_f32 v77, -v79, v74, v77
  v_fma_f32 v78, v76, v75, v78
  v_fma_f32 v79, v77, v75, v79
  v_cvt_pk_bf16_f32 v8, v78, v79
  v_sub_f32 v76, v34, v72
  v_sub_f32 v77, v35, v72
  v_cvt_pk_bf16_f32 v78, v76, v77
  v_lshlrev_b32 v76, 16, v78
  v_and_b32 v77, s18, v78
  v_mul_f32 v78, v76, v75
  v_mul_f32 v79, v77, v75
  v_fma_f32 v76, -v78, v74, v76
  v_fma_f32 v77, -v79, v74, v77
  v_fma_f32 v78, v76, v75, v78
  v_fma_f32 v79, v77, v75, v79
  v_cvt_pk_bf16_f32 v9, v78, v79
  v_sub_f32 v76, v36, v72
  v_sub_f32 v77, v37, v72
  v_cvt_pk_bf16_f32 v78, v76, v77
  v_lshlrev_b32 v76, 16, v78
  v_and_b32 v77, s18, v78
  v_mul_f32 v78, v76, v75
  v_mul_f32 v79, v77, v75
  v_fma_f32 v76, -v78, v74, v76
  v_fma_f32 v77, -v79, v74, v77
  v_fma_f32 v78, v76, v75, v78
  v_fma_f32 v79, v77, v75, v79
  v_cvt_pk_bf16_f32 v10, v78, v79
  v_sub_f32 v76, v38, v72
  v_sub_f32 v77, v39, v72
  v_cvt_pk_bf16_f32 v78, v76, v77
  v_lshlrev_b32 v76, 16, v78
  v_and_b32 v77, s18, v78
  v_mul_f32 v78, v76, v75
  v_mul_f32 v79, v77, v75
  v_fma_f32 v76, -v78, v74, v76
  v_fma_f32 v77, -v79, v74, v77
  v_fma_f32 v78, v76, v75, v78
  v_fma_f32 v79, v77, v75, v79
  v_cvt_pk_bf16_f32 v11, v78, v79
  v_sub_f32 v76, v40, v72
  v_sub_f32 v77, v41, v72
  v_cvt_pk_bf16_f32 v78, v76, v77
  v_lshlrev_b32 v76, 16, v78
  v_and_b32 v77, s18, v78
  v_mul_f32 v78, v76, v75
  v_mul_f32 v79, v77, v75
  v_fma_f32 v76, -v78, v74, v76
  v_fma_f32 v77, -v79, v74, v77
  v_fma_f32 v78, v76, v75, v78
  v_fma_f32 v79, v77, v75, v79
  v_cvt_pk_bf16_f32 v12, v78, v79
  v_sub_f32 v76, v42, v72
  v_sub_f32 v77, v43, v72
  v_cvt_pk_bf16_f32 v78, v76, v77
  v_lshlrev_b32 v76, 16, v78
  v_and_b32 v77, s18, v78
  v_mul_f32 v78, v76, v75
  v_mul_f32 v79, v77, v75
  v_fma_f32 v76, -v78, v74, v76
  v_fma_f32 v77, -v79, v74, v77
  v_fma_f32 v78, v76, v75, v78
  v_fma_f32 v79, v77, v75, v79
  v_cvt_pk_bf16_f32 v13, v78, v79
  v_sub_f32 v76, v44, v72
  v_sub_f32 v77, v45, v72
  v_cvt_pk_bf16_f32 v78, v76, v77
  v_lshlrev_b32 v76, 16, v78
  v_and_b32 v77, s18, v78
  v_mul_f32 v78, v76, v75
  v_mul_f32 v79, v77, v75
  v_fma_f32 v76, -v78, v74, v76
  v_fma_f32 v77, -v79, v74, v77
  v_fma_f32 v78, v76, v75, v78
  v_fma_f32 v79, v77, v75, v79
  v_cvt_pk_bf16_f32 v14, v78, v79
  v_sub_f32 v76, v46, v72
  v_sub_f32 v77, v47, v72
  v_cvt_pk_bf16_f32 v78, v76, v77
  v_lshlrev_b32 v76, 16, v78
  v_and_b32 v77, s18, v78
  v_mul_f32 v78, v76, v75
  v_mul_f32 v79, v77, v75
  v_fma_f32 v76, -v78, v74, v76
  v_fma_f32 v77, -v79, v74, v77
  v_fma_f32 v78, v76, v75, v78
  v_fma_f32 v79, v77, v75, v79
  v_cvt_pk_bf16_f32 v15, v78, v79
  v_sub_f32 v76, v48, v72
  v_sub_f32 v77, v49, v72
  v_cvt_pk_bf16_f32 v78, v76, v77
  v_lshlrev_b32 v76, 16, v78
  v_and_b32 v77, s18, v78
  v_mul_f32 v78, v76, v75
  v_mul_f32 v79, v77, v75
  v_fma_f32 v76, -v78, v74, v76
  v_fma_f32 v77, -v79, v74, v77
  v_fma_f32 v78, v76, v75, v78
  v_fma_f32 v79, v77, v75, v79
  v_cvt_pk_bf16_f32 v16, v78, v79
  v_sub_f32 v76, v50, v72
  v_sub_f32 v77, v51, v72
  v_cvt_pk_bf16_f32 v78, v76, v77
  v_lshlrev_b32 v76, 16, v78
  v_and_b32 v77, s18, v78
  v_mul_f32 v78, v76, v75
  v_mul_f32 v79, v77, v75
  v_fma_f32 v76, -v78, v74, v76
  v_fma_f32 v77, -v79, v74, v77
  v_fma_f32 v78, v76, v75, v78
  v_fma_f32 v79, v77, v75, v79
  v_cvt_pk_bf16_f32 v17, v78, v79
  v_sub_f32 v76, v52, v72
  v_sub_f32 v77, v53, v72
  v_cvt_pk_bf16_f32 v78, v76, v77
  v_lshlrev_b32 v76, 16, v78
  v_and_b32 v77, s18, v78
  v_mul_f32 v78, v76, v75
  v_mul_f32 v79, v77, v75
  v_fma_f32 v76, -v78, v74, v76
  v_fma_f32 v77, -v79, v74, v77
  v_fma_f32 v78, v76, v75, v78
  v_fma_f32 v79, v77, v75, v79
  v_cvt_pk_bf16_f32 v18, v78, v79
  v_sub_f32 v76, v54, v72
  v_sub_f32 v77, v55, v72
  v_cvt_pk_bf16_f32 v78, v76, v77
  v_lshlrev_b32 v76, 16, v78
  v_and_b32 v77, s18, v78
  v_mul_f32 v78, v76, v75
  v_mul_f32 v79, v77, v75
  v_fma_f32 v76, -v78, v74, v76
  v_fma_f32 v77, -v79, v74, v77
  v_fma_f32 v78, v76, v75, v78
  v_fma_f32 v79, v77, v75, v79
  v_cvt_pk_bf16_f32 v19, v78, v79
  v_sub_f32 v76, v56, v72
  v_sub_f32 v77, v57, v72
  v_cvt_pk_bf16_f32 v78, v76, v77
  v_lshlrev_b32 v76, 16, v78
  v_and_b32 v77, s18, v78
  v_mul_f32 v78, v76, v75
  v_mul_f32 v79, v77, v75
  v_fma_f32 v76, -v78, v74, v76
  v_fma_f32 v77, -v79, v74, v77
  v_fma_f32 v78, v76, v75, v78
  v_fma_f32 v79, v77, v75, v79
  v_cvt_pk_bf16_f32 v20, v78, v79
  v_sub_f32 v76, v58, v72
  v_sub_f32 v77, v59, v72
  v_cvt_pk_bf16_f32 v78, v76, v77
  v_lshlrev_b32 v76, 16, v78
  v_and_b32 v77, s18, v78
  v_mul_f32 v78, v76, v75
  v_mul_f32 v79, v77, v75
  v_fma_f32 v76, -v78, v74, v76
  v_fma_f32 v77, -v79, v74, v77
  v_fma_f32 v78, v76, v75, v78
  v_fma_f32 v79, v77, v75, v79
  v_cvt_pk_bf16_f32 v21, v78, v79
  v_sub_f32 v76, v60, v72
  v_sub_f32 v77, v61, v72
  v_cvt_pk_bf16_f32 v78, v76, v77
  v_lshlrev_b32 v76, 16, v78
  v_and_b32 v77, s18, v78
  v_mul_f32 v78, v76, v75
  v_mul_f32 v79, v77, v75
  v_fma_f32 v76, -v78, v74, v76
  v_fma_f32 v77, -v79, v74, v77
  v_fma_f32 v78, v76, v75, v78
  v_fma_f32 v79, v77, v75, v79
  v_cvt_pk_bf16_f32 v22, v78, v79
  v_sub_f32 v76, v62, v72
  v_sub_f32 v77, v63, v72
  v_cvt_pk_bf16_f32 v78, v76, v77
  v_lshlrev_b32 v76, 16, v78
  v_and_b32 v77, s18, v78
  v_mul_f32 v78, v76, v75
  v_mul_f32 v79, v77, v75
  v_fma_f32 v76, -v78, v74, v76
  v_fma_f32 v77, -v79, v74, v77
  v_fma_f32 v78, v76, v75, v78
  v_fma_f32 v79, v77, v75, v79
  v_cvt_pk_bf16_f32 v23, v78, v79
  v_sub_f32 v76, v64, v72
  v_sub_f32 v77, v65, v72
  v_cvt_pk_bf16_f32 v78, v76, v77
  v_lshlrev_b32 v76, 16, v78
  v_and_b32 v77, s18, v78
  v_mul_f32 v78, v76, v75
  v_mul_f32 v79, v77, v75
  v_fma_f32 v76, -v78, v74, v76
  v_fma_f32 v77, -v79, v74, v77
  v_fma_f32 v78, v76, v75, v78
  v_fma_f32 v79, v77, v75, v79
  v_cvt_pk_bf16_f32 v24, v78, v79
  v_sub_f32 v76, v66, v72
  v_sub_f32 v77, v67, v72
  v_cvt_pk_bf16_f32 v78, v76, v77
  v_lshlrev_b32 v76, 16, v78
  v_and_b32 v77, s18, v78
  v_mul_f32 v78, v76, v75
  v_mul_f32 v79, v77, v75
  v_fma_f32 v76, -v78, v74, v76
  v_fma_f32 v77, -v79, v74, v77
  v_fma_f32 v78, v76, v75, v78
  v_fma_f32 v79, v77, v75, v79
  v_cvt_pk_bf16_f32 v25, v78, v79
  v_sub_f32 v76, v68, v72
  v_sub_f32 v77, v69, v72
  v_cvt_pk_bf16_f32 v78, v76, v77
  v_lshlrev_b32 v76, 16, v78
  v_and_b32 v77, s18, v78
  v_mul_f32 v78, v76, v75
  v_mul_f32 v79, v77, v75
  v_fma_f32 v76, -v78, v74, v76
  v_fma_f32 v77, -v79, v74, v77
  v_fma_f32 v78, v76, v75, v78
  v_fma_f32 v79, v77, v75, v79
  v_cvt_pk_bf16_f32 v26, v78, v79
  v_sub_f32 v76, v70, v72
  v_sub_f32 v77, v71, v72
  v_cvt_pk_bf16_f32 v78, v76, v77
  v_lshlrev_b32 v76, 16, v78
  v_and_b32 v77, s18, v78
  v_mul_f32 v78, v76, v75
  v_mul_f32 v79, v77, v75
  v_fma_f32 v76, -v78, v74, v76
  v_fma_f32 v77, -v79, v74, v77
  v_fma_f32 v78, v76, v75, v78
  v_fma_f32 v79, v77, v75, v79
  v_cvt_pk_bf16_f32 v27, v78, v79
  s_mov_b32 s20, 0
  buffer_store_dwordx2 v[8:9], v7, s[12:15], s20 offen
  buffer_store_dwordx2 v[10:11], v7, s[12:15], s20 offen offset:256
  s_mov_b32 s20, 524288
  buffer_store_dwordx2 v[12:13], v7, s[12:15], s20 offen
  buffer_store_dwordx2 v[14:15], v7, s[12:15], s20 offen offset:256
  s_mov_b32 s20, 1048576
  buffer_store_dwordx2 v[16:17], v7, s[12:15], s20 offen
  buffer_store_dwordx2 v[18:19], v7, s[12:15], s20 offen offset:256
  s_mov_b32 s20, 1572864
  buffer_store_dwordx2 v[20:21], v7, s[12:15], s20 offen
  buffer_store_dwordx2 v[22:23], v7, s[12:15], s20 offen offset:256
  s_mov_b32 s20, 2097152
  buffer_store_dwordx2 v[24:25], v7, s[12:15], s20 offen
  buffer_store_dwordx2 v[26:27], v7, s[12:15], s20 offen offset:256
L_ln_end:
  s_endpgm
.section .rodata,"a"
.p2align 6
.amdhsa_kernel ln_kernel
  .amdhsa_next_free_vgpr 96
  .amdhsa_next_free_sgpr 102
  .amdhsa_accum_offset 96
  .amdhsa_group_segment_fixed_size 0
  .amdhsa_kernarg_size 104
  .amdhsa_user_sgpr_count 2
  .amdhsa_user_sgpr_kernarg_segment_ptr 1
  .amdhsa_system_sgpr_workgroup_id_x 1
.end_amdhsa_kernel
.text

.globl attn_kernel
.p2align 8
.type attn_kernel,@function
attn_kernel:
  s_cmp_ge_u32 s2, 256
  s_cbranch_scc1 L_at_end
  s_load_dwordx4 s[48:51], s[0:1], 8
  s_load_dwordx2 s[52:53], s[0:1], 24
  s_load_dwordx4 s[56:59], s[0:1], 48
  s_load_dwordx2 s[60:61], s[0:1], 96
  v_lshrrev_b32 v251, 6, v0
  s_nop 0
  v_readfirstlane_b32 s32, v251
  s_and_b32 s33, s2, 7
  s_lshr_b32 s34, s2, 6
  s_lshl_b32 s34, s34, 3
  s_or_b32 s33, s33, s34
  s_lshr_b32 s34, s2, 3
  s_and_b32 s34, s34, 7
  s_lshr_b32 s35, s32, 2
  s_lshl_b32 s36, s34, 3
  s_add_u32 s36, s36, s32
  s_lshl_b32 s36, s36, 1
  s_and_b32 s68, s32, 3
  s_mul_i32 s68, s68, 3072
  v_and_b32 v208, 63, v0
  v_lshlrev_b32 v251, 4, v208
  v_lshrrev_b32 v208, 4, v251
  v_and_b32 v209, 15, v208
  v_lshrrev_b32 v210, 4, v208
  v_bfe_u32 v211, v208, 2, 2
  v_and_b32 v212, 3, v208
  s_movk_i32 s42, 384
  v_lshl_add_u32 v214, v210, 2, v211
  v_and_b32 v215, 6, v214
  v_lshrrev_b32 v216, 1, v212
  v_xor_b32 v215, v215, v216
  v_lshlrev_b32 v215, 4, v215
  v_and_b32 v216, 1, v212
  v_lshl_add_u32 v215, v216, 3, v215
  v_mul_lo_u32 v214, v214, s42
  v_add_u32 v214, 24576, v214
  v_add_u32 v232, v214, v215
  v_xor_b32 v233, 32, v232
  v_xor_b32 v234, 64, v232
  v_xor_b32 v235, 96, v232
  v_lshl_add_u32 v214, v210, 2, v211
  v_lshlrev_b32 v214, 6, v214
  v_lshl_add_u32 v254, v212, 3, v214
  s_and_b32 s67, s32, 3
  s_lshl_b32 s67, s67, 3
  s_movk_i32 s62, 171
  s_movk_i32 s63, 384
  s_movk_i32 s64, 12288
  v_add_u32 v214, 0, v208
  v_mul_lo_u32 v215, v214, s62
  v_lshrrev_b32 v215, 12, v215
  v_mul_u32_u24 v216, 24, v215
  v_sub_u32 v214, v214, v216
  v_add_u32 v215, s67, v215
  v_and_b32 v216, 6, v215
  v_xor_b32 v216, v214, v216
  v_lshlrev_b32 v216, 4, v216
  v_mul_lo_u32 v217, v215, s64
  v_add_u32 v243, v217, v216
  v_and_b32 v216, 6, v215
  v_xor_b32 v214, v214, v216
  v_lshlrev_b32 v214, 4, v214
  v_mul_lo_u32 v216, v215, s63
  v_add_u32 v240, v216, v214
  v_add_u32 v214, 64, v208
  v_mul_lo_u32 v215, v214, s62
  v_lshrrev_b32 v215, 12, v215
  v_mul_u32_u24 v216, 24, v215
  v_sub_u32 v214, v214, v216
  v_add_u32 v215, s67, v215
  v_and_b32 v216, 6, v215
  v_xor_b32 v216, v214, v216
  v_lshlrev_b32 v216, 4, v216
  v_mul_lo_u32 v217, v215, s64
  v_add_u32 v244, v217, v216
  v_and_b32 v216, 6, v215
  v_xor_b32 v214, v214, v216
  v_lshlrev_b32 v214, 4, v214
  v_mul_lo_u32 v216, v215, s63
  v_add_u32 v241, v216, v214
  v_add_u32 v214, 128, v208
  v_mul_lo_u32 v215, v214, s62
  v_lshrrev_b32 v215, 12, v215
  v_mul_u32_u24 v216, 24, v215
  v_sub_u32 v214, v214, v216
  v_add_u32 v215, s67, v215
  v_and_b32 v216, 6, v215
  v_xor_b32 v216, v214, v216
  v_lshlrev_b32 v216, 4, v216
  v_mul_lo_u32 v217, v215, s64
  v_add_u32 v245, v217, v216
  v_and_b32 v216, 6, v215
  v_xor_b32 v214, v214, v216
  v_lshlrev_b32 v214, 4, v214
  v_mul_lo_u32 v216, v215, s63
  v_add_u32 v242, v216, v214
  s_lshr_b32 s47, s33, 1
  s_add_u32 s47, s47, 32
  s_and_b32 s62, s32, 3
  s_lshl_b32 s62, s62, 4
  v_lshrrev_b32 v214, 2, v208
  v_add_u32 v214, s62, v214
  s_movk_i32 s63, 3072
  v_mul_lo_u32 v214, v214, s63
  v_lshl_add_u32 v246, v212, 4, v214
  s_lshl_b32 s54, s33, 6
  s_lshl_b32 s55, s47, 6
  s_and_b32 s62, s32, 3
  s_lshl_b32 s44, s62, 10
  s_and_b32 s42, s33, 1
  s_cmp_eq_u32 s42, s35
  s_cselect_b32 s65, 1, 0
  s_waitcnt lgkmcnt(0)
  s_mul_i32 s42, s33, 786432
  s_add_u32 s4, s48, s42
  s_addc_u32 s5, s49, 0
  s_and_b32 s5, s5, 0xffff
  s_mov_b32 s6, 786432
  s_mov_b32 s7, 0x00020000
  s_add_u32 s8, s50, s42
  s_addc_u32 s9, s51, 0
  s_and_b32 s9, s9, 0xffff
  s_mov_b32 s10, 786432
  s_mov_b32 s11, 0x00020000
  s_mul_i32 s42, s33, 384
  s_add_u32 s12, s52, s42
  s_addc_u32 s13, s53, 0
  s_and_b32 s13, s13, 0xffff
  s_mov_b32 s14, 0
  s_mov_b32 s15, 0x00020000
  s_sub_u32 s14, 7864320, s42
  s_mov_b32 s16, s60
  s_and_b32 s17, s61, 0xffff
  s_mov_b32 s18, 2621440
  s_mov_b32 s19, 0x00020000
  s_add_u32 s20, s60, 4194304
  s_addc_u32 s21, s61, 0
  s_and_b32 s21, s21, 0xffff
  s_mov_b32 s22, 31457280
  s_mov_b32 s23, 0x00020000
  s_mov_b32 s24, s56
  s_and_b32 s25, s57, 0xffff
  s_mov_b32 s26, 1966080
  s_mov_b32 s27, 0x00020000
  s_mov_b32 s28, s58
  s_and_b32 s29, s59, 0xffff
  s_mov_b32 s30, 3072
  s_mov_b32 s31, 0x00020000
  s_lshl_b32 s66, s36, 10
  v_mov_b32 v0, 0
  v_mov_b32 v1, 0
  v_mov_b32 v2, 0
  v_mov_b32 v3, 0
  v_mov_b32 v4, 0
  v_mov_b32 v5, 0
  v_mov_b32 v6, 0
  v_mov_b32 v7, 0
  v_mov_b32 v8, 0
  v_mov_b32 v9, 0
  v_mov_b32 v10, 0
  v_mov_b32 v11, 0
  v_mov_b32 v12, 0
  v_mov_b32 v13, 0
  v_mov_b32 v14, 0
  v_mov_b32 v15, 0
  v_mov_b32 v16, 0
  v_mov_b32 v17, 0
  v_mov_b32 v18, 0
  v_mov_b32 v19, 0
  v_mov_b32 v20, 0
  v_mov_b32 v21, 0
  v_mov_b32 v22, 0
  v_mov_b32 v23, 0
  v_mov_b32 v24, 0
  v_mov_b32 v25, 0
  v_mov_b32 v26, 0
  v_mov_b32 v27, 0
  v_mov_b32 v28, 0
  v_mov_b32 v29, 0
  v_mov_b32 v30, 0
  v_mov_b32 v31, 0
  v_mov_b32 v32, 0
  v_mov_b32 v33, 0
  v_mov_b32 v34, 0
  v_mov_b32 v35, 0
  v_mov_b32 v36, 0
  v_mov_b32 v37, 0
  v_mov_b32 v38, 0
  v_mov_b32 v39, 0
  v_mov_b32 v40, 0
  v_mov_b32 v41, 0
  v_mov_b32 v42, 0
  v_mov_b32 v43, 0
  v_mov_b32 v44, 0
  v_mov_b32 v45, 0
  v_mov_b32 v46, 0
  v_mov_b32 v47, 0
  v_mov_b32 v48, 0
  v_mov_b32 v49, 0
  v_mov_b32 v50, 0
  v_mov_b32 v51, 0
  v_mov_b32 v52, 0
  v_mov_b32 v53, 0
  v_mov_b32 v54, 0
  v_mov_b32 v55, 0
  v_mov_b32 v56, 0
  v_mov_b32 v57, 0
  v_mov_b32 v58, 0
  v_mov_b32 v59, 0
  v_mov_b32 v60, 0
  v_mov_b32 v61, 0
  v_mov_b32 v62, 0
  v_mov_b32 v63, 0
  v_mov_b32 v64, 0
  v_mov_b32 v65, 0
  v_mov_b32 v66, 0
  v_mov_b32 v67, 0
  v_mov_b32 v68, 0
  v_mov_b32 v69, 0
  v_mov_b32 v70, 0
  v_mov_b32 v71, 0
  v_mov_b32 v72, 0
  v_mov_b32 v73, 0
  v_mov_b32 v74, 0
  v_mov_b32 v75, 0
  v_mov_b32 v76, 0
  v_mov_b32 v77, 0
  v_mov_b32 v78, 0
  v_mov_b32 v79, 0
  v_mov_b32 v80, 0
  v_mov_b32 v81, 0
  v_mov_b32 v82, 0
  v_mov_b32 v83, 0
  v_mov_b32 v84, 0
  v_mov_b32 v85, 0
  v_mov_b32 v86, 0
  v_mov_b32 v87, 0
  v_mov_b32 v88, 0
  v_mov_b32 v89, 0
  v_mov_b32 v90, 0
  v_mov_b32 v91, 0
  v_mov_b32 v92, 0
  v_mov_b32 v93, 0
  v_mov_b32 v94, 0
  v_mov_b32 v95, 0
  v_mov_b32 v144, 0
  v_mov_b32 v145, 0
  v_mov_b32 v146, 0
  v_mov_b32 v147, 0
  v_mov_b32 v148, 0
  v_mov_b32 v149, 0
  v_mov_b32 v150, 0
  v_mov_b32 v151, 0
  v_mov_b32 v152, 0
  v_mov_b32 v153, 0
  v_mov_b32 v154, 0
  v_mov_b32 v155, 0
  v_mov_b32 v156, 0
  v_mov_b32 v157, 0
  v_mov_b32 v158, 0
  v_mov_b32 v159, 0
  v_mov_b32 v160, 0
  v_mov_b32 v161, 0
  v_mov_b32 v162, 0
  v_mov_b32 v163, 0
  v_mov_b32 v164, 0
  v_mov_b32 v165, 0
  v_mov_b32 v166, 0
  v_mov_b32 v167, 0
  v_mov_b32 v168, 0
  v_mov_b32 v169, 0
  v_mov_b32 v170, 0
  v_mov_b32 v171, 0
  v_mov_b32 v172, 0
  v_mov_b32 v173, 0
  v_mov_b32 v174, 0
  v_mov_b32 v175, 0
  s_mov_b32 s37, 0
  s_mov_b32 s38, 98304
  v_lshrrev_b32 v214, 8, v251
  v_lshlrev_b32 v214, 3, v214
  buffer_load_dwordx2 v[176:177], v214, s[28:31], s54 offen
  buffer_load_dwordx2 v[178:179], v214, s[28:31], s54 offen offset:32
  buffer_load_dwordx2 v[180:181], v214, s[28:31], s55 offen
  buffer_load_dwordx2 v[182:183], v214, s[28:31], s55 offen offset:32
  s_mov_b32 s94, s66
  s_mov_b32 s95, 0
  s_mov_b32 s96, 0
  s_cmp_eq_u32 s35, 0
  s_cbranch_scc1 L_pro_i
  s_mov_b32 s67, 0
  s_add_u32 s43, s68, s67
  s_add_u32 s41, s95, 393216
  s_add_u32 m0, s43, 24576
  s_nop 0
  buffer_load_dwordx4 v243, s[12:15], s95 offen lds
  s_add_u32 m0, s43, 25600
  s_nop 0
  buffer_load_dwordx4 v244, s[12:15], s95 offen lds
  s_add_u32 m0, s43, 26624
  s_nop 0
  buffer_load_dwordx4 v245, s[12:15], s95 offen lds
  s_add_u32 m0, s43, 36864
  s_nop 0
  buffer_load_dwordx4 v243, s[12:15], s41 offen lds
  s_add_u32 m0, s43, 37888
  s_nop 0
  buffer_load_dwordx4 v244, s[12:15], s41 offen lds
  s_add_u32 m0, s43, 38912
  s_nop 0
  buffer_load_dwordx4 v245, s[12:15], s41 offen lds
  s_add_u32 s43, s44, s67
  s_add_u32 s40, s54, s96
  s_add_u32 m0, s43, 0
  s_nop 0
  buffer_load_dwordx4 v246, s[24:27], s40 offen lds
  s_add_u32 s40, s55, s96
  s_add_u32 m0, s43, 4096
  s_nop 0
  buffer_load_dwordx4 v246, s[24:27], s40 offen lds
  s_add_u32 s95, s95, 786432
  s_add_u32 s96, s96, 196608
  s_mov_b32 s67, 49152
  s_add_u32 s43, s68, s67
  s_add_u32 s41, s95, 393216
  s_add_u32 m0, s43, 24576
  s_nop 0
  buffer_load_dwordx4 v243, s[12:15], s95 offen lds
  s_add_u32 m0, s43, 25600
  s_nop 0
  buffer_load_dwordx4 v244, s[12:15], s95 offen lds
  s_add_u32 m0, s43, 26624
  s_nop 0
  buffer_load_dwordx4 v245, s[12:15], s95 offen lds
  s_add_u32 m0, s43, 36864
  s_nop 0
  buffer_load_dwordx4 v243, s[12:15], s41 offen lds
  s_add_u32 m0, s43, 37888
  s_nop 0
  buffer_load_dwordx4 v244, s[12:15], s41 offen lds
  s_add_u32 m0, s43, 38912
  s_nop 0
  buffer_load_dwordx4 v245, s[12:15], s41 offen lds
  s_add_u32 s43, s44, s67
  s_add_u32 s40, s54, s96
  s_add_u32 m0, s43, 0
  s_nop 0
  buffer_load_dwordx4 v246, s[24:27], s40 offen lds
  s_add_u32 s40, s55, s96
  s_add_u32 m0, s43, 4096
  s_nop 0
  buffer_load_dwordx4 v246, s[24:27], s40 offen lds
  s_add_u32 s95, s95, 786432
  s_add_u32 s96, s96, 196608
L_pro_i:
  s_add_u32 s42, s94, 0
  buffer_load_dwordx4 v[192:195], v251, s[16:19], s42 offen offset:0
  buffer_load_dwordx4 v[196:199], v251, s[16:19], s42 offen offset:1024
  s_add_u32 s42, s94, 131072
  buffer_load_dwordx4 v[200:203], v251, s[16:19], s42 offen offset:0
  buffer_load_dwordx4 v[204:207], v251, s[16:19], s42 offen offset:1024
  s_add_u32 s94, s94, 262144
  v_lshrrev_b32 v224, 4, v251
  s_movk_i32 s42, 43
  v_mul_lo_u32 v225, v224, s42
  v_lshrrev_b32 v225, 7, v225
  v_mul_u32_u24 v226, 3, v225
  v_sub_u32 v226, v224, v226
  v_min_u32 v225, 9, v225
  s_mul_i32 s42, s34, 80
  s_mul_i32 s43, s32, 10
  s_add_u32 s42, s42, s43
  v_add_u32 v225, s42, v225
  s_movk_i32 s43, 12288
  v_mul_lo_u32 v227, v225, s43
  v_lshl_add_u32 v227, v226, 7, v227
  buffer_load_dword v255, v227, s[12:15], 0 offen
  s_movk_i32 s43, 3072
  v_mul_lo_u32 v227, v225, s43
  buffer_load_dword v255, v227, s[24:27], s54 offen
  buffer_load_dword v255, v227, s[24:27], s55 offen
  s_waitcnt vmcnt(3)
  s_barrier
  s_mov_b32 s97, 0
  s_cmp_eq_u32 s35, 1
  s_cbranch_scc1 L_grpB0
  ds_read_b64_tr_b16 v[208:209], v232 offset:0
  ds_read_b64_tr_b16 v[210:211], v232 offset:6144
  ds_read_b64_tr_b16 v[212:213], v233 offset:0
  ds_read_b64_tr_b16 v[214:215], v233 offset:6144
  ds_read_b64_tr_b16 v[216:217], v234 offset:0
  ds_read_b64_tr_b16 v[218:219], v234 offset:6144
  ds_read_b64_tr_b16 v[220:221], v235 offset:0
  ds_read_b64_tr_b16 v[222:223], v235 offset:6144
  ds_read_b64_tr_b16 v[224:225], v232 offset:128
  ds_read_b64_tr_b16 v[226:227], v232 offset:6272
L_proA_loop:
  s_cmp_eq_u32 s65, 0
  s_cbranch_scc1 L_skipB_A0
  s_waitcnt lgkmcnt(8)
  v_mfma_f32_16x16x32_bf16 v[0:3], v[208:211], v[192:195], v[0:3]
  ds_read_b64_tr_b16 v[228:229], v233 offset:128
  v_mfma_f32_16x16x32_bf16 v[4:7], v[208:211], v[196:199], v[4:7]
  ds_read_b64_tr_b16 v[230:231], v233 offset:6272
  s_waitcnt lgkmcnt(8)
  v_mfma_f32_16x16x32_bf16 v[8:11], v[212:215], v[192:195], v[8:11]
  ds_read_b64_tr_b16 v[208:209], v234 offset:128
  v_mfma_f32_16x16x32_bf16 v[12:15], v[212:215], v[196:199], v[12:15]
  ds_read_b64_tr_b16 v[210:211], v234 offset:6272
  s_waitcnt lgkmcnt(8)
  v_mfma_f32_16x16x32_bf16 v[16:19], v[216:219], v[192:195], v[16:19]
  ds_read_b64_tr_b16 v[212:213], v235 offset:128
  v_mfma_f32_16x16x32_bf16 v[20:23], v[216:219], v[196:199], v[20:23]
  ds_read_b64_tr_b16 v[214:215], v235 offset:6272
  s_waitcnt lgkmcnt(8)
  v_mfma_f32_16x16x32_bf16 v[24:27], v[220:223], v[192:195], v[24:27]
  ds_read_b64_tr_b16 v[216:217], v232 offset:256
  v_mfma_f32_16x16x32_bf16 v[28:31], v[220:223], v[196:199], v[28:31]
  ds_read_b64_tr_b16 v[218:219], v232 offset:6400
  s_waitcnt lgkmcnt(8)
  v_mfma_f32_16x16x32_bf16 v[32:35], v[224:227], v[192:195], v[32:35]
  ds_read_b64_tr_b16 v[220:221], v233 offset:256
  v_mfma_f32_16x16x32_bf16 v[36:39], v[224:227], v[196:199], v[36:39]
  ds_read_b64_tr_b16 v[222:223], v233 offset:6400
  s_waitcnt lgkmcnt(8)
  v_mfma_f32_16x16x32_bf16 v[40:43], v[228:231], v[192:195], v[40:43]
  ds_read_b64_tr_b16 v[224:225], v234 offset:256
  v_mfma_f32_16x16x32_bf16 v[44:47], v[228:231], v[196:199], v[44:47]
  ds_read_b64_tr_b16 v[226:227], v234 offset:6400
  s_waitcnt lgkmcnt(8)
  v_mfma_f32_16x16x32_bf16 v[48:51], v[208:211], v[192:195], v[48:51]
  ds_read_b64_tr_b16 v[228:229], v235 offset:256
  v_mfma_f32_16x16x32_bf16 v[52:55], v[208:211], v[196:199], v[52:55]
  ds_read_b64_tr_b16 v[230:231], v235 offset:6400
  s_waitcnt lgkmcnt(8)
  v_mfma_f32_16x16x32_bf16 v[56:59], v[212:215], v[192:195], v[56:59]
  ds_read_b64_tr_b16 v[208:209], v232 offset:12288
  v_mfma_f32_16x16x32_bf16 v[60:63], v[212:215], v[196:199], v[60:63]
  ds_read_b64_tr_b16 v[210:211], v232 offset:18432
  s_waitcnt lgkmcnt(8)
  v_mfma_f32_16x16x32_bf16 v[64:67], v[216:219], v[192:195], v[64:67]
  ds_read_b64_tr_b16 v[212:213], v233 offset:12288
  v_mfma_f32_16x16x32_bf16 v[68:71], v[216:219], v[196:199], v[68:71]
  ds_read_b64_tr_b16 v[214:215], v233 offset:18432
  s_waitcnt lgkmcnt(8)
  v_mfma_f32_16x16x32_bf16 v[72:75], v[220:223], v[192:195], v[72:75]
  ds_read_b64_tr_b16 v[216:217], v234 offset:12288
  v_mfma_f32_16x16x32_bf16 v[76:79], v[220:223], v[196:199], v[76:79]
  ds_read_b64_tr_b16 v[218:219], v234 offset:18432
  s_waitcnt lgkmcnt(8)
  v_mfma_f32_16x16x32_bf16 v[80:83], v[224:227], v[192:195], v[80:83]
  ds_read_b64_tr_b16 v[220:221], v235 offset:12288
  v_mfma_f32_16x16x32_bf16 v[84:87], v[224:227], v[196:199], v[84:87]
  ds_read_b64_tr_b16 v[222:223], v235 offset:18432
  s_waitcnt lgkmcnt(8)
  v_mfma_f32_16x16x32_bf16 v[88:91], v[228:231], v[192:195], v[88:91]
  ds_read_b64_tr_b16 v[224:225], v232 offset:12416
  v_mfma_f32_16x16x32_bf16 v[92:95], v[228:231], v[196:199], v[92:95]
  ds_read_b64_tr_b16 v[226:227], v232 offset:18560
  s_waitcnt lgkmcnt(8)
  v_mfma_f32_16x16x32_bf16 v[0:3], v[208:211], v[200:203], v[0:3]
  ds_read_b64_tr_b16 v[228:229], v233 offset:12416
  v_mfma_f32_16x16x32_bf16 v[4:7], v[208:211], v[204:207], v[4:7]
  ds_read_b64_tr_b16 v[230:231], v233 offset:18560
  s_waitcnt lgkmcnt(8)
  v_mfma_f32_16x16x32_bf16 v[8:11], v[212:215], v[200:203], v[8:11]
  ds_read_b64_tr_b16 v[208:209], v234 offset:12416
  v_mfma_f32_16x16x32_bf16 v[12:15], v[212:215], v[204:207], v[12:15]
  ds_read_b64_tr_b16 v[210:211], v234 offset:18560
  s_waitcnt lgkmcnt(8)
  v_mfma_f32_16x16x32_bf16 v[16:19], v[216:219], v[200:203], v[16:19]
  ds_read_b64_tr_b16 v[212:213], v235 offset:12416
  v_mfma_f32_16x16x32_bf16 v[20:23], v[216:219], v[204:207], v[20:23]
  ds_read_b64_tr_b16 v[214:215], v235 offset:18560
  s_waitcnt lgkmcnt(8)
  v_mfma_f32_16x16x32_bf16 v[24:27], v[220:223], v[200:203], v[24:27]
  ds_read_b64_tr_b16 v[216:217], v232 offset:12544
  v_mfma_f32_16x16x32_bf16 v[28:31], v[220:223], v[204:207], v[28:31]
  ds_read_b64_tr_b16 v[218:219], v232 offset:18688
  s_waitcnt lgkmcnt(8)
  v_mfma_f32_16x16x32_bf16 v[32:35], v[224:227], v[200:203], v[32:35]
  ds_read_b64_tr_b16 v[220:221], v233 offset:12544
  v_mfma_f32_16x16x32_bf16 v[36:39], v[224:227], v[204:207], v[36:39]
  ds_read_b64_tr_b16 v[222:223], v233 offset:18688
  s_waitcnt lgkmcnt(8)
  v_mfma_f32_16x16x32_bf16 v[40:43], v[228:231], v[200:203], v[40:43]
  ds_read_b64_tr_b16 v[224:225], v234 offset:12544
  v_mfma_f32_16x16x32_bf16 v[44:47], v[228:231], v[204:207], v[44:47]
  ds_read_b64_tr_b16 v[226:227], v234 offset:18688
  s_waitcnt lgkmcnt(8)
  v_mfma_f32_16x16x32_bf16 v[48:51], v[208:211], v[200:203], v[48:51]
  ds_read_b64_tr_b16 v[228:229], v235 offset:12544
  v_mfma_f32_16x16x32_bf16 v[52:55], v[208:211], v[204:207], v[52:55]
  ds_read_b64_tr_b16 v[230:231], v235 offset:18688
  s_waitcnt lgkmcnt(8)
  v_mfma_f32_16x16x32_bf16 v[56:59], v[212:215], v[200:203], v[56:59]
  ds_read_b64_tr_b16 v[208:209], v254 offset:0
  v_mfma_f32_16x16x32_bf16 v[60:63], v[212:215], v[204:207], v[60:63]
  ds_read_b64_tr_b16 v[210:211], v254 offset:1024
  s_waitcnt lgkmcnt(8)
  v_mfma_f32_16x16x32_bf16 v[64:67], v[216:219], v[200:203], v[64:67]
  ds_read_b64_tr_b16 v[212:213], v254 offset:32
  v_mfma_f32_16x16x32_bf16 v[68:71], v[216:219], v[204:207], v[68:71]
  ds_read_b64_tr_b16 v[214:215], v254 offset:1056
  s_waitcnt lgkmcnt(8)
  v_mfma_f32_16x16x32_bf16 v[72:75], v[220:223], v[200:203], v[72:75]
  ds_read_b64_tr_b16 v[216:217], v254 offset:2048
  v_mfma_f32_16x16x32_bf16 v[76:79], v[220:223], v[204:207], v[76:79]
  ds_read_b64_tr_b16 v[218:219], v254 offset:3072
  s_waitcnt lgkmcnt(8)
  v_mfma_f32_16x16x32_bf16 v[80:83], v[224:227], v[200:203], v[80:83]
  ds_read_b64_tr_b16 v[220:221], v254 offset:2080
  v_mfma_f32_16x16x32_bf16 v[84:87], v[224:227], v[204:207], v[84:87]
  ds_read_b64_tr_b16 v[222:223], v254 offset:3104
  s_waitcnt lgkmcnt(8)
  v_mfma_f32_16x16x32_bf16 v[88:91], v[228:231], v[200:203], v[88:91]
  ds_read_b64_tr_b16 v[224:225], v254 offset:4096
  v_mfma_f32_16x16x32_bf16 v[92:95], v[228:231], v[204:207], v[92:95]
  ds_read_b64_tr_b16 v[226:227], v254 offset:5120
  s_waitcnt lgkmcnt(8)
  v_mfma_f32_16x16x32_bf16 v[144:147], v[208:211], v[192:195], v[144:147]
  ds_read_b64_tr_b16 v[228:229], v254 offset:4128
  v_mfma_f32_16x16x32_bf16 v[148:151], v[208:211], v[196:199], v[148:151]
  ds_read_b64_tr_b16 v[230:231], v254 offset:5152
  s_waitcnt lgkmcnt(8)
  v_mfma_f32_16x16x32_bf16 v[152:155], v[212:215], v[192:195], v[152:155]
  ds_read_b64_tr_b16 v[208:209], v254 offset:6144
  v_mfma_f32_16x16x32_bf16 v[156:159], v[212:215], v[196:199], v[156:159]
  ds_read_b64_tr_b16 v[210:211], v254 offset:7168
  s_waitcnt lgkmcnt(8)
  v_mfma_f32_16x16x32_bf16 v[144:147], v[216:219], v[200:203], v[144:147]
  ds_read_b64_tr_b16 v[212:213], v254 offset:6176
  v_mfma_f32_16x16x32_bf16 v[148:151], v[216:219], v[204:207], v[148:151]
  ds_read_b64_tr_b16 v[214:215], v254 offset:7200
  s_waitcnt lgkmcnt(8)
  v_mfma_f32_16x16x32_bf16 v[152:155], v[220:223], v[200:203], v[152:155]
  v_mfma_f32_16x16x32_bf16 v[156:159], v[220:223], v[204:207], v[156:159]
  s_waitcnt lgkmcnt(6)
  v_mfma_f32_16x16x32_bf16 v[160:163], v[224:227], v[192:195], v[160:163]
  v_mfma_f32_16x16x32_bf16 v[164:167], v[224:227], v[196:199], v[164:167]
  s_waitcnt lgkmcnt(4)
  v_mfma_f32_16x16x32_bf16 v[168:171], v[228:231], v[192:195], v[168:171]
  v_mfma_f32_16x16x32_bf16 v[172:175], v[228:231], v[196:199], v[172:175]
  s_waitcnt lgkmcnt(2)
  v_mfma_f32_16x16x32_bf16 v[160:163], v[208:211], v[200:203], v[160:163]
  v_mfma_f32_16x16x32_bf16 v[164:167], v[208:211], v[204:207], v[164:167]
  s_waitcnt lgkmcnt(0)
  v_mfma_f32_16x16x32_bf16 v[168:171], v[212:215], v[200:203], v[168:171]
  v_mfma_f32_16x16x32_bf16 v[172:175], v[212:215], v[204:207], v[172:175]
  s_branch L_skipE_A0
L_skipB_A0:
  s_waitcnt lgkmcnt(8)
  v_mfma_f32_16x16x32_bf16 v[0:3], v[208:211], v[192:195], v[0:3]
  ds_read_b64_tr_b16 v[228:229], v233 offset:128
  v_mfma_f32_16x16x32_bf16 v[4:7], v[208:211], v[196:199], v[4:7]
  ds_read_b64_tr_b16 v[230:231], v233 offset:6272
  s_waitcnt lgkmcnt(8)
  v_mfma_f32_16x16x32_bf16 v[8:11], v[212:215], v[192:195], v[8:11]
  ds_read_b64_tr_b16 v[208:209], v234 offset:128
  v_mfma_f32_16x16x32_bf16 v[12:15], v[212:215], v[196:199], v[12:15]
  ds_read_b64_tr_b16 v[210:211], v234 offset:6272
  s_waitcnt lgkmcnt(8)
  v_mfma_f32_16x16x32_bf16 v[16:19], v[216:219], v[192:195], v[16:19]
  ds_read_b64_tr_b16 v[212:213], v235 offset:128
  v_mfma_f32_16x16x32_bf16 v[20:23], v[216:219], v[196:199], v[20:23]
  ds_read_b64_tr_b16 v[214:215], v235 offset:6272
  s_waitcnt lgkmcnt(8)
  v_mfma_f32_16x16x32_bf16 v[24:27], v[220:223], v[192:195], v[24:27]
  ds_read_b64_tr_b16 v[216:217], v232 offset:256
  v_mfma_f32_16x16x32_bf16 v[28:31], v[220:223], v[196:199], v[28:31]
  ds_read_b64_tr_b16 v[218:219], v232 offset:6400
  s_waitcnt lgkmcnt(8)
  v_mfma_f32_16x16x32_bf16 v[32:35], v[224:227], v[192:195], v[32:35]
  ds_read_b64_tr_b16 v[220:221], v233 offset:256
  v_mfma_f32_16x16x32_bf16 v[36:39], v[224:227], v[196:199], v[36:39]
  ds_read_b64_tr_b16 v[222:223], v233 offset:6400
  s_waitcnt lgkmcnt(8)
  v_mfma_f32_16x16x32_bf16 v[40:43], v[228:231], v[192:195], v[40:43]
  ds_read_b64_tr_b16 v[224:225], v234 offset:256
  v_mfma_f32_16x16x32_bf16 v[44:47], v[228:231], v[196:199], v[44:47]
  ds_read_b64_tr_b16 v[226:227], v234 offset:6400
  s_waitcnt lgkmcnt(8)
  v_mfma_f32_16x16x32_bf16 v[48:51], v[208:211], v[192:195], v[48:51]
  ds_read_b64_tr_b16 v[228:229], v235 offset:256
  v_mfma_f32_16x16x32_bf16 v[52:55], v[208:211], v[196:199], v[52:55]
  ds_read_b64_tr_b16 v[230:231], v235 offset:6400
  s_waitcnt lgkmcnt(8)
  v_mfma_f32_16x16x32_bf16 v[56:59], v[212:215], v[192:195], v[56:59]
  ds_read_b64_tr_b16 v[208:209], v232 offset:12288
  v_mfma_f32_16x16x32_bf16 v[60:63], v[212:215], v[196:199], v[60:63]
  ds_read_b64_tr_b16 v[210:211], v232 offset:18432
  s_waitcnt lgkmcnt(8)
  v_mfma_f32_16x16x32_bf16 v[64:67], v[216:219], v[192:195], v[64:67]
  ds_read_b64_tr_b16 v[212:213], v233 offset:12288
  v_mfma_f32_16x16x32_bf16 v[68:71], v[216:219], v[196:199], v[68:71]
  ds_read_b64_tr_b16 v[214:215], v233 offset:18432
  s_waitcnt lgkmcnt(8)
  v_mfma_f32_16x16x32_bf16 v[72:75], v[220:223], v[192:195], v[72:75]
  ds_read_b64_tr_b16 v[216:217], v234 offset:12288
  v_mfma_f32_16x16x32_bf16 v[76:79], v[220:223], v[196:199], v[76:79]
  ds_read_b64_tr_b16 v[218:219], v234 offset:18432
  s_waitcnt lgkmcnt(8)
  v_mfma_f32_16x16x32_bf16 v[80:83], v[224:227], v[192:195], v[80:83]
  ds_read_b64_tr_b16 v[220:221], v235 offset:12288
  v_mfma_f32_16x16x32_bf16 v[84:87], v[224:227], v[196:199], v[84:87]
  ds_read_b64_tr_b16 v[222:223], v235 offset:18432
  s_waitcnt lgkmcnt(8)
  v_mfma_f32_16x16x32_bf16 v[88:91], v[228:231], v[192:195], v[88:91]
  ds_read_b64_tr_b16 v[224:225], v232 offset:12416
  v_mfma_f32_16x16x32_bf16 v[92:95], v[228:231], v[196:199], v[92:95]
  ds_read_b64_tr_b16 v[226:227], v232 offset:18560
  s_waitcnt lgkmcnt(8)
  v_mfma_f32_16x16x32_bf16 v[0:3], v[208:211], v[200:203], v[0:3]
  ds_read_b64_tr_b16 v[228:229], v233 offset:12416
  v_mfma_f32_16x16x32_bf16 v[4:7], v[208:211], v[204:207], v[4:7]
  ds_read_b64_tr_b16 v[230:231], v233 offset:18560
  s_waitcnt lgkmcnt(8)
  v_mfma_f32_16x16x32_bf16 v[8:11], v[212:215], v[200:203], v[8:11]
  ds_read_b64_tr_b16 v[208:209], v234 offset:12416
  v_mfma_f32_16x16x32_bf16 v[12:15], v[212:215], v[204:207], v[12:15]
  ds_read_b64_tr_b16 v[210:211], v234 offset:18560
  s_waitcnt lgkmcnt(8)
  v_mfma_f32_16x16x32_bf16 v[16:19], v[216:219], v[200:203], v[16:19]
  ds_read_b64_tr_b16 v[212:213], v235 offset:12416
  v_mfma_f32_16x16x32_bf16 v[20:23], v[216:219], v[204:207], v[20:23]
  ds_read_b64_tr_b16 v[214:215], v235 offset:18560
  s_waitcnt lgkmcnt(8)
  v_mfma_f32_16x16x32_bf16 v[24:27], v[220:223], v[200:203], v[24:27]
  ds_read_b64_tr_b16 v[216:217], v232 offset:12544
  v_mfma_f32_16x16x32_bf16 v[28:31], v[220:223], v[204:207], v[28:31]
  ds_read_b64_tr_b16 v[218:219], v232 offset:18688
  s_waitcnt lgkmcnt(8)
  v_mfma_f32_16x16x32_bf16 v[32:35], v[224:227], v[200:203], v[32:35]
  ds_read_b64_tr_b16 v[220:221], v233 offset:12544
  v_mfma_f32_16x16x32_bf16 v[36:39], v[224:227], v[204:207], v[36:39]
  ds_read_b64_tr_b16 v[222:223], v233 offset:18688
  s_waitcnt lgkmcnt(8)
  v_mfma_f32_16x16x32_bf16 v[40:43], v[228:231], v[200:203], v[40:43]
  ds_read_b64_tr_b16 v[224:225], v234 offset:12544
  v_mfma_f32_16x16x32_bf16 v[44:47], v[228:231], v[204:207], v[44:47]
  ds_read_b64_tr_b16 v[226:227], v234 offset:18688
  s_waitcnt lgkmcnt(8)
  v_mfma_f32_16x16x32_bf16 v[48:51], v[208:211], v[200:203], v[48:51]
  ds_read_b64_tr_b16 v[228:229], v235 offset:12544
  v_mfma_f32_16x16x32_bf16 v[52:55], v[208:211], v[204:207], v[52:55]
  ds_read_b64_tr_b16 v[230:231], v235 offset:18688
  s_waitcnt lgkmcnt(8)
  v_mfma_f32_16x16x32_bf16 v[56:59], v[212:215], v[200:203], v[56:59]
  ds_read_b64_tr_b16 v[208:209], v254 offset:0
  v_mfma_f32_16x16x32_bf16 v[60:63], v[212:215], v[204:207], v[60:63]
  ds_read_b64_tr_b16 v[210:211], v254 offset:1024
  s_waitcnt lgkmcnt(8)
  v_mfma_f32_16x16x32_bf16 v[64:67], v[216:219], v[200:203], v[64:67]
  ds_read_b64_tr_b16 v[212:213], v254 offset:32
  v_mfma_f32_16x16x32_bf16 v[68:71], v[216:219], v[204:207], v[68:71]
  ds_read_b64_tr_b16 v[214:215], v254 offset:1056
  s_waitcnt lgkmcnt(8)
  v_mfma_f32_16x16x32_bf16 v[72:75], v[220:223], v[200:203], v[72:75]
  ds_read_b64_tr_b16 v[216:217], v254 offset:2048
  v_mfma_f32_16x16x32_bf16 v[76:79], v[220:223], v[204:207], v[76:79]
  ds_read_b64_tr_b16 v[218:219], v254 offset:3072
  s_waitcnt lgkmcnt(8)
  v_mfma_f32_16x16x32_bf16 v[80:83], v[224:227], v[200:203], v[80:83]
  ds_read_b64_tr_b16 v[220:221], v254 offset:2080
  v_mfma_f32_16x16x32_bf16 v[84:87], v[224:227], v[204:207], v[84:87]
  ds_read_b64_tr_b16 v[222:223], v254 offset:3104
  s_waitcnt lgkmcnt(8)
  v_mfma_f32_16x16x32_bf16 v[88:91], v[228:231], v[200:203], v[88:91]
  v_mfma_f32_16x16x32_bf16 v[92:95], v[228:231], v[204:207], v[92:95]
  s_waitcnt lgkmcnt(6)
  v_mfma_f32_16x16x32_bf16 v[144:147], v[208:211], v[192:195], v[144:147]
  v_mfma_f32_16x16x32_bf16 v[148:151], v[208:211], v[196:199], v[148:151]
  s_waitcnt lgkmcnt(4)
  v_mfma_f32_16x16x32_bf16 v[152:155], v[212:215], v[192:195], v[152:155]
  v_mfma_f32_16x16x32_bf16 v[156:159], v[212:215], v[196:199], v[156:159]
  s_waitcnt lgkmcnt(2)
  v_mfma_f32_16x16x32_bf16 v[144:147], v[216:219], v[200:203], v[144:147]
  v_mfma_f32_16x16x32_bf16 v[148:151], v[216:219], v[204:207], v[148:151]
  s_waitcnt lgkmcnt(0)
  v_mfma_f32_16x16x32_bf16 v[152:155], v[220:223], v[200:203], v[152:155]
  v_mfma_f32_16x16x32_bf16 v[156:159], v[220:223], v[204:207], v[156:159]
L_skipE_A0:
  s_add_u32 s42, s94, 0
  buffer_load_dwordx4 v[96:99], v251, s[16:19], s42 offen offset:0
  buffer_load_dwordx4 v[100:103], v251, s[16:19], s42 offen offset:1024
  s_add_u32 s42, s94, 131072
  buffer_load_dwordx4 v[104:107], v251, s[16:19], s42 offen offset:0
  buffer_load_dwordx4 v[108:111], v251, s[16:19], s42 offen offset:1024
  s_add_u32 s94, s94, 262144
  s_mov_b32 s38, s37
  s_add_u32 s37, s37, 49152
  s_cmp_eq_u32 s37, 147456
  s_cselect_b32 s37, 0, s37
  s_sub_u32 s42, s37, s38
  v_add_u32 v232, s42, v232
  v_add_u32 v233, s42, v233
  v_add_u32 v234, s42, v234
  v_add_u32 v235, s42, v235
  v_add_u32 v254, s42, v254
  ds_read_b64_tr_b16 v[208:209], v232 offset:0
  ds_read_b64_tr_b16 v[210:211], v232 offset:6144
  ds_read_b64_tr_b16 v[212:213], v233 offset:0
  ds_read_b64_tr_b16 v[214:215], v233 offset:6144
  ds_read_b64_tr_b16 v[216:217], v234 offset:0
  ds_read_b64_tr_b16 v[218:219], v234 offset:6144
  ds_read_b64_tr_b16 v[220:221], v235 offset:0
  ds_read_b64_tr_b16 v[222:223], v235 offset:6144
  ds_read_b64_tr_b16 v[224:225], v232 offset:128
  ds_read_b64_tr_b16 v[226:227], v232 offset:6272
  s_waitcnt vmcnt(0)
  s_barrier
  s_cmp_eq_u32 s65, 0
  s_cbranch_scc1 L_skipB_A1
  s_waitcnt lgkmcnt(8)
  v_mfma_f32_16x16x32_bf16 v[0:3], v[208:211], v[96:99], v[0:3]
  ds_read_b64_tr_b16 v[228:229], v233 offset:128
  v_mfma_f32_16x16x32_bf16 v[4:7], v[208:211], v[100:103], v[4:7]
  ds_read_b64_tr_b16 v[230:231], v233 offset:6272
  s_waitcnt lgkmcnt(8)
  v_mfma_f32_16x16x32_bf16 v[8:11], v[212:215], v[96:99], v[8:11]
  ds_read_b64_tr_b16 v[208:209], v234 offset:128
  v_mfma_f32_16x16x32_bf16 v[12:15], v[212:215], v[100:103], v[12:15]
  ds_read_b64_tr_b16 v[210:211], v234 offset:6272
  s_waitcnt lgkmcnt(8)
  v_mfma_f32_16x16x32_bf16 v[16:19], v[216:219], v[96:99], v[16:19]
  ds_read_b64_tr_b16 v[212:213], v235 offset:128
  v_mfma_f32_16x16x32_bf16 v[20:23], v[216:219], v[100:103], v[20:23]
  ds_read_b64_tr_b16 v[214:215], v235 offset:6272
  s_waitcnt lgkmcnt(8)
  v_mfma_f32_16x16x32_bf16 v[24:27], v[220:223], v[96:99], v[24:27]
  ds_read_b64_tr_b16 v[216:217], v232 offset:256
  v_mfma_f32_16x16x32_bf16 v[28:31], v[220:223], v[100:103], v[28:31]
  ds_read_b64_tr_b16 v[218:219], v232 offset:6400
  s_waitcnt lgkmcnt(8)
  v_mfma_f32_16x16x32_bf16 v[32:35], v[224:227], v[96:99], v[32:35]
  ds_read_b64_tr_b16 v[220:221], v233 offset:256
  v_mfma_f32_16x16x32_bf16 v[36:39], v[224:227], v[100:103], v[36:39]
  ds_read_b64_tr_b16 v[222:223], v233 offset:6400
  s_waitcnt lgkmcnt(8)
  v_mfma_f32_16x16x32_bf16 v[40:43], v[228:231], v[96:99], v[40:43]
  ds_read_b64_tr_b16 v[224:225], v234 offset:256
  v_mfma_f32_16x16x32_bf16 v[44:47], v[228:231], v[100:103], v[44:47]
  ds_read_b64_tr_b16 v[226:227], v234 offset:6400
  s_waitcnt lgkmcnt(8)
  v_mfma_f32_16x16x32_bf16 v[48:51], v[208:211], v[96:99], v[48:51]
  ds_read_b64_tr_b16 v[228:229], v235 offset:256
  v_mfma_f32_16x16x32_bf16 v[52:55], v[208:211], v[100:103], v[52:55]
  ds_read_b64_tr_b16 v[230:231], v235 offset:6400
  s_waitcnt lgkmcnt(8)
  v_mfma_f32_16x16x32_bf16 v[56:59], v[212:215], v[96:99], v[56:59]
  ds_read_b64_tr_b16 v[208:209], v232 offset:12288
  v_mfma_f32_16x16x32_bf16 v[60:63], v[212:215], v[100:103], v[60:63]
  ds_read_b64_tr_b16 v[210:211], v232 offset:18432
  s_waitcnt lgkmcnt(8)
  v_mfma_f32_16x16x32_bf16 v[64:67], v[216:219], v[96:99], v[64:67]
  ds_read_b64_tr_b16 v[212:213], v233 offset:12288
  v_mfma_f32_16x16x32_bf16 v[68:71], v[216:219], v[100:103], v[68:71]
  ds_read_b64_tr_b16 v[214:215], v233 offset:18432
  s_waitcnt lgkmcnt(8)
  v_mfma_f32_16x16x32_bf16 v[72:75], v[220:223], v[96:99], v[72:75]
  ds_read_b64_tr_b16 v[216:217], v234 offset:12288
  v_mfma_f32_16x16x32_bf16 v[76:79], v[220:223], v[100:103], v[76:79]
  ds_read_b64_tr_b16 v[218:219], v234 offset:18432
  s_waitcnt lgkmcnt(8)
  v_mfma_f32_16x16x32_bf16 v[80:83], v[224:227], v[96:99], v[80:83]
  ds_read_b64_tr_b16 v[220:221], v235 offset:12288
  v_mfma_f32_16x16x32_bf16 v[84:87], v[224:227], v[100:103], v[84:87]
  ds_read_b64_tr_b16 v[222:223], v235 offset:18432
  s_waitcnt lgkmcnt(8)
  v_mfma_f32_16x16x32_bf16 v[88:91], v[228:231], v[96:99], v[88:91]
  ds_read_b64_tr_b16 v[224:225], v232 offset:12416
  v_mfma_f32_16x16x32_bf16 v[92:95], v[228:231], v[100:103], v[92:95]
  ds_read_b64_tr_b16 v[226:227], v232 offset:18560
  s_waitcnt lgkmcnt(8)
  v_mfma_f32_16x16x32_bf16 v[0:3], v[208:211], v[104:107], v[0:3]
  ds_read_b64_tr_b16 v[228:229], v233 offset:12416
  v_mfma_f32_16x16x32_bf16 v[4:7], v[208:211], v[108:111], v[4:7]
  ds_read_b64_tr_b16 v[230:231], v233 offset:18560
  s_waitcnt lgkmcnt(8)
  v_mfma_f32_16x16x32_bf16 v[8:11], v[212:215], v[104:107], v[8:11]
  ds_read_b64_tr_b16 v[208:209], v234 offset:12416
  v_mfma_f32_16x16x32_bf16 v[12:15], v[212:215], v[108:111], v[12:15]
  ds_read_b64_tr_b16 v[210:211], v234 offset:18560
  s_waitcnt lgkmcnt(8)
  v_mfma_f32_16x16x32_bf16 v[16:19], v[216:219], v[104:107], v[16:19]
  ds_read_b64_tr_b16 v[212:213], v235 offset:12416
  v_mfma_f32_16x16x32_bf16 v[20:23], v[216:219], v[108:111], v[20:23]
  ds_read_b64_tr_b16 v[214:215], v235 offset:18560
  s_waitcnt lgkmcnt(8)
  v_mfma_f32_16x16x32_bf16 v[24:27], v[220:223], v[104:107], v[24:27]
  ds_read_b64_tr_b16 v[216:217], v232 offset:12544
  v_mfma_f32_16x16x32_bf16 v[28:31], v[220:223], v[108:111], v[28:31]
  ds_read_b64_tr_b16 v[218:219], v232 offset:18688
  s_waitcnt lgkmcnt(8)
  v_mfma_f32_16x16x32_bf16 v[32:35], v[224:227], v[104:107], v[32:35]
  ds_read_b64_tr_b16 v[220:221], v233 offset:12544
  v_mfma_f32_16x16x32_bf16 v[36:39], v[224:227], v[108:111], v[36:39]
  ds_read_b64_tr_b16 v[222:223], v233 offset:18688
  s_waitcnt lgkmcnt(8)
  v_mfma_f32_16x16x32_bf16 v[40:43], v[228:231], v[104:107], v[40:43]
  ds_read_b64_tr_b16 v[224:225], v234 offset:12544
  v_mfma_f32_16x16x32_bf16 v[44:47], v[228:231], v[108:111], v[44:47]
  ds_read_b64_tr_b16 v[226:227], v234 offset:18688
  s_waitcnt lgkmcnt(8)
  v_mfma_f32_16x16x32_bf16 v[48:51], v[208:211], v[104:107], v[48:51]
  ds_read_b64_tr_b16 v[228:229], v235 offset:12544
  v_mfma_f32_16x16x32_bf16 v[52:55], v[208:211], v[108:111], v[52:55]
  ds_read_b64_tr_b16 v[230:231], v235 offset:18688
  s_waitcnt lgkmcnt(8)
  v_mfma_f32_16x16x32_bf16 v[56:59], v[212:215], v[104:107], v[56:59]
  ds_read_b64_tr_b16 v[208:209], v254 offset:0
  v_mfma_f32_16x16x32_bf16 v[60:63], v[212:215], v[108:111], v[60:63]
  ds_read_b64_tr_b16 v[210:211], v254 offset:1024
  s_waitcnt lgkmcnt(8)
  v_mfma_f32_16x16x32_bf16 v[64:67], v[216:219], v[104:107], v[64:67]
  ds_read_b64_tr_b16 v[212:213], v254 offset:32
  v_mfma_f32_16x16x32_bf16 v[68:71], v[216:219], v[108:111], v[68:71]
  ds_read_b64_tr_b16 v[214:215], v254 offset:1056
  s_waitcnt lgkmcnt(8)
  v_mfma_f32_16x16x32_bf16 v[72:75], v[220:223], v[104:107], v[72:75]
  ds_read_b64_tr_b16 v[216:217], v254 offset:2048
  v_mfma_f32_16x16x32_bf16 v[76:79], v[220:223], v[108:111], v[76:79]
  ds_read_b64_tr_b16 v[218:219], v254 offset:3072
  s_waitcnt lgkmcnt(8)
  v_mfma_f32_16x16x32_bf16 v[80:83], v[224:227], v[104:107], v[80:83]
  ds_read_b64_tr_b16 v[220:221], v254 offset:2080
  v_mfma_f32_16x16x32_bf16 v[84:87], v[224:227], v[108:111], v[84:87]
  ds_read_b64_tr_b16 v[222:223], v254 offset:3104
  s_waitcnt lgkmcnt(8)
  v_mfma_f32_16x16x32_bf16 v[88:91], v[228:231], v[104:107], v[88:91]
  ds_read_b64_tr_b16 v[224:225], v254 offset:4096
  v_mfma_f32_16x16x32_bf16 v[92:95], v[228:231], v[108:111], v[92:95]
  ds_read_b64_tr_b16 v[226:227], v254 offset:5120
  s_waitcnt lgkmcnt(8)
  v_mfma_f32_16x16x32_bf16 v[144:147], v[208:211], v[96:99], v[144:147]
  ds_read_b64_tr_b16 v[228:229], v254 offset:4128
  v_mfma_f32_16x16x32_bf16 v[148:151], v[208:211], v[100:103], v[148:151]
  ds_read_b64_tr_b16 v[230:231], v254 offset:5152
  s_waitcnt lgkmcnt(8)
  v_mfma_f32_16x16x32_bf16 v[152:155], v[212:215], v[96:99], v[152:155]
  ds_read_b64_tr_b16 v[208:209], v254 offset:6144
  v_mfma_f32_16x16x32_bf16 v[156:159], v[212:215], v[100:103], v[156:159]
  ds_read_b64_tr_b16 v[210:211], v254 offset:7168
  s_waitcnt lgkmcnt(8)
  v_mfma_f32_16x16x32_bf16 v[144:147], v[216:219], v[104:107], v[144:147]
  ds_read_b64_tr_b16 v[212:213], v254 offset:6176
  v_mfma_f32_16x16x32_bf16 v[148:151], v[216:219], v[108:111], v[148:151]
  ds_read_b64_tr_b16 v[214:215], v254 offset:7200
  s_waitcnt lgkmcnt(8)
  v_mfma_f32_16x16x32_bf16 v[152:155], v[220:223], v[104:107], v[152:155]
  v_mfma_f32_16x16x32_bf16 v[156:159], v[220:223], v[108:111], v[156:159]
  s_waitcnt lgkmcnt(6)
  v_mfma_f32_16x16x32_bf16 v[160:163], v[224:227], v[96:99], v[160:163]
  v_mfma_f32_16x16x32_bf16 v[164:167], v[224:227], v[100:103], v[164:167]
  s_waitcnt lgkmcnt(4)
  v_mfma_f32_16x16x32_bf16 v[168:171], v[228:231], v[96:99], v[168:171]
  v_mfma_f32_16x16x32_bf16 v[172:175], v[228:231], v[100:103], v[172:175]
  s_waitcnt lgkmcnt(2)
  v_mfma_f32_16x16x32_bf16 v[160:163], v[208:211], v[104:107], v[160:163]
  v_mfma_f32_16x16x32_bf16 v[164:167], v[208:211], v[108:111], v[164:167]
  s_waitcnt lgkmcnt(0)
  v_mfma_f32_16x16x32_bf16 v[168:171], v[212:215], v[104:107], v[168:171]
  v_mfma_f32_16x16x32_bf16 v[172:175], v[212:215], v[108:111], v[172:175]
  s_branch L_skipE_A1
L_skipB_A1:
  s_waitcnt lgkmcnt(8)
  v_mfma_f32_16x16x32_bf16 v[0:3], v[208:211], v[96:99], v[0:3]
  ds_read_b64_tr_b16 v[228:229], v233 offset:128
  v_mfma_f32_16x16x32_bf16 v[4:7], v[208:211], v[100:103], v[4:7]
  ds_read_b64_tr_b16 v[230:231], v233 offset:6272
  s_waitcnt lgkmcnt(8)
  v_mfma_f32_16x16x32_bf16 v[8:11], v[212:215], v[96:99], v[8:11]
  ds_read_b64_tr_b16 v[208:209], v234 offset:128
  v_mfma_f32_16x16x32_bf16 v[12:15], v[212:215], v[100:103], v[12:15]
  ds_read_b64_tr_b16 v[210:211], v234 offset:6272
  s_waitcnt lgkmcnt(8)
  v_mfma_f32_16x16x32_bf16 v[16:19], v[216:219], v[96:99], v[16:19]
  ds_read_b64_tr_b16 v[212:213], v235 offset:128
  v_mfma_f32_16x16x32_bf16 v[20:23], v[216:219], v[100:103], v[20:23]
  ds_read_b64_tr_b16 v[214:215], v235 offset:6272
  s_waitcnt lgkmcnt(8)
  v_mfma_f32_16x16x32_bf16 v[24:27], v[220:223], v[96:99], v[24:27]
  ds_read_b64_tr_b16 v[216:217], v232 offset:256
  v_mfma_f32_16x16x32_bf16 v[28:31], v[220:223], v[100:103], v[28:31]
  ds_read_b64_tr_b16 v[218:219], v232 offset:6400
  s_waitcnt lgkmcnt(8)
  v_mfma_f32_16x16x32_bf16 v[32:35], v[224:227], v[96:99], v[32:35]
  ds_read_b64_tr_b16 v[220:221], v233 offset:256
  v_mfma_f32_16x16x32_bf16 v[36:39], v[224:227], v[100:103], v[36:39]
  ds_read_b64_tr_b16 v[222:223], v233 offset:6400
  s_waitcnt lgkmcnt(8)
  v_mfma_f32_16x16x32_bf16 v[40:43], v[228:231], v[96:99], v[40:43]
  ds_read_b64_tr_b16 v[224:225], v234 offset:256
  v_mfma_f32_16x16x32_bf16 v[44:47], v[228:231], v[100:103], v[44:47]
  ds_read_b64_tr_b16 v[226:227], v234 offset:6400
  s_waitcnt lgkmcnt(8)
  v_mfma_f32_16x16x32_bf16 v[48:51], v[208:211], v[96:99], v[48:51]
  ds_read_b64_tr_b16 v[228:229], v235 offset:256
  v_mfma_f32_16x16x32_bf16 v[52:55], v[208:211], v[100:103], v[52:55]
  ds_read_b64_tr_b16 v[230:231], v235 offset:6400
  s_waitcnt lgkmcnt(8)
  v_mfma_f32_16x16x32_bf16 v[56:59], v[212:215], v[96:99], v[56:59]
  ds_read_b64_tr_b16 v[208:209], v232 offset:12288
  v_mfma_f32_16x16x32_bf16 v[60:63], v[212:215], v[100:103], v[60:63]
  ds_read_b64_tr_b16 v[210:211], v232 offset:18432
  s_waitcnt lgkmcnt(8)
  v_mfma_f32_16x16x32_bf16 v[64:67], v[216:219], v[96:99], v[64:67]
  ds_read_b64_tr_b16 v[212:213], v233 offset:12288
  v_mfma_f32_16x16x32_bf16 v[68:71], v[216:219], v[100:103], v[68:71]
  ds_read_b64_tr_b16 v[214:215], v233 offset:18432
  s_waitcnt lgkmcnt(8)
  v_mfma_f32_16x16x32_bf16 v[72:75], v[220:223], v[96:99], v[72:75]
  ds_read_b64_tr_b16 v[216:217], v234 offset:12288
  v_mfma_f32_16x16x32_bf16 v[76:79], v[220:223], v[100:103], v[76:79]
  ds_read_b64_tr_b16 v[218:219], v234 offset:18432
  s_waitcnt lgkmcnt(8)
  v_mfma_f32_16x16x32_bf16 v[80:83], v[224:227], v[96:99], v[80:83]
  ds_read_b64_tr_b16 v[220:221], v235 offset:12288
  v_mfma_f32_16x16x32_bf16 v[84:87], v[224:227], v[100:103], v[84:87]
  ds_read_b64_tr_b16 v[222:223], v235 offset:18432
  s_waitcnt lgkmcnt(8)
  v_mfma_f32_16x16x32_bf16 v[88:91], v[228:231], v[96:99], v[88:91]
  ds_read_b64_tr_b16 v[224:225], v232 offset:12416
  v_mfma_f32_16x16x32_bf16 v[92:95], v[228:231], v[100:103], v[92:95]
  ds_read_b64_tr_b16 v[226:227], v232 offset:18560
  s_waitcnt lgkmcnt(8)
  v_mfma_f32_16x16x32_bf16 v[0:3], v[208:211], v[104:107], v[0:3]
  ds_read_b64_tr_b16 v[228:229], v233 offset:12416
  v_mfma_f32_16x16x32_bf16 v[4:7], v[208:211], v[108:111], v[4:7]
  ds_read_b64_tr_b16 v[230:231], v233 offset:18560
  s_waitcnt lgkmcnt(8)
  v_mfma_f32_16x16x32_bf16 v[8:11], v[212:215], v[104:107], v[8:11]
  ds_read_b64_tr_b16 v[208:209], v234 offset:12416
  v_mfma_f32_16x16x32_bf16 v[12:15], v[212:215], v[108:111], v[12:15]
  ds_read_b64_tr_b16 v[210:211], v234 offset:18560
  s_waitcnt lgkmcnt(8)
  v_mfma_f32_16x16x32_bf16 v[16:19], v[216:219], v[104:107], v[16:19]
  ds_read_b64_tr_b16 v[212:213], v235 offset:12416
  v_mfma_f32_16x16x32_bf16 v[20:23], v[216:219], v[108:111], v[20:23]
  ds_read_b64_tr_b16 v[214:215], v235 offset:18560
  s_waitcnt lgkmcnt(8)
  v_mfma_f32_16x16x32_bf16 v[24:27], v[220:223], v[104:107], v[24:27]
  ds_read_b64_tr_b16 v[216:217], v232 offset:12544
  v_mfma_f32_16x16x32_bf16 v[28:31], v[220:223], v[108:111], v[28:31]
  ds_read_b64_tr_b16 v[218:219], v232 offset:18688
  s_waitcnt lgkmcnt(8)
  v_mfma_f32_16x16x32_bf16 v[32:35], v[224:227], v[104:107], v[32:35]
  ds_read_b64_tr_b16 v[220:221], v233 offset:12544
  v_mfma_f32_16x16x32_bf16 v[36:39], v[224:227], v[108:111], v[36:39]
  ds_read_b64_tr_b16 v[222:223], v233 offset:18688
  s_waitcnt lgkmcnt(8)
  v_mfma_f32_16x16x32_bf16 v[40:43], v[228:231], v[104:107], v[40:43]
  ds_read_b64_tr_b16 v[224:225], v234 offset:12544
  v_mfma_f32_16x16x32_bf16 v[44:47], v[228:231], v[108:111], v[44:47]
  ds_read_b64_tr_b16 v[226:227], v234 offset:18688
  s_waitcnt lgkmcnt(8)
  v_mfma_f32_16x16x32_bf16 v[48:51], v[208:211], v[104:107], v[48:51]
  ds_read_b64_tr_b16 v[228:229], v235 offset:12544
  v_mfma_f32_16x16x32_bf16 v[52:55], v[208:211], v[108:111], v[52:55]
  ds_read_b64_tr_b16 v[230:231], v235 offset:18688
  s_waitcnt lgkmcnt(8)
  v_mfma_f32_16x16x32_bf16 v[56:59], v[212:215], v[104:107], v[56:59]
  ds_read_b64_tr_b16 v[208:209], v254 offset:0
  v_mfma_f32_16x16x32_bf16 v[60:63], v[212:215], v[108:111], v[60:63]
  ds_read_b64_tr_b16 v[210:211], v254 offset:1024
  s_waitcnt lgkmcnt(8)
  v_mfma_f32_16x16x32_bf16 v[64:67], v[216:219], v[104:107], v[64:67]
  ds_read_b64_tr_b16 v[212:213], v254 offset:32
  v_mfma_f32_16x16x32_bf16 v[68:71], v[216:219], v[108:111], v[68:71]
  ds_read_b64_tr_b16 v[214:215], v254 offset:1056
  s_waitcnt lgkmcnt(8)
  v_mfma_f32_16x16x32_bf16 v[72:75], v[220:223], v[104:107], v[72:75]
  ds_read_b64_tr_b16 v[216:217], v254 offset:2048
  v_mfma_f32_16x16x32_bf16 v[76:79], v[220:223], v[108:111], v[76:79]
  ds_read_b64_tr_b16 v[218:219], v254 offset:3072
  s_waitcnt lgkmcnt(8)
  v_mfma_f32_16x16x32_bf16 v[80:83], v[224:227], v[104:107], v[80:83]
  ds_read_b64_tr_b16 v[220:221], v254 offset:2080
  v_mfma_f32_16x16x32_bf16 v[84:87], v[224:227], v[108:111], v[84:87]
  ds_read_b64_tr_b16 v[222:223], v254 offset:3104
  s_waitcnt lgkmcnt(8)
  v_mfma_f32_16x16x32_bf16 v[88:91], v[228:231], v[104:107], v[88:91]
  v_mfma_f32_16x16x32_bf16 v[92:95], v[228:231], v[108:111], v[92:95]
  s_waitcnt lgkmcnt(6)
  v_mfma_f32_16x16x32_bf16 v[144:147], v[208:211], v[96:99], v[144:147]
  v_mfma_f32_16x16x32_bf16 v[148:151], v[208:211], v[100:103], v[148:151]
  s_waitcnt lgkmcnt(4)
  v_mfma_f32_16x16x32_bf16 v[152:155], v[212:215], v[96:99], v[152:155]
  v_mfma_f32_16x16x32_bf16 v[156:159], v[212:215], v[100:103], v[156:159]
  s_waitcnt lgkmcnt(2)
  v_mfma_f32_16x16x32_bf16 v[144:147], v[216:219], v[104:107], v[144:147]
  v_mfma_f32_16x16x32_bf16 v[148:151], v[216:219], v[108:111], v[148:151]
  s_waitcnt lgkmcnt(0)
  v_mfma_f32_16x16x32_bf16 v[152:155], v[220:223], v[104:107], v[152:155]
  v_mfma_f32_16x16x32_bf16 v[156:159], v[220:223], v[108:111], v[156:159]
L_skipE_A1:
  s_add_u32 s42, s94, 0
  buffer_load_dwordx4 v[192:195], v251, s[16:19], s42 offen offset:0
  buffer_load_dwordx4 v[196:199], v251, s[16:19], s42 offen offset:1024
  s_add_u32 s42, s94, 131072
  buffer_load_dwordx4 v[200:203], v251, s[16:19], s42 offen offset:0
  buffer_load_dwordx4 v[204:207], v251, s[16:19], s42 offen offset:1024
  s_add_u32 s94, s94, 262144
  s_mov_b32 s38, s37
  s_add_u32 s37, s37, 49152
  s_cmp_eq_u32 s37, 147456
  s_cselect_b32 s37, 0, s37
  s_sub_u32 s42, s37, s38
  v_add_u32 v232, s42, v232
  v_add_u32 v233, s42, v233
  v_add_u32 v234, s42, v234
  v_add_u32 v235, s42, v235
  v_add_u32 v254, s42, v254
  ds_read_b64_tr_b16 v[208:209], v232 offset:0
  ds_read_b64_tr_b16 v[210:211], v232 offset:6144
  ds_read_b64_tr_b16 v[212:213], v233 offset:0
  ds_read_b64_tr_b16 v[214:215], v233 offset:6144
  ds_read_b64_tr_b16 v[216:217], v234 offset:0
  ds_read_b64_tr_b16 v[218:219], v234 offset:6144
  ds_read_b64_tr_b16 v[220:221], v235 offset:0
  ds_read_b64_tr_b16 v[222:223], v235 offset:6144
  ds_read_b64_tr_b16 v[224:225], v232 offset:128
  ds_read_b64_tr_b16 v[226:227], v232 offset:6272
  s_waitcnt vmcnt(0)
  s_barrier
  s_add_u32 s97, s97, 1
  s_cmp_lt_u32 s97, 4
  s_cbranch_scc1 L_proA_loop
  s_cmp_eq_u32 s65, 0
  s_cbranch_scc1 L_skipB_A8
  s_waitcnt lgkmcnt(8)
  v_mfma_f32_16x16x32_bf16 v[0:3], v[208:211], v[192:195], v[0:3]
  ds_read_b64_tr_b16 v[228:229], v233 offset:128
  v_mfma_f32_16x16x32_bf16 v[4:7], v[208:211], v[196:199], v[4:7]
  ds_read_b64_tr_b16 v[230:231], v233 offset:6272
  s_waitcnt lgkmcnt(8)
  v_mfma_f32_16x16x32_bf16 v[8:11], v[212:215], v[192:195], v[8:11]
  ds_read_b64_tr_b16 v[208:209], v234 offset:128
  v_mfma_f32_16x16x32_bf16 v[12:15], v[212:215], v[196:199], v[12:15]
  ds_read_b64_tr_b16 v[210:211], v234 offset:6272
  s_waitcnt lgkmcnt(8)
  v_mfma_f32_16x16x32_bf16 v[16:19], v[216:219], v[192:195], v[16:19]
  ds_read_b64_tr_b16 v[212:213], v235 offset:128
  v_mfma_f32_16x16x32_bf16 v[20:23], v[216:219], v[196:199], v[20:23]
  ds_read_b64_tr_b16 v[214:215], v235 offset:6272
  s_waitcnt lgkmcnt(8)
  v_mfma_f32_16x16x32_bf16 v[24:27], v[220:223], v[192:195], v[24:27]
  ds_read_b64_tr_b16 v[216:217], v232 offset:256
  v_mfma_f32_16x16x32_bf16 v[28:31], v[220:223], v[196:199], v[28:31]
  ds_read_b64_tr_b16 v[218:219], v232 offset:6400
  s_waitcnt lgkmcnt(8)
  v_mfma_f32_16x16x32_bf16 v[32:35], v[224:227], v[192:195], v[32:35]
  ds_read_b64_tr_b16 v[220:221], v233 offset:256
  v_mfma_f32_16x16x32_bf16 v[36:39], v[224:227], v[196:199], v[36:39]
  ds_read_b64_tr_b16 v[222:223], v233 offset:6400
  s_waitcnt lgkmcnt(8)
  v_mfma_f32_16x16x32_bf16 v[40:43], v[228:231], v[192:195], v[40:43]
  ds_read_b64_tr_b16 v[224:225], v234 offset:256
  v_mfma_f32_16x16x32_bf16 v[44:47], v[228:231], v[196:199], v[44:47]
  ds_read_b64_tr_b16 v[226:227], v234 offset:6400
  s_waitcnt lgkmcnt(8)
  v_mfma_f32_16x16x32_bf16 v[48:51], v[208:211], v[192:195], v[48:51]
  ds_read_b64_tr_b16 v[228:229], v235 offset:256
  v_mfma_f32_16x16x32_bf16 v[52:55], v[208:211], v[196:199], v[52:55]
  ds_read_b64_tr_b16 v[230:231], v235 offset:6400
  s_waitcnt lgkmcnt(8)
  v_mfma_f32_16x16x32_bf16 v[56:59], v[212:215], v[192:195], v[56:59]
  ds_read_b64_tr_b16 v[208:209], v232 offset:12288
  v_mfma_f32_16x16x32_bf16 v[60:63], v[212:215], v[196:199], v[60:63]
  ds_read_b64_tr_b16 v[210:211], v232 offset:18432
  s_waitcnt lgkmcnt(8)
  v_mfma_f32_16x16x32_bf16 v[64:67], v[216:219], v[192:195], v[64:67]
  ds_read_b64_tr_b16 v[212:213], v233 offset:12288
  v_mfma_f32_16x16x32_bf16 v[68:71], v[216:219], v[196:199], v[68:71]
  ds_read_b64_tr_b16 v[214:215], v233 offset:18432
  s_waitcnt lgkmcnt(8)
  v_mfma_f32_16x16x32_bf16 v[72:75], v[220:223], v[192:195], v[72:75]
  ds_read_b64_tr_b16 v[216:217], v234 offset:12288
  v_mfma_f32_16x16x32_bf16 v[76:79], v[220:223], v[196:199], v[76:79]
  ds_read_b64_tr_b16 v[218:219], v234 offset:18432
  s_waitcnt lgkmcnt(8)
  v_mfma_f32_16x16x32_bf16 v[80:83], v[224:227], v[192:195], v[80:83]
  ds_read_b64_tr_b16 v[220:221], v235 offset:12288
  v_mfma_f32_16x16x32_bf16 v[84:87], v[224:227], v[196:199], v[84:87]
  ds_read_b64_tr_b16 v[222:223], v235 offset:18432
  s_waitcnt lgkmcnt(8)
  v_mfma_f32_16x16x32_bf16 v[88:91], v[228:231], v[192:195], v[88:91]
  ds_read_b64_tr_b16 v[224:225], v232 offset:12416
  v_mfma_f32_16x16x32_bf16 v[92:95], v[228:231], v[196:199], v[92:95]
  ds_read_b64_tr_b16 v[226:227], v232 offset:18560
  s_waitcnt lgkmcnt(8)
  v_mfma_f32_16x16x32_bf16 v[0:3], v[208:211], v[200:203], v[0:3]
  ds_read_b64_tr_b16 v[228:229], v233 offset:12416
  v_mfma_f32_16x16x32_bf16 v[4:7], v[208:211], v[204:207], v[4:7]
  ds_read_b64_tr_b16 v[230:231], v233 offset:18560
  s_waitcnt lgkmcnt(8)
  v_mfma_f32_16x16x32_bf16 v[8:11], v[212:215], v[200:203], v[8:11]
  ds_read_b64_tr_b16 v[208:209], v234 offset:12416
  v_mfma_f32_16x16x32_bf16 v[12:15], v[212:215], v[204:207], v[12:15]
  ds_read_b64_tr_b16 v[210:211], v234 offset:18560
  s_waitcnt lgkmcnt(8)
  v_mfma_f32_16x16x32_bf16 v[16:19], v[216:219], v[200:203], v[16:19]
  ds_read_b64_tr_b16 v[212:213], v235 offset:12416
  v_mfma_f32_16x16x32_bf16 v[20:23], v[216:219], v[204:207], v[20:23]
  ds_read_b64_tr_b16 v[214:215], v235 offset:18560
  s_waitcnt lgkmcnt(8)
  v_mfma_f32_16x16x32_bf16 v[24:27], v[220:223], v[200:203], v[24:27]
  ds_read_b64_tr_b16 v[216:217], v232 offset:12544
  v_mfma_f32_16x16x32_bf16 v[28:31], v[220:223], v[204:207], v[28:31]
  ds_read_b64_tr_b16 v[218:219], v232 offset:18688
  s_waitcnt lgkmcnt(8)
  v_mfma_f32_16x16x32_bf16 v[32:35], v[224:227], v[200:203], v[32:35]
  ds_read_b64_tr_b16 v[220:221], v233 offset:12544
  v_mfma_f32_16x16x32_bf16 v[36:39], v[224:227], v[204:207], v[36:39]
  ds_read_b64_tr_b16 v[222:223], v233 offset:18688
  s_waitcnt lgkmcnt(8)
  v_mfma_f32_16x16x32_bf16 v[40:43], v[228:231], v[200:203], v[40:43]
  ds_read_b64_tr_b16 v[224:225], v234 offset:12544
  v_mfma_f32_16x16x32_bf16 v[44:47], v[228:231], v[204:207], v[44:47]
  ds_read_b64_tr_b16 v[226:227], v234 offset:18688
  s_waitcnt lgkmcnt(8)
  v_mfma_f32_16x16x32_bf16 v[48:51], v[208:211], v[200:203], v[48:51]
  ds_read_b64_tr_b16 v[228:229], v235 offset:12544
  v_mfma_f32_16x16x32_bf16 v[52:55], v[208:211], v[204:207], v[52:55]
  ds_read_b64_tr_b16 v[230:231], v235 offset:18688
  s_waitcnt lgkmcnt(8)
  v_mfma_f32_16x16x32_bf16 v[56:59], v[212:215], v[200:203], v[56:59]
  ds_read_b64_tr_b16 v[208:209], v254 offset:0
  v_mfma_f32_16x16x32_bf16 v[60:63], v[212:215], v[204:207], v[60:63]
  ds_read_b64_tr_b16 v[210:211], v254 offset:1024
  s_waitcnt lgkmcnt(8)
  v_mfma_f32_16x16x32_bf16 v[64:67], v[216:219], v[200:203], v[64:67]
  ds_read_b64_tr_b16 v[212:213], v254 offset:32
  v_mfma_f32_16x16x32_bf16 v[68:71], v[216:219], v[204:207], v[68:71]
  ds_read_b64_tr_b16 v[214:215], v254 offset:1056
  s_waitcnt lgkmcnt(8)
  v_mfma_f32_16x16x32_bf16 v[72:75], v[220:223], v[200:203], v[72:75]
  ds_read_b64_tr_b16 v[216:217], v254 offset:2048
  v_mfma_f32_16x16x32_bf16 v[76:79], v[220:223], v[204:207], v[76:79]
  ds_read_b64_tr_b16 v[218:219], v254 offset:3072
  s_waitcnt lgkmcnt(8)
  v_mfma_f32_16x16x32_bf16 v[80:83], v[224:227], v[200:203], v[80:83]
  ds_read_b64_tr_b16 v[220:221], v254 offset:2080
  v_mfma_f32_16x16x32_bf16 v[84:87], v[224:227], v[204:207], v[84:87]
  ds_read_b64_tr_b16 v[222:223], v254 offset:3104
  s_waitcnt lgkmcnt(8)
  v_mfma_f32_16x16x32_bf16 v[88:91], v[228:231], v[200:203], v[88:91]
  ds_read_b64_tr_b16 v[224:225], v254 offset:4096
  v_mfma_f32_16x16x32_bf16 v[92:95], v[228:231], v[204:207], v[92:95]
  ds_read_b64_tr_b16 v[226:227], v254 offset:5120
  s_waitcnt lgkmcnt(8)
  v_mfma_f32_16x16x32_bf16 v[144:147], v[208:211], v[192:195], v[144:147]
  ds_read_b64_tr_b16 v[228:229], v254 offset:4128
  v_mfma_f32_16x16x32_bf16 v[148:151], v[208:211], v[196:199], v[148:151]
  ds_read_b64_tr_b16 v[230:231], v254 offset:5152
  s_waitcnt lgkmcnt(8)
  v_mfma_f32_16x16x32_bf16 v[152:155], v[212:215], v[192:195], v[152:155]
  ds_read_b64_tr_b16 v[208:209], v254 offset:6144
  v_mfma_f32_16x16x32_bf16 v[156:159], v[212:215], v[196:199], v[156:159]
  ds_read_b64_tr_b16 v[210:211], v254 offset:7168
  s_waitcnt lgkmcnt(8)
  v_mfma_f32_16x16x32_bf16 v[144:147], v[216:219], v[200:203], v[144:147]
  ds_read_b64_tr_b16 v[212:213], v254 offset:6176
  v_mfma_f32_16x16x32_bf16 v[148:151], v[216:219], v[204:207], v[148:151]
  ds_read_b64_tr_b16 v[214:215], v254 offset:7200
  s_waitcnt lgkmcnt(8)
  v_mfma_f32_16x16x32_bf16 v[152:155], v[220:223], v[200:203], v[152:155]
  v_mfma_f32_16x16x32_bf16 v[156:159], v[220:223], v[204:207], v[156:159]
  s_waitcnt lgkmcnt(6)
  v_mfma_f32_16x16x32_bf16 v[160:163], v[224:227], v[192:195], v[160:163]
  v_mfma_f32_16x16x32_bf16 v[164:167], v[224:227], v[196:199], v[164:167]
  s_waitcnt lgkmcnt(4)
  v_mfma_f32_16x16x32_bf16 v[168:171], v[228:231], v[192:195], v[168:171]
  v_mfma_f32_16x16x32_bf16 v[172:175], v[228:231], v[196:199], v[172:175]
  s_waitcnt lgkmcnt(2)
  v_mfma_f32_16x16x32_bf16 v[160:163], v[208:211], v[200:203], v[160:163]
  v_mfma_f32_16x16x32_bf16 v[164:167], v[208:211], v[204:207], v[164:167]
  s_waitcnt lgkmcnt(0)
  v_mfma_f32_16x16x32_bf16 v[168:171], v[212:215], v[200:203], v[168:171]
  v_mfma_f32_16x16x32_bf16 v[172:175], v[212:215], v[204:207], v[172:175]
  s_branch L_skipE_A8
L_skipB_A8:
  s_waitcnt lgkmcnt(8)
  v_mfma_f32_16x16x32_bf16 v[0:3], v[208:211], v[192:195], v[0:3]
  ds_read_b64_tr_b16 v[228:229], v233 offset:128
  v_mfma_f32_16x16x32_bf16 v[4:7], v[208:211], v[196:199], v[4:7]
  ds_read_b64_tr_b16 v[230:231], v233 offset:6272
  s_waitcnt lgkmcnt(8)
  v_mfma_f32_16x16x32_bf16 v[8:11], v[212:215], v[192:195], v[8:11]
  ds_read_b64_tr_b16 v[208:209], v234 offset:128
  v_mfma_f32_16x16x32_bf16 v[12:15], v[212:215], v[196:199], v[12:15]
  ds_read_b64_tr_b16 v[210:211], v234 offset:6272
  s_waitcnt lgkmcnt(8)
  v_mfma_f32_16x16x32_bf16 v[16:19], v[216:219], v[192:195], v[16:19]
  ds_read_b64_tr_b16 v[212:213], v235 offset:128
  v_mfma_f32_16x16x32_bf16 v[20:23], v[216:219], v[196:199], v[20:23]
  ds_read_b64_tr_b16 v[214:215], v235 offset:6272
  s_waitcnt lgkmcnt(8)
  v_mfma_f32_16x16x32_bf16 v[24:27], v[220:223], v[192:195], v[24:27]
  ds_read_b64_tr_b16 v[216:217], v232 offset:256
  v_mfma_f32_16x16x32_bf16 v[28:31], v[220:223], v[196:199], v[28:31]
  ds_read_b64_tr_b16 v[218:219], v232 offset:6400
  s_waitcnt lgkmcnt(8)
  v_mfma_f32_16x16x32_bf16 v[32:35], v[224:227], v[192:195], v[32:35]
  ds_read_b64_tr_b16 v[220:221], v233 offset:256
  v_mfma_f32_16x16x32_bf16 v[36:39], v[224:227], v[196:199], v[36:39]
  ds_read_b64_tr_b16 v[222:223], v233 offset:6400
  s_waitcnt lgkmcnt(8)
  v_mfma_f32_16x16x32_bf16 v[40:43], v[228:231], v[192:195], v[40:43]
  ds_read_b64_tr_b16 v[224:225], v234 offset:256
  v_mfma_f32_16x16x32_bf16 v[44:47], v[228:231], v[196:199], v[44:47]
  ds_read_b64_tr_b16 v[226:227], v234 offset:6400
  s_waitcnt lgkmcnt(8)
  v_mfma_f32_16x16x32_bf16 v[48:51], v[208:211], v[192:195], v[48:51]
  ds_read_b64_tr_b16 v[228:229], v235 offset:256
  v_mfma_f32_16x16x32_bf16 v[52:55], v[208:211], v[196:199], v[52:55]
  ds_read_b64_tr_b16 v[230:231], v235 offset:6400
  s_waitcnt lgkmcnt(8)
  v_mfma_f32_16x16x32_bf16 v[56:59], v[212:215], v[192:195], v[56:59]
  ds_read_b64_tr_b16 v[208:209], v232 offset:12288
  v_mfma_f32_16x16x32_bf16 v[60:63], v[212:215], v[196:199], v[60:63]
  ds_read_b64_tr_b16 v[210:211], v232 offset:18432
  s_waitcnt lgkmcnt(8)
  v_mfma_f32_16x16x32_bf16 v[64:67], v[216:219], v[192:195], v[64:67]
  ds_read_b64_tr_b16 v[212:213], v233 offset:12288
  v_mfma_f32_16x16x32_bf16 v[68:71], v[216:219], v[196:199], v[68:71]
  ds_read_b64_tr_b16 v[214:215], v233 offset:18432
  s_waitcnt lgkmcnt(8)
  v_mfma_f32_16x16x32_bf16 v[72:75], v[220:223], v[192:195], v[72:75]
  ds_read_b64_tr_b16 v[216:217], v234 offset:12288
  v_mfma_f32_16x16x32_bf16 v[76:79], v[220:223], v[196:199], v[76:79]
  ds_read_b64_tr_b16 v[218:219], v234 offset:18432
  s_waitcnt lgkmcnt(8)
  v_mfma_f32_16x16x32_bf16 v[80:83], v[224:227], v[192:195], v[80:83]
  ds_read_b64_tr_b16 v[220:221], v235 offset:12288
  v_mfma_f32_16x16x32_bf16 v[84:87], v[224:227], v[196:199], v[84:87]
  ds_read_b64_tr_b16 v[222:223], v235 offset:18432
  s_waitcnt lgkmcnt(8)
  v_mfma_f32_16x16x32_bf16 v[88:91], v[228:231], v[192:195], v[88:91]
  ds_read_b64_tr_b16 v[224:225], v232 offset:12416
  v_mfma_f32_16x16x32_bf16 v[92:95], v[228:231], v[196:199], v[92:95]
  ds_read_b64_tr_b16 v[226:227], v232 offset:18560
  s_waitcnt lgkmcnt(8)
  v_mfma_f32_16x16x32_bf16 v[0:3], v[208:211], v[200:203], v[0:3]
  ds_read_b64_tr_b16 v[228:229], v233 offset:12416
  v_mfma_f32_16x16x32_bf16 v[4:7], v[208:211], v[204:207], v[4:7]
  ds_read_b64_tr_b16 v[230:231], v233 offset:18560
  s_waitcnt lgkmcnt(8)
  v_mfma_f32_16x16x32_bf16 v[8:11], v[212:215], v[200:203], v[8:11]
  ds_read_b64_tr_b16 v[208:209], v234 offset:12416
  v_mfma_f32_16x16x32_bf16 v[12:15], v[212:215], v[204:207], v[12:15]
  ds_read_b64_tr_b16 v[210:211], v234 offset:18560
  s_waitcnt lgkmcnt(8)
  v_mfma_f32_16x16x32_bf16 v[16:19], v[216:219], v[200:203], v[16:19]
  ds_read_b64_tr_b16 v[212:213], v235 offset:12416
  v_mfma_f32_16x16x32_bf16 v[20:23], v[216:219], v[204:207], v[20:23]
  ds_read_b64_tr_b16 v[214:215], v235 offset:18560
  s_waitcnt lgkmcnt(8)
  v_mfma_f32_16x16x32_bf16 v[24:27], v[220:223], v[200:203], v[24:27]
  ds_read_b64_tr_b16 v[216:217], v232 offset:12544
  v_mfma_f32_16x16x32_bf16 v[28:31], v[220:223], v[204:207], v[28:31]
  ds_read_b64_tr_b16 v[218:219], v232 offset:18688
  s_waitcnt lgkmcnt(8)
  v_mfma_f32_16x16x32_bf16 v[32:35], v[224:227], v[200:203], v[32:35]
  ds_read_b64_tr_b16 v[220:221], v233 offset:12544
  v_mfma_f32_16x16x32_bf16 v[36:39], v[224:227], v[204:207], v[36:39]
  ds_read_b64_tr_b16 v[222:223], v233 offset:18688
  s_waitcnt lgkmcnt(8)
  v_mfma_f32_16x16x32_bf16 v[40:43], v[228:231], v[200:203], v[40:43]
  ds_read_b64_tr_b16 v[224:225], v234 offset:12544
  v_mfma_f32_16x16x32_bf16 v[44:47], v[228:231], v[204:207], v[44:47]
  ds_read_b64_tr_b16 v[226:227], v234 offset:18688
  s_waitcnt lgkmcnt(8)
  v_mfma_f32_16x16x32_bf16 v[48:51], v[208:211], v[200:203], v[48:51]
  ds_read_b64_tr_b16 v[228:229], v235 offset:12544
  v_mfma_f32_16x16x32_bf16 v[52:55], v[208:211], v[204:207], v[52:55]
  ds_read_b64_tr_b16 v[230:231], v235 offset:18688
  s_waitcnt lgkmcnt(8)
  v_mfma_f32_16x16x32_bf16 v[56:59], v[212:215], v[200:203], v[56:59]
  ds_read_b64_tr_b16 v[208:209], v254 offset:0
  v_mfma_f32_16x16x32_bf16 v[60:63], v[212:215], v[204:207], v[60:63]
  ds_read_b64_tr_b16 v[210:211], v254 offset:1024
  s_waitcnt lgkmcnt(8)
  v_mfma_f32_16x16x32_bf16 v[64:67], v[216:219], v[200:203], v[64:67]
  ds_read_b64_tr_b16 v[212:213], v254 offset:32
  v_mfma_f32_16x16x32_bf16 v[68:71], v[216:219], v[204:207], v[68:71]
  ds_read_b64_tr_b16 v[214:215], v254 offset:1056
  s_waitcnt lgkmcnt(8)
  v_mfma_f32_16x16x32_bf16 v[72:75], v[220:223], v[200:203], v[72:75]
  ds_read_b64_tr_b16 v[216:217], v254 offset:2048
  v_mfma_f32_16x16x32_bf16 v[76:79], v[220:223], v[204:207], v[76:79]
  ds_read_b64_tr_b16 v[218:219], v254 offset:3072
  s_waitcnt lgkmcnt(8)
  v_mfma_f32_16x16x32_bf16 v[80:83], v[224:227], v[200:203], v[80:83]
  ds_read_b64_tr_b16 v[220:221], v254 offset:2080
  v_mfma_f32_16x16x32_bf16 v[84:87], v[224:227], v[204:207], v[84:87]
  ds_read_b64_tr_b16 v[222:223], v254 offset:3104
  s_waitcnt lgkmcnt(8)
  v_mfma_f32_16x16x32_bf16 v[88:91], v[228:231], v[200:203], v[88:91]
  v_mfma_f32_16x16x32_bf16 v[92:95], v[228:231], v[204:207], v[92:95]
  s_waitcnt lgkmcnt(6)
  v_mfma_f32_16x16x32_bf16 v[144:147], v[208:211], v[192:195], v[144:147]
  v_mfma_f32_16x16x32_bf16 v[148:151], v[208:211], v[196:199], v[148:151]
  s_waitcnt lgkmcnt(4)
  v_mfma_f32_16x16x32_bf16 v[152:155], v[212:215], v[192:195], v[152:155]
  v_mfma_f32_16x16x32_bf16 v[156:159], v[212:215], v[196:199], v[156:159]
  s_waitcnt lgkmcnt(2)
  v_mfma_f32_16x16x32_bf16 v[144:147], v[216:219], v[200:203], v[144:147]
  v_mfma_f32_16x16x32_bf16 v[148:151], v[216:219], v[204:207], v[148:151]
  s_waitcnt lgkmcnt(0)
  v_mfma_f32_16x16x32_bf16 v[152:155], v[220:223], v[200:203], v[152:155]
  v_mfma_f32_16x16x32_bf16 v[156:159], v[220:223], v[204:207], v[156:159]
L_skipE_A8:
  s_add_u32 s42, s94, 0
  buffer_load_dwordx4 v[96:99], v251, s[16:19], s42 offen offset:0
  buffer_load_dwordx4 v[100:103], v251, s[16:19], s42 offen offset:1024
  s_add_u32 s42, s94, 131072
  buffer_load_dwordx4 v[104:107], v251, s[16:19], s42 offen offset:0
  buffer_load_dwordx4 v[108:111], v251, s[16:19], s42 offen offset:1024
  s_add_u32 s94, s94, 262144
  s_mov_b32 s38, s37
  s_add_u32 s37, s37, 49152
  s_cmp_eq_u32 s37, 147456
  s_cselect_b32 s37, 0, s37
  s_sub_u32 s42, s37, s38
  v_add_u32 v232, s42, v232
  v_add_u32 v233, s42, v233
  v_add_u32 v234, s42, v234
  v_add_u32 v235, s42, v235
  v_add_u32 v254, s42, v254
  ds_read_b64_tr_b16 v[208:209], v232 offset:0
  ds_read_b64_tr_b16 v[210:211], v232 offset:6144
  ds_read_b64_tr_b16 v[212:213], v233 offset:0
  ds_read_b64_tr_b16 v[214:215], v233 offset:6144
  ds_read_b64_tr_b16 v[216:217], v234 offset:0
  ds_read_b64_tr_b16 v[218:219], v234 offset:6144
  ds_read_b64_tr_b16 v[220:221], v235 offset:0
  ds_read_b64_tr_b16 v[222:223], v235 offset:6144
  ds_read_b64_tr_b16 v[224:225], v232 offset:128
  ds_read_b64_tr_b16 v[226:227], v232 offset:6272
  s_waitcnt vmcnt(0)
  s_barrier
  s_cmp_eq_u32 s65, 0
  s_cbranch_scc1 L_skipB_A9
  s_waitcnt lgkmcnt(8)
  v_mfma_f32_16x16x32_bf16 v[0:3], v[208:211], v[96:99], v[0:3]
  ds_read_b64_tr_b16 v[228:229], v233 offset:128
  v_mfma_f32_16x16x32_bf16 v[4:7], v[208:211], v[100:103], v[4:7]
  ds_read_b64_tr_b16 v[230:231], v233 offset:6272
  s_waitcnt lgkmcnt(8)
  v_mfma_f32_16x16x32_bf16 v[8:11], v[212:215], v[96:99], v[8:11]
  ds_read_b64_tr_b16 v[208:209], v234 offset:128
  v_mfma_f32_16x16x32_bf16 v[12:15], v[212:215], v[100:103], v[12:15]
  ds_read_b64_tr_b16 v[210:211], v234 offset:6272
  s_waitcnt lgkmcnt(8)
  v_mfma_f32_16x16x32_bf16 v[16:19], v[216:219], v[96:99], v[16:19]
  ds_read_b64_tr_b16 v[212:213], v235 offset:128
  v_mfma_f32_16x16x32_bf16 v[20:23], v[216:219], v[100:103], v[20:23]
  ds_read_b64_tr_b16 v[214:215], v235 offset:6272
  s_waitcnt lgkmcnt(8)
  v_mfma_f32_16x16x32_bf16 v[24:27], v[220:223], v[96:99], v[24:27]
  ds_read_b64_tr_b16 v[216:217], v232 offset:256
  v_mfma_f32_16x16x32_bf16 v[28:31], v[220:223], v[100:103], v[28:31]
  ds_read_b64_tr_b16 v[218:219], v232 offset:6400
  s_waitcnt lgkmcnt(8)
  v_mfma_f32_16x16x32_bf16 v[32:35], v[224:227], v[96:99], v[32:35]
  ds_read_b64_tr_b16 v[220:221], v233 offset:256
  v_mfma_f32_16x16x32_bf16 v[36:39], v[224:227], v[100:103], v[36:39]
  ds_read_b64_tr_b16 v[222:223], v233 offset:6400
  s_waitcnt lgkmcnt(8)
  v_mfma_f32_16x16x32_bf16 v[40:43], v[228:231], v[96:99], v[40:43]
  ds_read_b64_tr_b16 v[224:225], v234 offset:256
  v_mfma_f32_16x16x32_bf16 v[44:47], v[228:231], v[100:103], v[44:47]
  ds_read_b64_tr_b16 v[226:227], v234 offset:6400
  s_waitcnt lgkmcnt(8)
  v_mfma_f32_16x16x32_bf16 v[48:51], v[208:211], v[96:99], v[48:51]
  ds_read_b64_tr_b16 v[228:229], v235 offset:256
  v_mfma_f32_16x16x32_bf16 v[52:55], v[208:211], v[100:103], v[52:55]
  ds_read_b64_tr_b16 v[230:231], v235 offset:6400
  s_waitcnt lgkmcnt(8)
  v_mfma_f32_16x16x32_bf16 v[56:59], v[212:215], v[96:99], v[56:59]
  ds_read_b64_tr_b16 v[208:209], v232 offset:12288
  v_mfma_f32_16x16x32_bf16 v[60:63], v[212:215], v[100:103], v[60:63]
  ds_read_b64_tr_b16 v[210:211], v232 offset:18432
  s_waitcnt lgkmcnt(8)
  v_mfma_f32_16x16x32_bf16 v[64:67], v[216:219], v[96:99], v[64:67]
  ds_read_b64_tr_b16 v[212:213], v233 offset:12288
  v_mfma_f32_16x16x32_bf16 v[68:71], v[216:219], v[100:103], v[68:71]
  ds_read_b64_tr_b16 v[214:215], v233 offset:18432
  s_waitcnt lgkmcnt(8)
  v_mfma_f32_16x16x32_bf16 v[72:75], v[220:223], v[96:99], v[72:75]
  ds_read_b64_tr_b16 v[216:217], v234 offset:12288
  v_mfma_f32_16x16x32_bf16 v[76:79], v[220:223], v[100:103], v[76:79]
  ds_read_b64_tr_b16 v[218:219], v234 offset:18432
  s_waitcnt lgkmcnt(8)
  v_mfma_f32_16x16x32_bf16 v[80:83], v[224:227], v[96:99], v[80:83]
  ds_read_b64_tr_b16 v[220:221], v235 offset:12288
  v_mfma_f32_16x16x32_bf16 v[84:87], v[224:227], v[100:103], v[84:87]
  ds_read_b64_tr_b16 v[222:223], v235 offset:18432
  s_waitcnt lgkmcnt(8)
  v_mfma_f32_16x16x32_bf16 v[88:91], v[228:231], v[96:99], v[88:91]
  ds_read_b64_tr_b16 v[224:225], v232 offset:12416
  v_mfma_f32_16x16x32_bf16 v[92:95], v[228:231], v[100:103], v[92:95]
  ds_read_b64_tr_b16 v[226:227], v232 offset:18560
  s_waitcnt lgkmcnt(8)
  v_mfma_f32_16x16x32_bf16 v[0:3], v[208:211], v[104:107], v[0:3]
  ds_read_b64_tr_b16 v[228:229], v233 offset:12416
  v_mfma_f32_16x16x32_bf16 v[4:7], v[208:211], v[108:111], v[4:7]
  ds_read_b64_tr_b16 v[230:231], v233 offset:18560
  s_waitcnt lgkmcnt(8)
  v_mfma_f32_16x16x32_bf16 v[8:11], v[212:215], v[104:107], v[8:11]
  ds_read_b64_tr_b16 v[208:209], v234 offset:12416
  v_mfma_f32_16x16x32_bf16 v[12:15], v[212:215], v[108:111], v[12:15]
  ds_read_b64_tr_b16 v[210:211], v234 offset:18560
  s_waitcnt lgkmcnt(8)
  v_mfma_f32_16x16x32_bf16 v[16:19], v[216:219], v[104:107], v[16:19]
  ds_read_b64_tr_b16 v[212:213], v235 offset:12416
  v_mfma_f32_16x16x32_bf16 v[20:23], v[216:219], v[108:111], v[20:23]
  ds_read_b64_tr_b16 v[214:215], v235 offset:18560
  s_waitcnt lgkmcnt(8)
  v_mfma_f32_16x16x32_bf16 v[24:27], v[220:223], v[104:107], v[24:27]
  ds_read_b64_tr_b16 v[216:217], v232 offset:12544
  v_mfma_f32_16x16x32_bf16 v[28:31], v[220:223], v[108:111], v[28:31]
  ds_read_b64_tr_b16 v[218:219], v232 offset:18688
  s_waitcnt lgkmcnt(8)
  v_mfma_f32_16x16x32_bf16 v[32:35], v[224:227], v[104:107], v[32:35]
  ds_read_b64_tr_b16 v[220:221], v233 offset:12544
  v_mfma_f32_16x16x32_bf16 v[36:39], v[224:227], v[108:111], v[36:39]
  ds_read_b64_tr_b16 v[222:223], v233 offset:18688
  s_waitcnt lgkmcnt(8)
  v_mfma_f32_16x16x32_bf16 v[40:43], v[228:231], v[104:107], v[40:43]
  ds_read_b64_tr_b16 v[224:225], v234 offset:12544
  v_mfma_f32_16x16x32_bf16 v[44:47], v[228:231], v[108:111], v[44:47]
  ds_read_b64_tr_b16 v[226:227], v234 offset:18688
  s_waitcnt lgkmcnt(8)
  v_mfma_f32_16x16x32_bf16 v[48:51], v[208:211], v[104:107], v[48:51]
  ds_read_b64_tr_b16 v[228:229], v235 offset:12544
  v_mfma_f32_16x16x32_bf16 v[52:55], v[208:211], v[108:111], v[52:55]
  ds_read_b64_tr_b16 v[230:231], v235 offset:18688
  s_waitcnt lgkmcnt(8)
  v_mfma_f32_16x16x32_bf16 v[56:59], v[212:215], v[104:107], v[56:59]
  ds_read_b64_tr_b16 v[208:209], v254 offset:0
  v_mfma_f32_16x16x32_bf16 v[60:63], v[212:215], v[108:111], v[60:63]
  ds_read_b64_tr_b16 v[210:211], v254 offset:1024
  s_waitcnt lgkmcnt(8)
  v_mfma_f32_16x16x32_bf16 v[64:67], v[216:219], v[104:107], v[64:67]
  ds_read_b64_tr_b16 v[212:213], v254 offset:32
  v_mfma_f32_16x16x32_bf16 v[68:71], v[216:219], v[108:111], v[68:71]
  ds_read_b64_tr_b16 v[214:215], v254 offset:1056
  s_waitcnt lgkmcnt(8)
  v_mfma_f32_16x16x32_bf16 v[72:75], v[220:223], v[104:107], v[72:75]
  ds_read_b64_tr_b16 v[216:217], v254 offset:2048
  v_mfma_f32_16x16x32_bf16 v[76:79], v[220:223], v[108:111], v[76:79]
  ds_read_b64_tr_b16 v[218:219], v254 offset:3072
  s_waitcnt lgkmcnt(8)
  v_mfma_f32_16x16x32_bf16 v[80:83], v[224:227], v[104:107], v[80:83]
  ds_read_b64_tr_b16 v[220:221], v254 offset:2080
  v_mfma_f32_16x16x32_bf16 v[84:87], v[224:227], v[108:111], v[84:87]
  ds_read_b64_tr_b16 v[222:223], v254 offset:3104
  s_waitcnt lgkmcnt(8)
  v_mfma_f32_16x16x32_bf16 v[88:91], v[228:231], v[104:107], v[88:91]
  ds_read_b64_tr_b16 v[224:225], v254 offset:4096
  v_mfma_f32_16x16x32_bf16 v[92:95], v[228:231], v[108:111], v[92:95]
  ds_read_b64_tr_b16 v[226:227], v254 offset:5120
  s_waitcnt lgkmcnt(8)
  v_mfma_f32_16x16x32_bf16 v[144:147], v[208:211], v[96:99], v[144:147]
  ds_read_b64_tr_b16 v[228:229], v254 offset:4128
  v_mfma_f32_16x16x32_bf16 v[148:151], v[208:211], v[100:103], v[148:151]
  ds_read_b64_tr_b16 v[230:231], v254 offset:5152
  s_waitcnt lgkmcnt(8)
  v_mfma_f32_16x16x32_bf16 v[152:155], v[212:215], v[96:99], v[152:155]
  ds_read_b64_tr_b16 v[208:209], v254 offset:6144
  v_mfma_f32_16x16x32_bf16 v[156:159], v[212:215], v[100:103], v[156:159]
  ds_read_b64_tr_b16 v[210:211], v254 offset:7168
  s_waitcnt lgkmcnt(8)
  v_mfma_f32_16x16x32_bf16 v[144:147], v[216:219], v[104:107], v[144:147]
  ds_read_b64_tr_b16 v[212:213], v254 offset:6176
  v_mfma_f32_16x16x32_bf16 v[148:151], v[216:219], v[108:111], v[148:151]
  ds_read_b64_tr_b16 v[214:215], v254 offset:7200
  s_waitcnt lgkmcnt(8)
  v_mfma_f32_16x16x32_bf16 v[152:155], v[220:223], v[104:107], v[152:155]
  v_mfma_f32_16x16x32_bf16 v[156:159], v[220:223], v[108:111], v[156:159]
  s_waitcnt lgkmcnt(6)
  v_mfma_f32_16x16x32_bf16 v[160:163], v[224:227], v[96:99], v[160:163]
  v_mfma_f32_16x16x32_bf16 v[164:167], v[224:227], v[100:103], v[164:167]
  s_waitcnt lgkmcnt(4)
  v_mfma_f32_16x16x32_bf16 v[168:171], v[228:231], v[96:99], v[168:171]
  v_mfma_f32_16x16x32_bf16 v[172:175], v[228:231], v[100:103], v[172:175]
  s_waitcnt lgkmcnt(2)
  v_mfma_f32_16x16x32_bf16 v[160:163], v[208:211], v[104:107], v[160:163]
  v_mfma_f32_16x16x32_bf16 v[164:167], v[208:211], v[108:111], v[164:167]
  s_waitcnt lgkmcnt(0)
  v_mfma_f32_16x16x32_bf16 v[168:171], v[212:215], v[104:107], v[168:171]
  v_mfma_f32_16x16x32_bf16 v[172:175], v[212:215], v[108:111], v[172:175]
  s_branch L_skipE_A9
L_skipB_A9:
  s_waitcnt lgkmcnt(8)
  v_mfma_f32_16x16x32_bf16 v[0:3], v[208:211], v[96:99], v[0:3]
  ds_read_b64_tr_b16 v[228:229], v233 offset:128
  v_mfma_f32_16x16x32_bf16 v[4:7], v[208:211], v[100:103], v[4:7]
  ds_read_b64_tr_b16 v[230:231], v233 offset:6272
  s_waitcnt lgkmcnt(8)
  v_mfma_f32_16x16x32_bf16 v[8:11], v[212:215], v[96:99], v[8:11]
  ds_read_b64_tr_b16 v[208:209], v234 offset:128
  v_mfma_f32_16x16x32_bf16 v[12:15], v[212:215], v[100:103], v[12:15]
  ds_read_b64_tr_b16 v[210:211], v234 offset:6272
  s_waitcnt lgkmcnt(8)
  v_mfma_f32_16x16x32_bf16 v[16:19], v[216:219], v[96:99], v[16:19]
  ds_read_b64_tr_b16 v[212:213], v235 offset:128
  v_mfma_f32_16x16x32_bf16 v[20:23], v[216:219], v[100:103], v[20:23]
  ds_read_b64_tr_b16 v[214:215], v235 offset:6272
  s_waitcnt lgkmcnt(8)
  v_mfma_f32_16x16x32_bf16 v[24:27], v[220:223], v[96:99], v[24:27]
  ds_read_b64_tr_b16 v[216:217], v232 offset:256
  v_mfma_f32_16x16x32_bf16 v[28:31], v[220:223], v[100:103], v[28:31]
  ds_read_b64_tr_b16 v[218:219], v232 offset:6400
  s_waitcnt lgkmcnt(8)
  v_mfma_f32_16x16x32_bf16 v[32:35], v[224:227], v[96:99], v[32:35]
  ds_read_b64_tr_b16 v[220:221], v233 offset:256
  v_mfma_f32_16x16x32_bf16 v[36:39], v[224:227], v[100:103], v[36:39]
  ds_read_b64_tr_b16 v[222:223], v233 offset:6400
  s_waitcnt lgkmcnt(8)
  v_mfma_f32_16x16x32_bf16 v[40:43], v[228:231], v[96:99], v[40:43]
  ds_read_b64_tr_b16 v[224:225], v234 offset:256
  v_mfma_f32_16x16x32_bf16 v[44:47], v[228:231], v[100:103], v[44:47]
  ds_read_b64_tr_b16 v[226:227], v234 offset:6400
  s_waitcnt lgkmcnt(8)
  v_mfma_f32_16x16x32_bf16 v[48:51], v[208:211], v[96:99], v[48:51]
  ds_read_b64_tr_b16 v[228:229], v235 offset:256
  v_mfma_f32_16x16x32_bf16 v[52:55], v[208:211], v[100:103], v[52:55]
  ds_read_b64_tr_b16 v[230:231], v235 offset:6400
  s_waitcnt lgkmcnt(8)
  v_mfma_f32_16x16x32_bf16 v[56:59], v[212:215], v[96:99], v[56:59]
  ds_read_b64_tr_b16 v[208:209], v232 offset:12288
  v_mfma_f32_16x16x32_bf16 v[60:63], v[212:215], v[100:103], v[60:63]
  ds_read_b64_tr_b16 v[210:211], v232 offset:18432
  s_waitcnt lgkmcnt(8)
  v_mfma_f32_16x16x32_bf16 v[64:67], v[216:219], v[96:99], v[64:67]
  ds_read_b64_tr_b16 v[212:213], v233 offset:12288
  v_mfma_f32_16x16x32_bf16 v[68:71], v[216:219], v[100:103], v[68:71]
  ds_read_b64_tr_b16 v[214:215], v233 offset:18432
  s_waitcnt lgkmcnt(8)
  v_mfma_f32_16x16x32_bf16 v[72:75], v[220:223], v[96:99], v[72:75]
  ds_read_b64_tr_b16 v[216:217], v234 offset:12288
  v_mfma_f32_16x16x32_bf16 v[76:79], v[220:223], v[100:103], v[76:79]
  ds_read_b64_tr_b16 v[218:219], v234 offset:18432
  s_waitcnt lgkmcnt(8)
  v_mfma_f32_16x16x32_bf16 v[80:83], v[224:227], v[96:99], v[80:83]
  ds_read_b64_tr_b16 v[220:221], v235 offset:12288
  v_mfma_f32_16x16x32_bf16 v[84:87], v[224:227], v[100:103], v[84:87]
  ds_read_b64_tr_b16 v[222:223], v235 offset:18432
  s_waitcnt lgkmcnt(8)
  v_mfma_f32_16x16x32_bf16 v[88:91], v[228:231], v[96:99], v[88:91]
  ds_read_b64_tr_b16 v[224:225], v232 offset:12416
  v_mfma_f32_16x16x32_bf16 v[92:95], v[228:231], v[100:103], v[92:95]
  ds_read_b64_tr_b16 v[226:227], v232 offset:18560
  s_waitcnt lgkmcnt(8)
  v_mfma_f32_16x16x32_bf16 v[0:3], v[208:211], v[104:107], v[0:3]
  ds_read_b64_tr_b16 v[228:229], v233 offset:12416
  v_mfma_f32_16x16x32_bf16 v[4:7], v[208:211], v[108:111], v[4:7]
  ds_read_b64_tr_b16 v[230:231], v233 offset:18560
  s_waitcnt lgkmcnt(8)
  v_mfma_f32_16x16x32_bf16 v[8:11], v[212:215], v[104:107], v[8:11]
  ds_read_b64_tr_b16 v[208:209], v234 offset:12416
  v_mfma_f32_16x16x32_bf16 v[12:15], v[212:215], v[108:111], v[12:15]
  ds_read_b64_tr_b16 v[210:211], v234 offset:18560
  s_waitcnt lgkmcnt(8)
  v_mfma_f32_16x16x32_bf16 v[16:19], v[216:219], v[104:107], v[16:19]
  ds_read_b64_tr_b16 v[212:213], v235 offset:12416
  v_mfma_f32_16x16x32_bf16 v[20:23], v[216:219], v[108:111], v[20:23]
  ds_read_b64_tr_b16 v[214:215], v235 offset:18560
  s_waitcnt lgkmcnt(8)
  v_mfma_f32_16x16x32_bf16 v[24:27], v[220:223], v[104:107], v[24:27]
  ds_read_b64_tr_b16 v[216:217], v232 offset:12544
  v_mfma_f32_16x16x32_bf16 v[28:31], v[220:223], v[108:111], v[28:31]
  ds_read_b64_tr_b16 v[218:219], v232 offset:18688
  s_waitcnt lgkmcnt(8)
  v_mfma_f32_16x16x32_bf16 v[32:35], v[224:227], v[104:107], v[32:35]
  ds_read_b64_tr_b16 v[220:221], v233 offset:12544
  v_mfma_f32_16x16x32_bf16 v[36:39], v[224:227], v[108:111], v[36:39]
  ds_read_b64_tr_b16 v[222:223], v233 offset:18688
  s_waitcnt lgkmcnt(8)
  v_mfma_f32_16x16x32_bf16 v[40:43], v[228:231], v[104:107], v[40:43]
  ds_read_b64_tr_b16 v[224:225], v234 offset:12544
  v_mfma_f32_16x16x32_bf16 v[44:47], v[228:231], v[108:111], v[44:47]
  ds_read_b64_tr_b16 v[226:227], v234 offset:18688
  s_waitcnt lgkmcnt(8)
  v_mfma_f32_16x16x32_bf16 v[48:51], v[208:211], v[104:107], v[48:51]
  ds_read_b64_tr_b16 v[228:229], v235 offset:12544
  v_mfma_f32_16x16x32_bf16 v[52:55], v[208:211], v[108:111], v[52:55]
  ds_read_b64_tr_b16 v[230:231], v235 offset:18688
  s_waitcnt lgkmcnt(8)
  v_mfma_f32_16x16x32_bf16 v[56:59], v[212:215], v[104:107], v[56:59]
  ds_read_b64_tr_b16 v[208:209], v254 offset:0
  v_mfma_f32_16x16x32_bf16 v[60:63], v[212:215], v[108:111], v[60:63]
  ds_read_b64_tr_b16 v[210:211], v254 offset:1024
  s_waitcnt lgkmcnt(8)
  v_mfma_f32_16x16x32_bf16 v[64:67], v[216:219], v[104:107], v[64:67]
  ds_read_b64_tr_b16 v[212:213], v254 offset:32
  v_mfma_f32_16x16x32_bf16 v[68:71], v[216:219], v[108:111], v[68:71]
  ds_read_b64_tr_b16 v[214:215], v254 offset:1056
  s_waitcnt lgkmcnt(8)
  v_mfma_f32_16x16x32_bf16 v[72:75], v[220:223], v[104:107], v[72:75]
  ds_read_b64_tr_b16 v[216:217], v254 offset:2048
  v_mfma_f32_16x16x32_bf16 v[76:79], v[220:223], v[108:111], v[76:79]
  ds_read_b64_tr_b16 v[218:219], v254 offset:3072
  s_waitcnt lgkmcnt(8)
  v_mfma_f32_16x16x32_bf16 v[80:83], v[224:227], v[104:107], v[80:83]
  ds_read_b64_tr_b16 v[220:221], v254 offset:2080
  v_mfma_f32_16x16x32_bf16 v[84:87], v[224:227], v[108:111], v[84:87]
  ds_read_b64_tr_b16 v[222:223], v254 offset:3104
  s_waitcnt lgkmcnt(8)
  v_mfma_f32_16x16x32_bf16 v[88:91], v[228:231], v[104:107], v[88:91]
  v_mfma_f32_16x16x32_bf16 v[92:95], v[228:231], v[108:111], v[92:95]
  s_waitcnt lgkmcnt(6)
  v_mfma_f32_16x16x32_bf16 v[144:147], v[208:211], v[96:99], v[144:147]
  v_mfma_f32_16x16x32_bf16 v[148:151], v[208:211], v[100:103], v[148:151]
  s_waitcnt lgkmcnt(4)
  v_mfma_f32_16x16x32_bf16 v[152:155], v[212:215], v[96:99], v[152:155]
  v_mfma_f32_16x16x32_bf16 v[156:159], v[212:215], v[100:103], v[156:159]
  s_waitcnt lgkmcnt(2)
  v_mfma_f32_16x16x32_bf16 v[144:147], v[216:219], v[104:107], v[144:147]
  v_mfma_f32_16x16x32_bf16 v[148:151], v[216:219], v[108:111], v[148:151]
  s_waitcnt lgkmcnt(0)
  v_mfma_f32_16x16x32_bf16 v[152:155], v[220:223], v[104:107], v[152:155]
  v_mfma_f32_16x16x32_bf16 v[156:159], v[220:223], v[108:111], v[156:159]
L_skipE_A9:
  s_add_u32 s43, s68, s38
  s_mov_b32 s40, 24576
  s_add_u32 m0, s43, 0
  s_nop 0
  buffer_load_dwordx4 v240, s[4:7], s40 offen lds
  s_add_u32 m0, s43, 1024
  s_nop 0
  buffer_load_dwordx4 v241, s[4:7], s40 offen lds
  s_add_u32 m0, s43, 2048
  s_nop 0
  buffer_load_dwordx4 v242, s[4:7], s40 offen lds
  s_add_u32 s69, s40, 12288
  s_add_u32 m0, s43, 12288
  s_nop 0
  buffer_load_dwordx4 v240, s[4:7], s69 offen lds
  s_add_u32 m0, s43, 13312
  s_nop 0
  buffer_load_dwordx4 v241, s[4:7], s69 offen lds
  s_add_u32 m0, s43, 14336
  s_nop 0
  buffer_load_dwordx4 v242, s[4:7], s69 offen lds
  s_mov_b32 s38, s37
  s_add_u32 s37, s37, 49152
  s_cmp_eq_u32 s37, 147456
  s_cselect_b32 s37, 0, s37
  s_sub_u32 s42, s37, s38
  s_barrier
  s_branch L_conv
L_grpB0:
L_proB_loop:
  s_add_u32 s43, s68, s38
  s_add_u32 s41, s95, 393216
  s_add_u32 m0, s43, 24576
  s_nop 0
  buffer_load_dwordx4 v243, s[12:15], s95 offen lds
  s_add_u32 m0, s43, 25600
  s_nop 0
  buffer_load_dwordx4 v244, s[12:15], s95 offen lds
  s_add_u32 m0, s43, 26624
  s_nop 0
  buffer_load_dwordx4 v245, s[12:15], s95 offen lds
  s_add_u32 m0, s43, 36864
  s_nop 0
  buffer_load_dwordx4 v243, s[12:15], s41 offen lds
  s_add_u32 m0, s43, 37888
  s_nop 0
  buffer_load_dwordx4 v244, s[12:15], s41 offen lds
  s_add_u32 m0, s43, 38912
  s_nop 0
  buffer_load_dwordx4 v245, s[12:15], s41 offen lds
  s_add_u32 s43, s44, s38
  s_add_u32 s40, s54, s96
  s_add_u32 m0, s43, 0
  s_nop 0
  buffer_load_dwordx4 v246, s[24:27], s40 offen lds
  s_add_u32 s40, s55, s96
  s_add_u32 m0, s43, 4096
  s_nop 0
  buffer_load_dwordx4 v246, s[24:27], s40 offen lds
  s_add_u32 s95, s95, 786432
  s_add_u32 s96, s96, 196608
  s_add_u32 s42, s94, 0
  buffer_load_dwordx4 v[96:99], v251, s[16:19], s42 offen offset:0
  buffer_load_dwordx4 v[100:103], v251, s[16:19], s42 offen offset:1024
  s_add_u32 s42, s94, 131072
  buffer_load_dwordx4 v[104:107], v251, s[16:19], s42 offen offset:0
  buffer_load_dwordx4 v[108:111], v251, s[16:19], s42 offen offset:1024
  s_add_u32 s94, s94, 262144
  s_cmp_eq_u32 s65, 0
  s_cbranch_scc1 L_skipB_B0
  ds_read_b64_tr_b16 v[208:209], v232 offset:0
  ds_read_b64_tr_b16 v[210:211], v232 offset:6144
  ds_read_b64_tr_b16 v[212:213], v233 offset:0
  ds_read_b64_tr_b16 v[214:215], v233 offset:6144
  ds_read_b64_tr_b16 v[216:217], v234 offset:0
  ds_read_b64_tr_b16 v[218:219], v234 offset:6144
  ds_read_b64_tr_b16 v[220:221], v235 offset:0
  ds_read_b64_tr_b16 v[222:223], v235 offset:6144
  ds_read_b64_tr_b16 v[224:225], v232 offset:128
  ds_read_b64_tr_b16 v[226:227], v232 offset:6272
  s_waitcnt lgkmcnt(8)
  v_mfma_f32_16x16x32_bf16 v[0:3], v[208:211], v[192:195], v[0:3]
  ds_read_b64_tr_b16 v[228:229], v233 offset:128
  v_mfma_f32_16x16x32_bf16 v[4:7], v[208:211], v[196:199], v[4:7]
  ds_read_b64_tr_b16 v[230:231], v233 offset:6272
  s_waitcnt lgkmcnt(8)
  v_mfma_f32_16x16x32_bf16 v[8:11], v[212:215], v[192:195], v[8:11]
  ds_read_b64_tr_b16 v[208:209], v234 offset:128
  v_mfma_f32_16x16x32_bf16 v[12:15], v[212:215], v[196:199], v[12:15]
  ds_read_b64_tr_b16 v[210:211], v234 offset:6272
  s_waitcnt lgkmcnt(8)
  v_mfma_f32_16x16x32_bf16 v[16:19], v[216:219], v[192:195], v[16:19]
  ds_read_b64_tr_b16 v[212:213], v235 offset:128
  v_mfma_f32_16x16x32_bf16 v[20:23], v[216:219], v[196:199], v[20:23]
  ds_read_b64_tr_b16 v[214:215], v235 offset:6272
  s_waitcnt lgkmcnt(8)
  v_mfma_f32_16x16x32_bf16 v[24:27], v[220:223], v[192:195], v[24:27]
  ds_read_b64_tr_b16 v[216:217], v232 offset:256
  v_mfma_f32_16x16x32_bf16 v[28:31], v[220:223], v[196:199], v[28:31]
  ds_read_b64_tr_b16 v[218:219], v232 offset:6400
  s_waitcnt lgkmcnt(8)
  v_mfma_f32_16x16x32_bf16 v[32:35], v[224:227], v[192:195], v[32:35]
  ds_read_b64_tr_b16 v[220:221], v233 offset:256
  v_mfma_f32_16x16x32_bf16 v[36:39], v[224:227], v[196:199], v[36:39]
  ds_read_b64_tr_b16 v[222:223], v233 offset:6400
  s_waitcnt lgkmcnt(8)
  v_mfma_f32_16x16x32_bf16 v[40:43], v[228:231], v[192:195], v[40:43]
  ds_read_b64_tr_b16 v[224:225], v234 offset:256
  v_mfma_f32_16x16x32_bf16 v[44:47], v[228:231], v[196:199], v[44:47]
  ds_read_b64_tr_b16 v[226:227], v234 offset:6400
  s_waitcnt lgkmcnt(8)
  v_mfma_f32_16x16x32_bf16 v[48:51], v[208:211], v[192:195], v[48:51]
  ds_read_b64_tr_b16 v[228:229], v235 offset:256
  v_mfma_f32_16x16x32_bf16 v[52:55], v[208:211], v[196:199], v[52:55]
  ds_read_b64_tr_b16 v[230:231], v235 offset:6400
  s_waitcnt lgkmcnt(8)
  v_mfma_f32_16x16x32_bf16 v[56:59], v[212:215], v[192:195], v[56:59]
  ds_read_b64_tr_b16 v[208:209], v232 offset:12288
  v_mfma_f32_16x16x32_bf16 v[60:63], v[212:215], v[196:199], v[60:63]
  ds_read_b64_tr_b16 v[210:211], v232 offset:18432
  s_waitcnt lgkmcnt(8)
  v_mfma_f32_16x16x32_bf16 v[64:67], v[216:219], v[192:195], v[64:67]
  ds_read_b64_tr_b16 v[212:213], v233 offset:12288
  v_mfma_f32_16x16x32_bf16 v[68:71], v[216:219], v[196:199], v[68:71]
  ds_read_b64_tr_b16 v[214:215], v233 offset:18432
  s_waitcnt lgkmcnt(8)
  v_mfma_f32_16x16x32_bf16 v[72:75], v[220:223], v[192:195], v[72:75]
  ds_read_b64_tr_b16 v[216:217], v234 offset:12288
  v_mfma_f32_16x16x32_bf16 v[76:79], v[220:223], v[196:199], v[76:79]
  ds_read_b64_tr_b16 v[218:219], v234 offset:18432
  s_waitcnt lgkmcnt(8)
  v_mfma_f32_16x16x32_bf16 v[80:83], v[224:227], v[192:195], v[80:83]
  ds_read_b64_tr_b16 v[220:221], v235 offset:12288
  v_mfma_f32_16x16x32_bf16 v[84:87], v[224:227], v[196:199], v[84:87]
  ds_read_b64_tr_b16 v[222:223], v235 offset:18432
  s_waitcnt lgkmcnt(8)
  v_mfma_f32_16x16x32_bf16 v[88:91], v[228:231], v[192:195], v[88:91]
  ds_read_b64_tr_b16 v[224:225], v232 offset:12416
  v_mfma_f32_16x16x32_bf16 v[92:95], v[228:231], v[196:199], v[92:95]
  ds_read_b64_tr_b16 v[226:227], v232 offset:18560
  s_waitcnt lgkmcnt(8)
  v_mfma_f32_16x16x32_bf16 v[0:3], v[208:211], v[200:203], v[0:3]
  ds_read_b64_tr_b16 v[228:229], v233 offset:12416
  v_mfma_f32_16x16x32_bf16 v[4:7], v[208:211], v[204:207], v[4:7]
  ds_read_b64_tr_b16 v[230:231], v233 offset:18560
  s_waitcnt lgkmcnt(8)
  v_mfma_f32_16x16x32_bf16 v[8:11], v[212:215], v[200:203], v[8:11]
  ds_read_b64_tr_b16 v[208:209], v234 offset:12416
  v_mfma_f32_16x16x32_bf16 v[12:15], v[212:215], v[204:207], v[12:15]
  ds_read_b64_tr_b16 v[210:211], v234 offset:18560
  s_waitcnt lgkmcnt(8)
  v_mfma_f32_16x16x32_bf16 v[16:19], v[216:219], v[200:203], v[16:19]
  ds_read_b64_tr_b16 v[212:213], v235 offset:12416
  v_mfma_f32_16x16x32_bf16 v[20:23], v[216:219], v[204:207], v[20:23]
  ds_read_b64_tr_b16 v[214:215], v235 offset:18560
  s_waitcnt lgkmcnt(8)
  v_mfma_f32_16x16x32_bf16 v[24:27], v[220:223], v[200:203], v[24:27]
  ds_read_b64_tr_b16 v[216:217], v232 offset:12544
  v_mfma_f32_16x16x32_bf16 v[28:31], v[220:223], v[204:207], v[28:31]
  ds_read_b64_tr_b16 v[218:219], v232 offset:18688
  s_waitcnt lgkmcnt(8)
  v_mfma_f32_16x16x32_bf16 v[32:35], v[224:227], v[200:203], v[32:35]
  ds_read_b64_tr_b16 v[220:221], v233 offset:12544
  v_mfma_f32_16x16x32_bf16 v[36:39], v[224:227], v[204:207], v[36:39]
  ds_read_b64_tr_b16 v[222:223], v233 offset:18688
  s_waitcnt lgkmcnt(8)
  v_mfma_f32_16x16x32_bf16 v[40:43], v[228:231], v[200:203], v[40:43]
  ds_read_b64_tr_b16 v[224:225], v234 offset:12544
  v_mfma_f32_16x16x32_bf16 v[44:47], v[228:231], v[204:207], v[44:47]
  ds_read_b64_tr_b16 v[226:227], v234 offset:18688
  s_waitcnt lgkmcnt(8)
  v_mfma_f32_16x16x32_bf16 v[48:51], v[208:211], v[200:203], v[48:51]
  ds_read_b64_tr_b16 v[228:229], v235 offset:12544
  v_mfma_f32_16x16x32_bf16 v[52:55], v[208:211], v[204:207], v[52:55]
  ds_read_b64_tr_b16 v[230:231], v235 offset:18688
  s_waitcnt lgkmcnt(8)
  v_mfma_f32_16x16x32_bf16 v[56:59], v[212:215], v[200:203], v[56:59]
  ds_read_b64_tr_b16 v[208:209], v254 offset:0
  v_mfma_f32_16x16x32_bf16 v[60:63], v[212:215], v[204:207], v[60:63]
  ds_read_b64_tr_b16 v[210:211], v254 offset:1024
  s_waitcnt lgkmcnt(8)
  v_mfma_f32_16x16x32_bf16 v[64:67], v[216:219], v[200:203], v[64:67]
  ds_read_b64_tr_b16 v[212:213], v254 offset:32
  v_mfma_f32_16x16x32_bf16 v[68:71], v[216:219], v[204:207], v[68:71]
  ds_read_b64_tr_b16 v[214:215], v254 offset:1056
  s_waitcnt lgkmcnt(8)
  v_mfma_f32_16x16x32_bf16 v[72:75], v[220:223], v[200:203], v[72:75]
  ds_read_b64_tr_b16 v[216:217], v254 offset:2048
  v_mfma_f32_16x16x32_bf16 v[76:79], v[220:223], v[204:207], v[76:79]
  ds_read_b64_tr_b16 v[218:219], v254 offset:3072
  s_waitcnt lgkmcnt(8)
  v_mfma_f32_16x16x32_bf16 v[80:83], v[224:227], v[200:203], v[80:83]
  ds_read_b64_tr_b16 v[220:221], v254 offset:2080
  v_mfma_f32_16x16x32_bf16 v[84:87], v[224:227], v[204:207], v[84:87]
  ds_read_b64_tr_b16 v[222:223], v254 offset:3104
  s_waitcnt lgkmcnt(8)
  v_mfma_f32_16x16x32_bf16 v[88:91], v[228:231], v[200:203], v[88:91]
  ds_read_b64_tr_b16 v[224:225], v254 offset:4096
  v_mfma_f32_16x16x32_bf16 v[92:95], v[228:231], v[204:207], v[92:95]
  ds_read_b64_tr_b16 v[226:227], v254 offset:5120
  s_waitcnt lgkmcnt(8)
  v_mfma_f32_16x16x32_bf16 v[144:147], v[208:211], v[192:195], v[144:147]
  ds_read_b64_tr_b16 v[228:229], v254 offset:4128
  v_mfma_f32_16x16x32_bf16 v[148:151], v[208:211], v[196:199], v[148:151]
  ds_read_b64_tr_b16 v[230:231], v254 offset:5152
  s_waitcnt lgkmcnt(8)
  v_mfma_f32_16x16x32_bf16 v[152:155], v[212:215], v[192:195], v[152:155]
  ds_read_b64_tr_b16 v[208:209], v254 offset:6144
  v_mfma_f32_16x16x32_bf16 v[156:159], v[212:215], v[196:199], v[156:159]
  ds_read_b64_tr_b16 v[210:211], v254 offset:7168
  s_waitcnt lgkmcnt(8)
  v_mfma_f32_16x16x32_bf16 v[144:147], v[216:219], v[200:203], v[144:147]
  ds_read_b64_tr_b16 v[212:213], v254 offset:6176
  v_mfma_f32_16x16x32_bf16 v[148:151], v[216:219], v[204:207], v[148:151]
  ds_read_b64_tr_b16 v[214:215], v254 offset:7200
  s_waitcnt lgkmcnt(8)
  v_mfma_f32_16x16x32_bf16 v[152:155], v[220:223], v[200:203], v[152:155]
  v_mfma_f32_16x16x32_bf16 v[156:159], v[220:223], v[204:207], v[156:159]
  s_waitcnt lgkmcnt(6)
  v_mfma_f32_16x16x32_bf16 v[160:163], v[224:227], v[192:195], v[160:163]
  v_mfma_f32_16x16x32_bf16 v[164:167], v[224:227], v[196:199], v[164:167]
  s_waitcnt lgkmcnt(4)
  v_mfma_f32_16x16x32_bf16 v[168:171], v[228:231], v[192:195], v[168:171]
  v_mfma_f32_16x16x32_bf16 v[172:175], v[228:231], v[196:199], v[172:175]
  s_waitcnt lgkmcnt(2)
  v_mfma_f32_16x16x32_bf16 v[160:163], v[208:211], v[200:203], v[160:163]
  v_mfma_f32_16x16x32_bf16 v[164:167], v[208:211], v[204:207], v[164:167]
  s_waitcnt lgkmcnt(0)
  v_mfma_f32_16x16x32_bf16 v[168:171], v[212:215], v[200:203], v[168:171]
  v_mfma_f32_16x16x32_bf16 v[172:175], v[212:215], v[204:207], v[172:175]
  s_branch L_skipE_B0
L_skipB_B0:
  ds_read_b64_tr_b16 v[208:209], v232 offset:0
  ds_read_b64_tr_b16 v[210:211], v232 offset:6144
  ds_read_b64_tr_b16 v[212:213], v233 offset:0
  ds_read_b64_tr_b16 v[214:215], v233 offset:6144
  ds_read_b64_tr_b16 v[216:217], v234 offset:0
  ds_read_b64_tr_b16 v[218:219], v234 offset:6144
  ds_read_b64_tr_b16 v[220:221], v235 offset:0
  ds_read_b64_tr_b16 v[222:223], v235 offset:6144
  ds_read_b64_tr_b16 v[224:225], v232 offset:128
  ds_read_b64_tr_b16 v[226:227], v232 offset:6272
  s_waitcnt lgkmcnt(8)
  v_mfma_f32_16x16x32_bf16 v[0:3], v[208:211], v[192:195], v[0:3]
  ds_read_b64_tr_b16 v[228:229], v233 offset:128
  v_mfma_f32_16x16x32_bf16 v[4:7], v[208:211], v[196:199], v[4:7]
  ds_read_b64_tr_b16 v[230:231], v233 offset:6272
  s_waitcnt lgkmcnt(8)
  v_mfma_f32_16x16x32_bf16 v[8:11], v[212:215], v[192:195], v[8:11]
  ds_read_b64_tr_b16 v[208:209], v234 offset:128
  v_mfma_f32_16x16x32_bf16 v[12:15], v[212:215], v[196:199], v[12:15]
  ds_read_b64_tr_b16 v[210:211], v234 offset:6272
  s_waitcnt lgkmcnt(8)
  v_mfma_f32_16x16x32_bf16 v[16:19], v[216:219], v[192:195], v[16:19]
  ds_read_b64_tr_b16 v[212:213], v235 offset:128
  v_mfma_f32_16x16x32_bf16 v[20:23], v[216:219], v[196:199], v[20:23]
  ds_read_b64_tr_b16 v[214:215], v235 offset:6272
  s_waitcnt lgkmcnt(8)
  v_mfma_f32_16x16x32_bf16 v[24:27], v[220:223], v[192:195], v[24:27]
  ds_read_b64_tr_b16 v[216:217], v232 offset:256
  v_mfma_f32_16x16x32_bf16 v[28:31], v[220:223], v[196:199], v[28:31]
  ds_read_b64_tr_b16 v[218:219], v232 offset:6400
  s_waitcnt lgkmcnt(8)
  v_mfma_f32_16x16x32_bf16 v[32:35], v[224:227], v[192:195], v[32:35]
  ds_read_b64_tr_b16 v[220:221], v233 offset:256
  v_mfma_f32_16x16x32_bf16 v[36:39], v[224:227], v[196:199], v[36:39]
  ds_read_b64_tr_b16 v[222:223], v233 offset:6400
  s_waitcnt lgkmcnt(8)
  v_mfma_f32_16x16x32_bf16 v[40:43], v[228:231], v[192:195], v[40:43]
  ds_read_b64_tr_b16 v[224:225], v234 offset:256
  v_mfma_f32_16x16x32_bf16 v[44:47], v[228:231], v[196:199], v[44:47]
  ds_read_b64_tr_b16 v[226:227], v234 offset:6400
  s_waitcnt lgkmcnt(8)
  v_mfma_f32_16x16x32_bf16 v[48:51], v[208:211], v[192:195], v[48:51]
  ds_read_b64_tr_b16 v[228:229], v235 offset:256
  v_mfma_f32_16x16x32_bf16 v[52:55], v[208:211], v[196:199], v[52:55]
  ds_read_b64_tr_b16 v[230:231], v235 offset:6400
  s_waitcnt lgkmcnt(8)
  v_mfma_f32_16x16x32_bf16 v[56:59], v[212:215], v[192:195], v[56:59]
  ds_read_b64_tr_b16 v[208:209], v232 offset:12288
  v_mfma_f32_16x16x32_bf16 v[60:63], v[212:215], v[196:199], v[60:63]
  ds_read_b64_tr_b16 v[210:211], v232 offset:18432
  s_waitcnt lgkmcnt(8)
  v_mfma_f32_16x16x32_bf16 v[64:67], v[216:219], v[192:195], v[64:67]
  ds_read_b64_tr_b16 v[212:213], v233 offset:12288
  v_mfma_f32_16x16x32_bf16 v[68:71], v[216:219], v[196:199], v[68:71]
  ds_read_b64_tr_b16 v[214:215], v233 offset:18432
  s_waitcnt lgkmcnt(8)
  v_mfma_f32_16x16x32_bf16 v[72:75], v[220:223], v[192:195], v[72:75]
  ds_read_b64_tr_b16 v[216:217], v234 offset:12288
  v_mfma_f32_16x16x32_bf16 v[76:79], v[220:223], v[196:199], v[76:79]
  ds_read_b64_tr_b16 v[218:219], v234 offset:18432
  s_waitcnt lgkmcnt(8)
  v_mfma_f32_16x16x32_bf16 v[80:83], v[224:227], v[192:195], v[80:83]
  ds_read_b64_tr_b16 v[220:221], v235 offset:12288
  v_mfma_f32_16x16x32_bf16 v[84:87], v[224:227], v[196:199], v[84:87]
  ds_read_b64_tr_b16 v[222:223], v235 offset:18432
  s_waitcnt lgkmcnt(8)
  v_mfma_f32_16x16x32_bf16 v[88:91], v[228:231], v[192:195], v[88:91]
  ds_read_b64_tr_b16 v[224:225], v232 offset:12416
  v_mfma_f32_16x16x32_bf16 v[92:95], v[228:231], v[196:199], v[92:95]
  ds_read_b64_tr_b16 v[226:227], v232 offset:18560
  s_waitcnt lgkmcnt(8)
  v_mfma_f32_16x16x32_bf16 v[0:3], v[208:211], v[200:203], v[0:3]
  ds_read_b64_tr_b16 v[228:229], v233 offset:12416
  v_mfma_f32_16x16x32_bf16 v[4:7], v[208:211], v[204:207], v[4:7]
  ds_read_b64_tr_b16 v[230:231], v233 offset:18560
  s_waitcnt lgkmcnt(8)
  v_mfma_f32_16x16x32_bf16 v[8:11], v[212:215], v[200:203], v[8:11]
  ds_read_b64_tr_b16 v[208:209], v234 offset:12416
  v_mfma_f32_16x16x32_bf16 v[12:15], v[212:215], v[204:207], v[12:15]
  ds_read_b64_tr_b16 v[210:211], v234 offset:18560
  s_waitcnt lgkmcnt(8)
  v_mfma_f32_16x16x32_bf16 v[16:19], v[216:219], v[200:203], v[16:19]
  ds_read_b64_tr_b16 v[212:213], v235 offset:12416
  v_mfma_f32_16x16x32_bf16 v[20:23], v[216:219], v[204:207], v[20:23]
  ds_read_b64_tr_b16 v[214:215], v235 offset:18560
  s_waitcnt lgkmcnt(8)
  v_mfma_f32_16x16x32_bf16 v[24:27], v[220:223], v[200:203], v[24:27]
  ds_read_b64_tr_b16 v[216:217], v232 offset:12544
  v_mfma_f32_16x16x32_bf16 v[28:31], v[220:223], v[204:207], v[28:31]
  ds_read_b64_tr_b16 v[218:219], v232 offset:18688
  s_waitcnt lgkmcnt(8)
  v_mfma_f32_16x16x32_bf16 v[32:35], v[224:227], v[200:203], v[32:35]
  ds_read_b64_tr_b16 v[220:221], v233 offset:12544
  v_mfma_f32_16x16x32_bf16 v[36:39], v[224:227], v[204:207], v[36:39]
  ds_read_b64_tr_b16 v[222:223], v233 offset:18688
  s_waitcnt lgkmcnt(8)
  v_mfma_f32_16x16x32_bf16 v[40:43], v[228:231], v[200:203], v[40:43]
  ds_read_b64_tr_b16 v[224:225], v234 offset:12544
  v_mfma_f32_16x16x32_bf16 v[44:47], v[228:231], v[204:207], v[44:47]
  ds_read_b64_tr_b16 v[226:227], v234 offset:18688
  s_waitcnt lgkmcnt(8)
  v_mfma_f32_16x16x32_bf16 v[48:51], v[208:211], v[200:203], v[48:51]
  ds_read_b64_tr_b16 v[228:229], v235 offset:12544
  v_mfma_f32_16x16x32_bf16 v[52:55], v[208:211], v[204:207], v[52:55]
  ds_read_b64_tr_b16 v[230:231], v235 offset:18688
  s_waitcnt lgkmcnt(8)
  v_mfma_f32_16x16x32_bf16 v[56:59], v[212:215], v[200:203], v[56:59]
  ds_read_b64_tr_b16 v[208:209], v254 offset:0
  v_mfma_f32_16x16x32_bf16 v[60:63], v[212:215], v[204:207], v[60:63]
  ds_read_b64_tr_b16 v[210:211], v254 offset:1024
  s_waitcnt lgkmcnt(8)
  v_mfma_f32_16x16x32_bf16 v[64:67], v[216:219], v[200:203], v[64:67]
  ds_read_b64_tr_b16 v[212:213], v254 offset:32
  v_mfma_f32_16x16x32_bf16 v[68:71], v[216:219], v[204:207], v[68:71]
  ds_read_b64_tr_b16 v[214:215], v254 offset:1056
  s_waitcnt lgkmcnt(8)
  v_mfma_f32_16x16x32_bf16 v[72:75], v[220:223], v[200:203], v[72:75]
  ds_read_b64_tr_b16 v[216:217], v254 offset:2048
  v_mfma_f32_16x16x32_bf16 v[76:79], v[220:223], v[204:207], v[76:79]
  ds_read_b64_tr_b16 v[218:219], v254 offset:3072
  s_waitcnt lgkmcnt(8)
  v_mfma_f32_16x16x32_bf16 v[80:83], v[224:227], v[200:203], v[80:83]
  ds_read_b64_tr_b16 v[220:221], v254 offset:2080
  v_mfma_f32_16x16x32_bf16 v[84:87], v[224:227], v[204:207], v[84:87]
  ds_read_b64_tr_b16 v[222:223], v254 offset:3104
  s_waitcnt lgkmcnt(8)
  v_mfma_f32_16x16x32_bf16 v[88:91], v[228:231], v[200:203], v[88:91]
  v_mfma_f32_16x16x32_bf16 v[92:95], v[228:231], v[204:207], v[92:95]
  s_waitcnt lgkmcnt(6)
  v_mfma_f32_16x16x32_bf16 v[144:147], v[208:211], v[192:195], v[144:147]
  v_mfma_f32_16x16x32_bf16 v[148:151], v[208:211], v[196:199], v[148:151]
  s_waitcnt lgkmcnt(4)
  v_mfma_f32_16x16x32_bf16 v[152:155], v[212:215], v[192:195], v[152:155]
  v_mfma_f32_16x16x32_bf16 v[156:159], v[212:215], v[196:199], v[156:159]
  s_waitcnt lgkmcnt(2)
  v_mfma_f32_16x16x32_bf16 v[144:147], v[216:219], v[200:203], v[144:147]
  v_mfma_f32_16x16x32_bf16 v[148:151], v[216:219], v[204:207], v[148:151]
  s_waitcnt lgkmcnt(0)
  v_mfma_f32_16x16x32_bf16 v[152:155], v[220:223], v[200:203], v[152:155]
  v_mfma_f32_16x16x32_bf16 v[156:159], v[220:223], v[204:207], v[156:159]
L_skipE_B0:
  s_waitcnt vmcnt(0)
  s_mov_b32 s38, s37
  s_add_u32 s37, s37, 49152
  s_cmp_eq_u32 s37, 147456
  s_cselect_b32 s37, 0, s37
  s_sub_u32 s42, s37, s38
  v_add_u32 v232, s42, v232
  v_add_u32 v233, s42, v233
  v_add_u32 v234, s42, v234
  v_add_u32 v235, s42, v235
  v_add_u32 v254, s42, v254
  s_barrier
  s_add_u32 s43, s68, s38
  s_add_u32 s41, s95, 393216
  s_add_u32 m0, s43, 24576
  s_nop 0
  buffer_load_dwordx4 v243, s[12:15], s95 offen lds
  s_add_u32 m0, s43, 25600
  s_nop 0
  buffer_load_dwordx4 v244, s[12:15], s95 offen lds
  s_add_u32 m0, s43, 26624
  s_nop 0
  buffer_load_dwordx4 v245, s[12:15], s95 offen lds
  s_add_u32 m0, s43, 36864
  s_nop 0
  buffer_load_dwordx4 v243, s[12:15], s41 offen lds
  s_add_u32 m0, s43, 37888
  s_nop 0
  buffer_load_dwordx4 v244, s[12:15], s41 offen lds
  s_add_u32 m0, s43, 38912
  s_nop 0
  buffer_load_dwordx4 v245, s[12:15], s41 offen lds
  s_add_u32 s43, s44, s38
  s_add_u32 s40, s54, s96
  s_add_u32 m0, s43, 0
  s_nop 0
  buffer_load_dwordx4 v246, s[24:27], s40 offen lds
  s_add_u32 s40, s55, s96
  s_add_u32 m0, s43, 4096
  s_nop 0
  buffer_load_dwordx4 v246, s[24:27], s40 offen lds
  s_add_u32 s95, s95, 786432
  s_add_u32 s96, s96, 196608
  s_add_u32 s42, s94, 0
  buffer_load_dwordx4 v[192:195], v251, s[16:19], s42 offen offset:0
  buffer_load_dwordx4 v[196:199], v251, s[16:19], s42 offen offset:1024
  s_add_u32 s42, s94, 131072
  buffer_load_dwordx4 v[200:203], v251, s[16:19], s42 offen offset:0
  buffer_load_dwordx4 v[204:207], v251, s[16:19], s42 offen offset:1024
  s_add_u32 s94, s94, 262144
  s_cmp_eq_u32 s65, 0
  s_cbranch_scc1 L_skipB_B1
  ds_read_b64_tr_b16 v[208:209], v232 offset:0
  ds_read_b64_tr_b16 v[210:211], v232 offset:6144
  ds_read_b64_tr_b16 v[212:213], v233 offset:0
  ds_read_b64_tr_b16 v[214:215], v233 offset:6144
  ds_read_b64_tr_b16 v[216:217], v234 offset:0
  ds_read_b64_tr_b16 v[218:219], v234 offset:6144
  ds_read_b64_tr_b16 v[220:221], v235 offset:0
  ds_read_b64_tr_b16 v[222:223], v235 offset:6144
  ds_read_b64_tr_b16 v[224:225], v232 offset:128
  ds_read_b64_tr_b16 v[226:227], v232 offset:6272
  s_waitcnt lgkmcnt(8)
  v_mfma_f32_16x16x32_bf16 v[0:3], v[208:211], v[96:99], v[0:3]
  ds_read_b64_tr_b16 v[228:229], v233 offset:128
  v_mfma_f32_16x16x32_bf16 v[4:7], v[208:211], v[100:103], v[4:7]
  ds_read_b64_tr_b16 v[230:231], v233 offset:6272
  s_waitcnt lgkmcnt(8)
  v_mfma_f32_16x16x32_bf16 v[8:11], v[212:215], v[96:99], v[8:11]
  ds_read_b64_tr_b16 v[208:209], v234 offset:128
  v_mfma_f32_16x16x32_bf16 v[12:15], v[212:215], v[100:103], v[12:15]
  ds_read_b64_tr_b16 v[210:211], v234 offset:6272
  s_waitcnt lgkmcnt(8)
  v_mfma_f32_16x16x32_bf16 v[16:19], v[216:219], v[96:99], v[16:19]
  ds_read_b64_tr_b16 v[212:213], v235 offset:128
  v_mfma_f32_16x16x32_bf16 v[20:23], v[216:219], v[100:103], v[20:23]
  ds_read_b64_tr_b16 v[214:215], v235 offset:6272
  s_waitcnt lgkmcnt(8)
  v_mfma_f32_16x16x32_bf16 v[24:27], v[220:223], v[96:99], v[24:27]
  ds_read_b64_tr_b16 v[216:217], v232 offset:256
  v_mfma_f32_16x16x32_bf16 v[28:31], v[220:223], v[100:103], v[28:31]
  ds_read_b64_tr_b16 v[218:219], v232 offset:6400
  s_waitcnt lgkmcnt(8)
  v_mfma_f32_16x16x32_bf16 v[32:35], v[224:227], v[96:99], v[32:35]
  ds_read_b64_tr_b16 v[220:221], v233 offset:256
  v_mfma_f32_16x16x32_bf16 v[36:39], v[224:227], v[100:103], v[36:39]
  ds_read_b64_tr_b16 v[222:223], v233 offset:6400
  s_waitcnt lgkmcnt(8)
  v_mfma_f32_16x16x32_bf16 v[40:43], v[228:231], v[96:99], v[40:43]
  ds_read_b64_tr_b16 v[224:225], v234 offset:256
  v_mfma_f32_16x16x32_bf16 v[44:47], v[228:231], v[100:103], v[44:47]
  ds_read_b64_tr_b16 v[226:227], v234 offset:6400
  s_waitcnt lgkmcnt(8)
  v_mfma_f32_16x16x32_bf16 v[48:51], v[208:211], v[96:99], v[48:51]
  ds_read_b64_tr_b16 v[228:229], v235 offset:256
  v_mfma_f32_16x16x32_bf16 v[52:55], v[208:211], v[100:103], v[52:55]
  ds_read_b64_tr_b16 v[230:231], v235 offset:6400
  s_waitcnt lgkmcnt(8)
  v_mfma_f32_16x16x32_bf16 v[56:59], v[212:215], v[96:99], v[56:59]
  ds_read_b64_tr_b16 v[208:209], v232 offset:12288
  v_mfma_f32_16x16x32_bf16 v[60:63], v[212:215], v[100:103], v[60:63]
  ds_read_b64_tr_b16 v[210:211], v232 offset:18432
  s_waitcnt lgkmcnt(8)
  v_mfma_f32_16x16x32_bf16 v[64:67], v[216:219], v[96:99], v[64:67]
  ds_read_b64_tr_b16 v[212:213], v233 offset:12288
  v_mfma_f32_16x16x32_bf16 v[68:71], v[216:219], v[100:103], v[68:71]
  ds_read_b64_tr_b16 v[214:215], v233 offset:18432
  s_waitcnt lgkmcnt(8)
  v_mfma_f32_16x16x32_bf16 v[72:75], v[220:223], v[96:99], v[72:75]
  ds_read_b64_tr_b16 v[216:217], v234 offset:12288
  v_mfma_f32_16x16x32_bf16 v[76:79], v[220:223], v[100:103], v[76:79]
  ds_read_b64_tr_b16 v[218:219], v234 offset:18432
  s_waitcnt lgkmcnt(8)
  v_mfma_f32_16x16x32_bf16 v[80:83], v[224:227], v[96:99], v[80:83]
  ds_read_b64_tr_b16 v[220:221], v235 offset:12288
  v_mfma_f32_16x16x32_bf16 v[84:87], v[224:227], v[100:103], v[84:87]
  ds_read_b64_tr_b16 v[222:223], v235 offset:18432
  s_waitcnt lgkmcnt(8)
  v_mfma_f32_16x16x32_bf16 v[88:91], v[228:231], v[96:99], v[88:91]
  ds_read_b64_tr_b16 v[224:225], v232 offset:12416
  v_mfma_f32_16x16x32_bf16 v[92:95], v[228:231], v[100:103], v[92:95]
  ds_read_b64_tr_b16 v[226:227], v232 offset:18560
  s_waitcnt lgkmcnt(8)
  v_mfma_f32_16x16x32_bf16 v[0:3], v[208:211], v[104:107], v[0:3]
  ds_read_b64_tr_b16 v[228:229], v233 offset:12416
  v_mfma_f32_16x16x32_bf16 v[4:7], v[208:211], v[108:111], v[4:7]
  ds_read_b64_tr_b16 v[230:231], v233 offset:18560
  s_waitcnt lgkmcnt(8)
  v_mfma_f32_16x16x32_bf16 v[8:11], v[212:215], v[104:107], v[8:11]
  ds_read_b64_tr_b16 v[208:209], v234 offset:12416
  v_mfma_f32_16x16x32_bf16 v[12:15], v[212:215], v[108:111], v[12:15]
  ds_read_b64_tr_b16 v[210:211], v234 offset:18560
  s_waitcnt lgkmcnt(8)
  v_mfma_f32_16x16x32_bf16 v[16:19], v[216:219], v[104:107], v[16:19]
  ds_read_b64_tr_b16 v[212:213], v235 offset:12416
  v_mfma_f32_16x16x32_bf16 v[20:23], v[216:219], v[108:111], v[20:23]
  ds_read_b64_tr_b16 v[214:215], v235 offset:18560
  s_waitcnt lgkmcnt(8)
  v_mfma_f32_16x16x32_bf16 v[24:27], v[220:223], v[104:107], v[24:27]
  ds_read_b64_tr_b16 v[216:217], v232 offset:12544
  v_mfma_f32_16x16x32_bf16 v[28:31], v[220:223], v[108:111], v[28:31]
  ds_read_b64_tr_b16 v[218:219], v232 offset:18688
  s_waitcnt lgkmcnt(8)
  v_mfma_f32_16x16x32_bf16 v[32:35], v[224:227], v[104:107], v[32:35]
  ds_read_b64_tr_b16 v[220:221], v233 offset:12544
  v_mfma_f32_16x16x32_bf16 v[36:39], v[224:227], v[108:111], v[36:39]
  ds_read_b64_tr_b16 v[222:223], v233 offset:18688
  s_waitcnt lgkmcnt(8)
  v_mfma_f32_16x16x32_bf16 v[40:43], v[228:231], v[104:107], v[40:43]
  ds_read_b64_tr_b16 v[224:225], v234 offset:12544
  v_mfma_f32_16x16x32_bf16 v[44:47], v[228:231], v[108:111], v[44:47]
  ds_read_b64_tr_b16 v[226:227], v234 offset:18688
  s_waitcnt lgkmcnt(8)
  v_mfma_f32_16x16x32_bf16 v[48:51], v[208:211], v[104:107], v[48:51]
  ds_read_b64_tr_b16 v[228:229], v235 offset:12544
  v_mfma_f32_16x16x32_bf16 v[52:55], v[208:211], v[108:111], v[52:55]
  ds_read_b64_tr_b16 v[230:231], v235 offset:18688
  s_waitcnt lgkmcnt(8)
  v_mfma_f32_16x16x32_bf16 v[56:59], v[212:215], v[104:107], v[56:59]
  ds_read_b64_tr_b16 v[208:209], v254 offset:0
  v_mfma_f32_16x16x32_bf16 v[60:63], v[212:215], v[108:111], v[60:63]
  ds_read_b64_tr_b16 v[210:211], v254 offset:1024
  s_waitcnt lgkmcnt(8)
  v_mfma_f32_16x16x32_bf16 v[64:67], v[216:219], v[104:107], v[64:67]
  ds_read_b64_tr_b16 v[212:213], v254 offset:32
  v_mfma_f32_16x16x32_bf16 v[68:71], v[216:219], v[108:111], v[68:71]
  ds_read_b64_tr_b16 v[214:215], v254 offset:1056
  s_waitcnt lgkmcnt(8)
  v_mfma_f32_16x16x32_bf16 v[72:75], v[220:223], v[104:107], v[72:75]
  ds_read_b64_tr_b16 v[216:217], v254 offset:2048
  v_mfma_f32_16x16x32_bf16 v[76:79], v[220:223], v[108:111], v[76:79]
  ds_read_b64_tr_b16 v[218:219], v254 offset:3072
  s_waitcnt lgkmcnt(8)
  v_mfma_f32_16x16x32_bf16 v[80:83], v[224:227], v[104:107], v[80:83]
  ds_read_b64_tr_b16 v[220:221], v254 offset:2080
  v_mfma_f32_16x16x32_bf16 v[84:87], v[224:227], v[108:111], v[84:87]
  ds_read_b64_tr_b16 v[222:223], v254 offset:3104
  s_waitcnt lgkmcnt(8)
  v_mfma_f32_16x16x32_bf16 v[88:91], v[228:231], v[104:107], v[88:91]
  ds_read_b64_tr_b16 v[224:225], v254 offset:4096
  v_mfma_f32_16x16x32_bf16 v[92:95], v[228:231], v[108:111], v[92:95]
  ds_read_b64_tr_b16 v[226:227], v254 offset:5120
  s_waitcnt lgkmcnt(8)
  v_mfma_f32_16x16x32_bf16 v[144:147], v[208:211], v[96:99], v[144:147]
  ds_read_b64_tr_b16 v[228:229], v254 offset:4128
  v_mfma_f32_16x16x32_bf16 v[148:151], v[208:211], v[100:103], v[148:151]
  ds_read_b64_tr_b16 v[230:231], v254 offset:5152
  s_waitcnt lgkmcnt(8)
  v_mfma_f32_16x16x32_bf16 v[152:155], v[212:215], v[96:99], v[152:155]
  ds_read_b64_tr_b16 v[208:209], v254 offset:6144
  v_mfma_f32_16x16x32_bf16 v[156:159], v[212:215], v[100:103], v[156:159]
  ds_read_b64_tr_b16 v[210:211], v254 offset:7168
  s_waitcnt lgkmcnt(8)
  v_mfma_f32_16x16x32_bf16 v[144:147], v[216:219], v[104:107], v[144:147]
  ds_read_b64_tr_b16 v[212:213], v254 offset:6176
  v_mfma_f32_16x16x32_bf16 v[148:151], v[216:219], v[108:111], v[148:151]
  ds_read_b64_tr_b16 v[214:215], v254 offset:7200
  s_waitcnt lgkmcnt(8)
  v_mfma_f32_16x16x32_bf16 v[152:155], v[220:223], v[104:107], v[152:155]
  v_mfma_f32_16x16x32_bf16 v[156:159], v[220:223], v[108:111], v[156:159]
  s_waitcnt lgkmcnt(6)
  v_mfma_f32_16x16x32_bf16 v[160:163], v[224:227], v[96:99], v[160:163]
  v_mfma_f32_16x16x32_bf16 v[164:167], v[224:227], v[100:103], v[164:167]
  s_waitcnt lgkmcnt(4)
  v_mfma_f32_16x16x32_bf16 v[168:171], v[228:231], v[96:99], v[168:171]
  v_mfma_f32_16x16x32_bf16 v[172:175], v[228:231], v[100:103], v[172:175]
  s_waitcnt lgkmcnt(2)
  v_mfma_f32_16x16x32_bf16 v[160:163], v[208:211], v[104:107], v[160:163]
  v_mfma_f32_16x16x32_bf16 v[164:167], v[208:211], v[108:111], v[164:167]
  s_waitcnt lgkmcnt(0)
  v_mfma_f32_16x16x32_bf16 v[168:171], v[212:215], v[104:107], v[168:171]
  v_mfma_f32_16x16x32_bf16 v[172:175], v[212:215], v[108:111], v[172:175]
  s_branch L_skipE_B1
L_skipB_B1:
  ds_read_b64_tr_b16 v[208:209], v232 offset:0
  ds_read_b64_tr_b16 v[210:211], v232 offset:6144
  ds_read_b64_tr_b16 v[212:213], v233 offset:0
  ds_read_b64_tr_b16 v[214:215], v233 offset:6144
  ds_read_b64_tr_b16 v[216:217], v234 offset:0
  ds_read_b64_tr_b16 v[218:219], v234 offset:6144
  ds_read_b64_tr_b16 v[220:221], v235 offset:0
  ds_read_b64_tr_b16 v[222:223], v235 offset:6144
  ds_read_b64_tr_b16 v[224:225], v232 offset:128
  ds_read_b64_tr_b16 v[226:227], v232 offset:6272
  s_waitcnt lgkmcnt(8)
  v_mfma_f32_16x16x32_bf16 v[0:3], v[208:211], v[96:99], v[0:3]
  ds_read_b64_tr_b16 v[228:229], v233 offset:128
  v_mfma_f32_16x16x32_bf16 v[4:7], v[208:211], v[100:103], v[4:7]
  ds_read_b64_tr_b16 v[230:231], v233 offset:6272
  s_waitcnt lgkmcnt(8)
  v_mfma_f32_16x16x32_bf16 v[8:11], v[212:215], v[96:99], v[8:11]
  ds_read_b64_tr_b16 v[208:209], v234 offset:128
  v_mfma_f32_16x16x32_bf16 v[12:15], v[212:215], v[100:103], v[12:15]
  ds_read_b64_tr_b16 v[210:211], v234 offset:6272
  s_waitcnt lgkmcnt(8)
  v_mfma_f32_16x16x32_bf16 v[16:19], v[216:219], v[96:99], v[16:19]
  ds_read_b64_tr_b16 v[212:213], v235 offset:128
  v_mfma_f32_16x16x32_bf16 v[20:23], v[216:219], v[100:103], v[20:23]
  ds_read_b64_tr_b16 v[214:215], v235 offset:6272
  s_waitcnt lgkmcnt(8)
  v_mfma_f32_16x16x32_bf16 v[24:27], v[220:223], v[96:99], v[24:27]
  ds_read_b64_tr_b16 v[216:217], v232 offset:256
  v_mfma_f32_16x16x32_bf16 v[28:31], v[220:223], v[100:103], v[28:31]
  ds_read_b64_tr_b16 v[218:219], v232 offset:6400
  s_waitcnt lgkmcnt(8)
  v_mfma_f32_16x16x32_bf16 v[32:35], v[224:227], v[96:99], v[32:35]
  ds_read_b64_tr_b16 v[220:221], v233 offset:256
  v_mfma_f32_16x16x32_bf16 v[36:39], v[224:227], v[100:103], v[36:39]
  ds_read_b64_tr_b16 v[222:223], v233 offset:6400
  s_waitcnt lgkmcnt(8)
  v_mfma_f32_16x16x32_bf16 v[40:43], v[228:231], v[96:99], v[40:43]
  ds_read_b64_tr_b16 v[224:225], v234 offset:256
  v_mfma_f32_16x16x32_bf16 v[44:47], v[228:231], v[100:103], v[44:47]
  ds_read_b64_tr_b16 v[226:227], v234 offset:6400
  s_waitcnt lgkmcnt(8)
  v_mfma_f32_16x16x32_bf16 v[48:51], v[208:211], v[96:99], v[48:51]
  ds_read_b64_tr_b16 v[228:229], v235 offset:256
  v_mfma_f32_16x16x32_bf16 v[52:55], v[208:211], v[100:103], v[52:55]
  ds_read_b64_tr_b16 v[230:231], v235 offset:6400
  s_waitcnt lgkmcnt(8)
  v_mfma_f32_16x16x32_bf16 v[56:59], v[212:215], v[96:99], v[56:59]
  ds_read_b64_tr_b16 v[208:209], v232 offset:12288
  v_mfma_f32_16x16x32_bf16 v[60:63], v[212:215], v[100:103], v[60:63]
  ds_read_b64_tr_b16 v[210:211], v232 offset:18432
  s_waitcnt lgkmcnt(8)
  v_mfma_f32_16x16x32_bf16 v[64:67], v[216:219], v[96:99], v[64:67]
  ds_read_b64_tr_b16 v[212:213], v233 offset:12288
  v_mfma_f32_16x16x32_bf16 v[68:71], v[216:219], v[100:103], v[68:71]
  ds_read_b64_tr_b16 v[214:215], v233 offset:18432
  s_waitcnt lgkmcnt(8)
  v_mfma_f32_16x16x32_bf16 v[72:75], v[220:223], v[96:99], v[72:75]
  ds_read_b64_tr_b16 v[216:217], v234 offset:12288
  v_mfma_f32_16x16x32_bf16 v[76:79], v[220:223], v[100:103], v[76:79]
  ds_read_b64_tr_b16 v[218:219], v234 offset:18432
  s_waitcnt lgkmcnt(8)
  v_mfma_f32_16x16x32_bf16 v[80:83], v[224:227], v[96:99], v[80:83]
  ds_read_b64_tr_b16 v[220:221], v235 offset:12288
  v_mfma_f32_16x16x32_bf16 v[84:87], v[224:227], v[100:103], v[84:87]
  ds_read_b64_tr_b16 v[222:223], v235 offset:18432
  s_waitcnt lgkmcnt(8)
  v_mfma_f32_16x16x32_bf16 v[88:91], v[228:231], v[96:99], v[88:91]
  ds_read_b64_tr_b16 v[224:225], v232 offset:12416
  v_mfma_f32_16x16x32_bf16 v[92:95], v[228:231], v[100:103], v[92:95]
  ds_read_b64_tr_b16 v[226:227], v232 offset:18560
  s_waitcnt lgkmcnt(8)
  v_mfma_f32_16x16x32_bf16 v[0:3], v[208:211], v[104:107], v[0:3]
  ds_read_b64_tr_b16 v[228:229], v233 offset:12416
  v_mfma_f32_16x16x32_bf16 v[4:7], v[208:211], v[108:111], v[4:7]
  ds_read_b64_tr_b16 v[230:231], v233 offset:18560
  s_waitcnt lgkmcnt(8)
  v_mfma_f32_16x16x32_bf16 v[8:11], v[212:215], v[104:107], v[8:11]
  ds_read_b64_tr_b16 v[208:209], v234 offset:12416
  v_mfma_f32_16x16x32_bf16 v[12:15], v[212:215], v[108:111], v[12:15]
  ds_read_b64_tr_b16 v[210:211], v234 offset:18560
  s_waitcnt lgkmcnt(8)
  v_mfma_f32_16x16x32_bf16 v[16:19], v[216:219], v[104:107], v[16:19]
  ds_read_b64_tr_b16 v[212:213], v235 offset:12416
  v_mfma_f32_16x16x32_bf16 v[20:23], v[216:219], v[108:111], v[20:23]
  ds_read_b64_tr_b16 v[214:215], v235 offset:18560
  s_waitcnt lgkmcnt(8)
  v_mfma_f32_16x16x32_bf16 v[24:27], v[220:223], v[104:107], v[24:27]
  ds_read_b64_tr_b16 v[216:217], v232 offset:12544
  v_mfma_f32_16x16x32_bf16 v[28:31], v[220:223], v[108:111], v[28:31]
  ds_read_b64_tr_b16 v[218:219], v232 offset:18688
  s_waitcnt lgkmcnt(8)
  v_mfma_f32_16x16x32_bf16 v[32:35], v[224:227], v[104:107], v[32:35]
  ds_read_b64_tr_b16 v[220:221], v233 offset:12544
  v_mfma_f32_16x16x32_bf16 v[36:39], v[224:227], v[108:111], v[36:39]
  ds_read_b64_tr_b16 v[222:223], v233 offset:18688
  s_waitcnt lgkmcnt(8)
  v_mfma_f32_16x16x32_bf16 v[40:43], v[228:231], v[104:107], v[40:43]
  ds_read_b64_tr_b16 v[224:225], v234 offset:12544
  v_mfma_f32_16x16x32_bf16 v[44:47], v[228:231], v[108:111], v[44:47]
  ds_read_b64_tr_b16 v[226:227], v234 offset:18688
  s_waitcnt lgkmcnt(8)
  v_mfma_f32_16x16x32_bf16 v[48:51], v[208:211], v[104:107], v[48:51]
  ds_read_b64_tr_b16 v[228:229], v235 offset:12544
  v_mfma_f32_16x16x32_bf16 v[52:55], v[208:211], v[108:111], v[52:55]
  ds_read_b64_tr_b16 v[230:231], v235 offset:18688
  s_waitcnt lgkmcnt(8)
  v_mfma_f32_16x16x32_bf16 v[56:59], v[212:215], v[104:107], v[56:59]
  ds_read_b64_tr_b16 v[208:209], v254 offset:0
  v_mfma_f32_16x16x32_bf16 v[60:63], v[212:215], v[108:111], v[60:63]
  ds_read_b64_tr_b16 v[210:211], v254 offset:1024
  s_waitcnt lgkmcnt(8)
  v_mfma_f32_16x16x32_bf16 v[64:67], v[216:219], v[104:107], v[64:67]
  ds_read_b64_tr_b16 v[212:213], v254 offset:32
  v_mfma_f32_16x16x32_bf16 v[68:71], v[216:219], v[108:111], v[68:71]
  ds_read_b64_tr_b16 v[214:215], v254 offset:1056
  s_waitcnt lgkmcnt(8)
  v_mfma_f32_16x16x32_bf16 v[72:75], v[220:223], v[104:107], v[72:75]
  ds_read_b64_tr_b16 v[216:217], v254 offset:2048
  v_mfma_f32_16x16x32_bf16 v[76:79], v[220:223], v[108:111], v[76:79]
  ds_read_b64_tr_b16 v[218:219], v254 offset:3072
  s_waitcnt lgkmcnt(8)
  v_mfma_f32_16x16x32_bf16 v[80:83], v[224:227], v[104:107], v[80:83]
  ds_read_b64_tr_b16 v[220:221], v254 offset:2080
  v_mfma_f32_16x16x32_bf16 v[84:87], v[224:227], v[108:111], v[84:87]
  ds_read_b64_tr_b16 v[222:223], v254 offset:3104
  s_waitcnt lgkmcnt(8)
  v_mfma_f32_16x16x32_bf16 v[88:91], v[228:231], v[104:107], v[88:91]
  v_mfma_f32_16x16x32_bf16 v[92:95], v[228:231], v[108:111], v[92:95]
  s_waitcnt lgkmcnt(6)
  v_mfma_f32_16x16x32_bf16 v[144:147], v[208:211], v[96:99], v[144:147]
  v_mfma_f32_16x16x32_bf16 v[148:151], v[208:211], v[100:103], v[148:151]
  s_waitcnt lgkmcnt(4)
  v_mfma_f32_16x16x32_bf16 v[152:155], v[212:215], v[96:99], v[152:155]
  v_mfma_f32_16x16x32_bf16 v[156:159], v[212:215], v[100:103], v[156:159]
  s_waitcnt lgkmcnt(2)
  v_mfma_f32_16x16x32_bf16 v[144:147], v[216:219], v[104:107], v[144:147]
  v_mfma_f32_16x16x32_bf16 v[148:151], v[216:219], v[108:111], v[148:151]
  s_waitcnt lgkmcnt(0)
  v_mfma_f32_16x16x32_bf16 v[152:155], v[220:223], v[104:107], v[152:155]
  v_mfma_f32_16x16x32_bf16 v[156:159], v[220:223], v[108:111], v[156:159]
L_skipE_B1:
  s_waitcnt vmcnt(0)
  s_mov_b32 s38, s37
  s_add_u32 s37, s37, 49152
  s_cmp_eq_u32 s37, 147456
  s_cselect_b32 s37, 0, s37
  s_sub_u32 s42, s37, s38
  v_add_u32 v232, s42, v232
  v_add_u32 v233, s42, v233
  v_add_u32 v234, s42, v234
  v_add_u32 v235, s42, v235
  v_add_u32 v254, s42, v254
  s_barrier
  s_add_u32 s97, s97, 1
  s_cmp_lt_u32 s97, 4
  s_cbranch_scc1 L_proB_loop
  s_add_u32 s43, s68, s38
  s_mov_b32 s40, 0
  s_add_u32 m0, s43, 0
  s_nop 0
  buffer_load_dwordx4 v240, s[4:7], s40 offen lds
  s_add_u32 m0, s43, 1024
  s_nop 0
  buffer_load_dwordx4 v241, s[4:7], s40 offen lds
  s_add_u32 m0, s43, 2048
  s_nop 0
  buffer_load_dwordx4 v242, s[4:7], s40 offen lds
  s_add_u32 s69, s40, 12288
  s_add_u32 m0, s43, 12288
  s_nop 0
  buffer_load_dwordx4 v240, s[4:7], s69 offen lds
  s_add_u32 m0, s43, 13312
  s_nop 0
  buffer_load_dwordx4 v241, s[4:7], s69 offen lds
  s_add_u32 m0, s43, 14336
  s_nop 0
  buffer_load_dwordx4 v242, s[4:7], s69 offen lds
  s_add_u32 s42, s94, 0
  buffer_load_dwordx4 v[96:99], v251, s[16:19], s42 offen offset:0
  buffer_load_dwordx4 v[100:103], v251, s[16:19], s42 offen offset:1024
  s_add_u32 s42, s94, 131072
  buffer_load_dwordx4 v[104:107], v251, s[16:19], s42 offen offset:0
  buffer_load_dwordx4 v[108:111], v251, s[16:19], s42 offen offset:1024
  s_add_u32 s94, s94, 262144
  s_cmp_eq_u32 s65, 0
  s_cbranch_scc1 L_skipB_B8
  ds_read_b64_tr_b16 v[208:209], v232 offset:0
  ds_read_b64_tr_b16 v[210:211], v232 offset:6144
  ds_read_b64_tr_b16 v[212:213], v233 offset:0
  ds_read_b64_tr_b16 v[214:215], v233 offset:6144
  ds_read_b64_tr_b16 v[216:217], v234 offset:0
  ds_read_b64_tr_b16 v[218:219], v234 offset:6144
  ds_read_b64_tr_b16 v[220:221], v235 offset:0
  ds_read_b64_tr_b16 v[222:223], v235 offset:6144
  ds_read_b64_tr_b16 v[224:225], v232 offset:128
  ds_read_b64_tr_b16 v[226:227], v232 offset:6272
  s_waitcnt lgkmcnt(8)
  v_mfma_f32_16x16x32_bf16 v[0:3], v[208:211], v[192:195], v[0:3]
  ds_read_b64_tr_b16 v[228:229], v233 offset:128
  v_mfma_f32_16x16x32_bf16 v[4:7], v[208:211], v[196:199], v[4:7]
  ds_read_b64_tr_b16 v[230:231], v233 offset:6272
  s_waitcnt lgkmcnt(8)
  v_mfma_f32_16x16x32_bf16 v[8:11], v[212:215], v[192:195], v[8:11]
  ds_read_b64_tr_b16 v[208:209], v234 offset:128
  v_mfma_f32_16x16x32_bf16 v[12:15], v[212:215], v[196:199], v[12:15]
  ds_read_b64_tr_b16 v[210:211], v234 offset:6272
  s_waitcnt lgkmcnt(8)
  v_mfma_f32_16x16x32_bf16 v[16:19], v[216:219], v[192:195], v[16:19]
  ds_read_b64_tr_b16 v[212:213], v235 offset:128
  v_mfma_f32_16x16x32_bf16 v[20:23], v[216:219], v[196:199], v[20:23]
  ds_read_b64_tr_b16 v[214:215], v235 offset:6272
  s_waitcnt lgkmcnt(8)
  v_mfma_f32_16x16x32_bf16 v[24:27], v[220:223], v[192:195], v[24:27]
  ds_read_b64_tr_b16 v[216:217], v232 offset:256
  v_mfma_f32_16x16x32_bf16 v[28:31], v[220:223], v[196:199], v[28:31]
  ds_read_b64_tr_b16 v[218:219], v232 offset:6400
  s_waitcnt lgkmcnt(8)
  v_mfma_f32_16x16x32_bf16 v[32:35], v[224:227], v[192:195], v[32:35]
  ds_read_b64_tr_b16 v[220:221], v233 offset:256
  v_mfma_f32_16x16x32_bf16 v[36:39], v[224:227], v[196:199], v[36:39]
  ds_read_b64_tr_b16 v[222:223], v233 offset:6400
  s_waitcnt lgkmcnt(8)
  v_mfma_f32_16x16x32_bf16 v[40:43], v[228:231], v[192:195], v[40:43]
  ds_read_b64_tr_b16 v[224:225], v234 offset:256
  v_mfma_f32_16x16x32_bf16 v[44:47], v[228:231], v[196:199], v[44:47]
  ds_read_b64_tr_b16 v[226:227], v234 offset:6400
  s_waitcnt lgkmcnt(8)
  v_mfma_f32_16x16x32_bf16 v[48:51], v[208:211], v[192:195], v[48:51]
  ds_read_b64_tr_b16 v[228:229], v235 offset:256
  v_mfma_f32_16x16x32_bf16 v[52:55], v[208:211], v[196:199], v[52:55]
  ds_read_b64_tr_b16 v[230:231], v235 offset:6400
  s_waitcnt lgkmcnt(8)
  v_mfma_f32_16x16x32_bf16 v[56:59], v[212:215], v[192:195], v[56:59]
  ds_read_b64_tr_b16 v[208:209], v232 offset:12288
  v_mfma_f32_16x16x32_bf16 v[60:63], v[212:215], v[196:199], v[60:63]
  ds_read_b64_tr_b16 v[210:211], v232 offset:18432
  s_waitcnt lgkmcnt(8)
  v_mfma_f32_16x16x32_bf16 v[64:67], v[216:219], v[192:195], v[64:67]
  ds_read_b64_tr_b16 v[212:213], v233 offset:12288
  v_mfma_f32_16x16x32_bf16 v[68:71], v[216:219], v[196:199], v[68:71]
  ds_read_b64_tr_b16 v[214:215], v233 offset:18432
  s_waitcnt lgkmcnt(8)
  v_mfma_f32_16x16x32_bf16 v[72:75], v[220:223], v[192:195], v[72:75]
  ds_read_b64_tr_b16 v[216:217], v234 offset:12288
  v_mfma_f32_16x16x32_bf16 v[76:79], v[220:223], v[196:199], v[76:79]
  ds_read_b64_tr_b16 v[218:219], v234 offset:18432
  s_waitcnt lgkmcnt(8)
  v_mfma_f32_16x16x32_bf16 v[80:83], v[224:227], v[192:195], v[80:83]
  ds_read_b64_tr_b16 v[220:221], v235 offset:12288
  v_mfma_f32_16x16x32_bf16 v[84:87], v[224:227], v[196:199], v[84:87]
  ds_read_b64_tr_b16 v[222:223], v235 offset:18432
  s_waitcnt lgkmcnt(8)
  v_mfma_f32_16x16x32_bf16 v[88:91], v[228:231], v[192:195], v[88:91]
  ds_read_b64_tr_b16 v[224:225], v232 offset:12416
  v_mfma_f32_16x16x32_bf16 v[92:95], v[228:231], v[196:199], v[92:95]
  ds_read_b64_tr_b16 v[226:227], v232 offset:18560
  s_waitcnt lgkmcnt(8)
  v_mfma_f32_16x16x32_bf16 v[0:3], v[208:211], v[200:203], v[0:3]
  ds_read_b64_tr_b16 v[228:229], v233 offset:12416
  v_mfma_f32_16x16x32_bf16 v[4:7], v[208:211], v[204:207], v[4:7]
  ds_read_b64_tr_b16 v[230:231], v233 offset:18560
  s_waitcnt lgkmcnt(8)
  v_mfma_f32_16x16x32_bf16 v[8:11], v[212:215], v[200:203], v[8:11]
  ds_read_b64_tr_b16 v[208:209], v234 offset:12416
  v_mfma_f32_16x16x32_bf16 v[12:15], v[212:215], v[204:207], v[12:15]
  ds_read_b64_tr_b16 v[210:211], v234 offset:18560
  s_waitcnt lgkmcnt(8)
  v_mfma_f32_16x16x32_bf16 v[16:19], v[216:219], v[200:203], v[16:19]
  ds_read_b64_tr_b16 v[212:213], v235 offset:12416
  v_mfma_f32_16x16x32_bf16 v[20:23], v[216:219], v[204:207], v[20:23]
  ds_read_b64_tr_b16 v[214:215], v235 offset:18560
  s_waitcnt lgkmcnt(8)
  v_mfma_f32_16x16x32_bf16 v[24:27], v[220:223], v[200:203], v[24:27]
  ds_read_b64_tr_b16 v[216:217], v232 offset:12544
  v_mfma_f32_16x16x32_bf16 v[28:31], v[220:223], v[204:207], v[28:31]
  ds_read_b64_tr_b16 v[218:219], v232 offset:18688
  s_waitcnt lgkmcnt(8)
  v_mfma_f32_16x16x32_bf16 v[32:35], v[224:227], v[200:203], v[32:35]
  ds_read_b64_tr_b16 v[220:221], v233 offset:12544
  v_mfma_f32_16x16x32_bf16 v[36:39], v[224:227], v[204:207], v[36:39]
  ds_read_b64_tr_b16 v[222:223], v233 offset:18688
  s_waitcnt lgkmcnt(8)
  v_mfma_f32_16x16x32_bf16 v[40:43], v[228:231], v[200:203], v[40:43]
  ds_read_b64_tr_b16 v[224:225], v234 offset:12544
  v_mfma_f32_16x16x32_bf16 v[44:47], v[228:231], v[204:207], v[44:47]
  ds_read_b64_tr_b16 v[226:227], v234 offset:18688
  s_waitcnt lgkmcnt(8)
  v_mfma_f32_16x16x32_bf16 v[48:51], v[208:211], v[200:203], v[48:51]
  ds_read_b64_tr_b16 v[228:229], v235 offset:12544
  v_mfma_f32_16x16x32_bf16 v[52:55], v[208:211], v[204:207], v[52:55]
  ds_read_b64_tr_b16 v[230:231], v235 offset:18688
  s_waitcnt lgkmcnt(8)
  v_mfma_f32_16x16x32_bf16 v[56:59], v[212:215], v[200:203], v[56:59]
  ds_read_b64_tr_b16 v[208:209], v254 offset:0
  v_mfma_f32_16x16x32_bf16 v[60:63], v[212:215], v[204:207], v[60:63]
  ds_read_b64_tr_b16 v[210:211], v254 offset:1024
  s_waitcnt lgkmcnt(8)
  v_mfma_f32_16x16x32_bf16 v[64:67], v[216:219], v[200:203], v[64:67]
  ds_read_b64_tr_b16 v[212:213], v254 offset:32
  v_mfma_f32_16x16x32_bf16 v[68:71], v[216:219], v[204:207], v[68:71]
  ds_read_b64_tr_b16 v[214:215], v254 offset:1056
  s_waitcnt lgkmcnt(8)
  v_mfma_f32_16x16x32_bf16 v[72:75], v[220:223], v[200:203], v[72:75]
  ds_read_b64_tr_b16 v[216:217], v254 offset:2048
  v_mfma_f32_16x16x32_bf16 v[76:79], v[220:223], v[204:207], v[76:79]
  ds_read_b64_tr_b16 v[218:219], v254 offset:3072
  s_waitcnt lgkmcnt(8)
  v_mfma_f32_16x16x32_bf16 v[80:83], v[224:227], v[200:203], v[80:83]
  ds_read_b64_tr_b16 v[220:221], v254 offset:2080
  v_mfma_f32_16x16x32_bf16 v[84:87], v[224:227], v[204:207], v[84:87]
  ds_read_b64_tr_b16 v[222:223], v254 offset:3104
  s_waitcnt lgkmcnt(8)
  v_mfma_f32_16x16x32_bf16 v[88:91], v[228:231], v[200:203], v[88:91]
  ds_read_b64_tr_b16 v[224:225], v254 offset:4096
  v_mfma_f32_16x16x32_bf16 v[92:95], v[228:231], v[204:207], v[92:95]
  ds_read_b64_tr_b16 v[226:227], v254 offset:5120
  s_waitcnt lgkmcnt(8)
  v_mfma_f32_16x16x32_bf16 v[144:147], v[208:211], v[192:195], v[144:147]
  ds_read_b64_tr_b16 v[228:229], v254 offset:4128
  v_mfma_f32_16x16x32_bf16 v[148:151], v[208:211], v[196:199], v[148:151]
  ds_read_b64_tr_b16 v[230:231], v254 offset:5152
  s_waitcnt lgkmcnt(8)
  v_mfma_f32_16x16x32_bf16 v[152:155], v[212:215], v[192:195], v[152:155]
  ds_read_b64_tr_b16 v[208:209], v254 offset:6144
  v_mfma_f32_16x16x32_bf16 v[156:159], v[212:215], v[196:199], v[156:159]
  ds_read_b64_tr_b16 v[210:211], v254 offset:7168
  s_waitcnt lgkmcnt(8)
  v_mfma_f32_16x16x32_bf16 v[144:147], v[216:219], v[200:203], v[144:147]
  ds_read_b64_tr_b16 v[212:213], v254 offset:6176
  v_mfma_f32_16x16x32_bf16 v[148:151], v[216:219], v[204:207], v[148:151]
  ds_read_b64_tr_b16 v[214:215], v254 offset:7200
  s_waitcnt lgkmcnt(8)
  v_mfma_f32_16x16x32_bf16 v[152:155], v[220:223], v[200:203], v[152:155]
  v_mfma_f32_16x16x32_bf16 v[156:159], v[220:223], v[204:207], v[156:159]
  s_waitcnt lgkmcnt(6)
  v_mfma_f32_16x16x32_bf16 v[160:163], v[224:227], v[192:195], v[160:163]
  v_mfma_f32_16x16x32_bf16 v[164:167], v[224:227], v[196:199], v[164:167]
  s_waitcnt lgkmcnt(4)
  v_mfma_f32_16x16x32_bf16 v[168:171], v[228:231], v[192:195], v[168:171]
  v_mfma_f32_16x16x32_bf16 v[172:175], v[228:231], v[196:199], v[172:175]
  s_waitcnt lgkmcnt(2)
  v_mfma_f32_16x16x32_bf16 v[160:163], v[208:211], v[200:203], v[160:163]
  v_mfma_f32_16x16x32_bf16 v[164:167], v[208:211], v[204:207], v[164:167]
  s_waitcnt lgkmcnt(0)
  v_mfma_f32_16x16x32_bf16 v[168:171], v[212:215], v[200:203], v[168:171]
  v_mfma_f32_16x16x32_bf16 v[172:175], v[212:215], v[204:207], v[172:175]
  s_branch L_skipE_B8
L_skipB_B8:
  ds_read_b64_tr_b16 v[208:209], v232 offset:0
  ds_read_b64_tr_b16 v[210:211], v232 offset:6144
  ds_read_b64_tr_b16 v[212:213], v233 offset:0
  ds_read_b64_tr_b16 v[214:215], v233 offset:6144
  ds_read_b64_tr_b16 v[216:217], v234 offset:0
  ds_read_b64_tr_b16 v[218:219], v234 offset:6144
  ds_read_b64_tr_b16 v[220:221], v235 offset:0
  ds_read_b64_tr_b16 v[222:223], v235 offset:6144
  ds_read_b64_tr_b16 v[224:225], v232 offset:128
  ds_read_b64_tr_b16 v[226:227], v232 offset:6272
  s_waitcnt lgkmcnt(8)
  v_mfma_f32_16x16x32_bf16 v[0:3], v[208:211], v[192:195], v[0:3]
  ds_read_b64_tr_b16 v[228:229], v233 offset:128
  v_mfma_f32_16x16x32_bf16 v[4:7], v[208:211], v[196:199], v[4:7]
  ds_read_b64_tr_b16 v[230:231], v233 offset:6272
  s_waitcnt lgkmcnt(8)
  v_mfma_f32_16x16x32_bf16 v[8:11], v[212:215], v[192:195], v[8:11]
  ds_read_b64_tr_b16 v[208:209], v234 offset:128
  v_mfma_f32_16x16x32_bf16 v[12:15], v[212:215], v[196:199], v[12:15]
  ds_read_b64_tr_b16 v[210:211], v234 offset:6272
  s_waitcnt lgkmcnt(8)
  v_mfma_f32_16x16x32_bf16 v[16:19], v[216:219], v[192:195], v[16:19]
  ds_read_b64_tr_b16 v[212:213], v235 offset:128
  v_mfma_f32_16x16x32_bf16 v[20:23], v[216:219], v[196:199], v[20:23]
  ds_read_b64_tr_b16 v[214:215], v235 offset:6272
  s_waitcnt lgkmcnt(8)
  v_mfma_f32_16x16x32_bf16 v[24:27], v[220:223], v[192:195], v[24:27]
  ds_read_b64_tr_b16 v[216:217], v232 offset:256
  v_mfma_f32_16x16x32_bf16 v[28:31], v[220:223], v[196:199], v[28:31]
  ds_read_b64_tr_b16 v[218:219], v232 offset:6400
  s_waitcnt lgkmcnt(8)
  v_mfma_f32_16x16x32_bf16 v[32:35], v[224:227], v[192:195], v[32:35]
  ds_read_b64_tr_b16 v[220:221], v233 offset:256
  v_mfma_f32_16x16x32_bf16 v[36:39], v[224:227], v[196:199], v[36:39]
  ds_read_b64_tr_b16 v[222:223], v233 offset:6400
  s_waitcnt lgkmcnt(8)
  v_mfma_f32_16x16x32_bf16 v[40:43], v[228:231], v[192:195], v[40:43]
  ds_read_b64_tr_b16 v[224:225], v234 offset:256
  v_mfma_f32_16x16x32_bf16 v[44:47], v[228:231], v[196:199], v[44:47]
  ds_read_b64_tr_b16 v[226:227], v234 offset:6400
  s_waitcnt lgkmcnt(8)
  v_mfma_f32_16x16x32_bf16 v[48:51], v[208:211], v[192:195], v[48:51]
  ds_read_b64_tr_b16 v[228:229], v235 offset:256
  v_mfma_f32_16x16x32_bf16 v[52:55], v[208:211], v[196:199], v[52:55]
  ds_read_b64_tr_b16 v[230:231], v235 offset:6400
  s_waitcnt lgkmcnt(8)
  v_mfma_f32_16x16x32_bf16 v[56:59], v[212:215], v[192:195], v[56:59]
  ds_read_b64_tr_b16 v[208:209], v232 offset:12288
  v_mfma_f32_16x16x32_bf16 v[60:63], v[212:215], v[196:199], v[60:63]
  ds_read_b64_tr_b16 v[210:211], v232 offset:18432
  s_waitcnt lgkmcnt(8)
  v_mfma_f32_16x16x32_bf16 v[64:67], v[216:219], v[192:195], v[64:67]
  ds_read_b64_tr_b16 v[212:213], v233 offset:12288
  v_mfma_f32_16x16x32_bf16 v[68:71], v[216:219], v[196:199], v[68:71]
  ds_read_b64_tr_b16 v[214:215], v233 offset:18432
  s_waitcnt lgkmcnt(8)
  v_mfma_f32_16x16x32_bf16 v[72:75], v[220:223], v[192:195], v[72:75]
  ds_read_b64_tr_b16 v[216:217], v234 offset:12288
  v_mfma_f32_16x16x32_bf16 v[76:79], v[220:223], v[196:199], v[76:79]
  ds_read_b64_tr_b16 v[218:219], v234 offset:18432
  s_waitcnt lgkmcnt(8)
  v_mfma_f32_16x16x32_bf16 v[80:83], v[224:227], v[192:195], v[80:83]
  ds_read_b64_tr_b16 v[220:221], v235 offset:12288
  v_mfma_f32_16x16x32_bf16 v[84:87], v[224:227], v[196:199], v[84:87]
  ds_read_b64_tr_b16 v[222:223], v235 offset:18432
  s_waitcnt lgkmcnt(8)
  v_mfma_f32_16x16x32_bf16 v[88:91], v[228:231], v[192:195], v[88:91]
  ds_read_b64_tr_b16 v[224:225], v232 offset:12416
  v_mfma_f32_16x16x32_bf16 v[92:95], v[228:231], v[196:199], v[92:95]
  ds_read_b64_tr_b16 v[226:227], v232 offset:18560
  s_waitcnt lgkmcnt(8)
  v_mfma_f32_16x16x32_bf16 v[0:3], v[208:211], v[200:203], v[0:3]
  ds_read_b64_tr_b16 v[228:229], v233 offset:12416
  v_mfma_f32_16x16x32_bf16 v[4:7], v[208:211], v[204:207], v[4:7]
  ds_read_b64_tr_b16 v[230:231], v233 offset:18560
  s_waitcnt lgkmcnt(8)
  v_mfma_f32_16x16x32_bf16 v[8:11], v[212:215], v[200:203], v[8:11]
  ds_read_b64_tr_b16 v[208:209], v234 offset:12416
  v_mfma_f32_16x16x32_bf16 v[12:15], v[212:215], v[204:207], v[12:15]
  ds_read_b64_tr_b16 v[210:211], v234 offset:18560
  s_waitcnt lgkmcnt(8)
  v_mfma_f32_16x16x32_bf16 v[16:19], v[216:219], v[200:203], v[16:19]
  ds_read_b64_tr_b16 v[212:213], v235 offset:12416
  v_mfma_f32_16x16x32_bf16 v[20:23], v[216:219], v[204:207], v[20:23]
  ds_read_b64_tr_b16 v[214:215], v235 offset:18560
  s_waitcnt lgkmcnt(8)
  v_mfma_f32_16x16x32_bf16 v[24:27], v[220:223], v[200:203], v[24:27]
  ds_read_b64_tr_b16 v[216:217], v232 offset:12544
  v_mfma_f32_16x16x32_bf16 v[28:31], v[220:223], v[204:207], v[28:31]
  ds_read_b64_tr_b16 v[218:219], v232 offset:18688
  s_waitcnt lgkmcnt(8)
  v_mfma_f32_16x16x32_bf16 v[32:35], v[224:227], v[200:203], v[32:35]
  ds_read_b64_tr_b16 v[220:221], v233 offset:12544
  v_mfma_f32_16x16x32_bf16 v[36:39], v[224:227], v[204:207], v[36:39]
  ds_read_b64_tr_b16 v[222:223], v233 offset:18688
  s_waitcnt lgkmcnt(8)
  v_mfma_f32_16x16x32_bf16 v[40:43], v[228:231], v[200:203], v[40:43]
  ds_read_b64_tr_b16 v[224:225], v234 offset:12544
  v_mfma_f32_16x16x32_bf16 v[44:47], v[228:231], v[204:207], v[44:47]
  ds_read_b64_tr_b16 v[226:227], v234 offset:18688
  s_waitcnt lgkmcnt(8)
  v_mfma_f32_16x16x32_bf16 v[48:51], v[208:211], v[200:203], v[48:51]
  ds_read_b64_tr_b16 v[228:229], v235 offset:12544
  v_mfma_f32_16x16x32_bf16 v[52:55], v[208:211], v[204:207], v[52:55]
  ds_read_b64_tr_b16 v[230:231], v235 offset:18688
  s_waitcnt lgkmcnt(8)
  v_mfma_f32_16x16x32_bf16 v[56:59], v[212:215], v[200:203], v[56:59]
  ds_read_b64_tr_b16 v[208:209], v254 offset:0
  v_mfma_f32_16x16x32_bf16 v[60:63], v[212:215], v[204:207], v[60:63]
  ds_read_b64_tr_b16 v[210:211], v254 offset:1024
  s_waitcnt lgkmcnt(8)
  v_mfma_f32_16x16x32_bf16 v[64:67], v[216:219], v[200:203], v[64:67]
  ds_read_b64_tr_b16 v[212:213], v254 offset:32
  v_mfma_f32_16x16x32_bf16 v[68:71], v[216:219], v[204:207], v[68:71]
  ds_read_b64_tr_b16 v[214:215], v254 offset:1056
  s_waitcnt lgkmcnt(8)
  v_mfma_f32_16x16x32_bf16 v[72:75], v[220:223], v[200:203], v[72:75]
  ds_read_b64_tr_b16 v[216:217], v254 offset:2048
  v_mfma_f32_16x16x32_bf16 v[76:79], v[220:223], v[204:207], v[76:79]
  ds_read_b64_tr_b16 v[218:219], v254 offset:3072
  s_waitcnt lgkmcnt(8)
  v_mfma_f32_16x16x32_bf16 v[80:83], v[224:227], v[200:203], v[80:83]
  ds_read_b64_tr_b16 v[220:221], v254 offset:2080
  v_mfma_f32_16x16x32_bf16 v[84:87], v[224:227], v[204:207], v[84:87]
  ds_read_b64_tr_b16 v[222:223], v254 offset:3104
  s_waitcnt lgkmcnt(8)
  v_mfma_f32_16x16x32_bf16 v[88:91], v[228:231], v[200:203], v[88:91]
  v_mfma_f32_16x16x32_bf16 v[92:95], v[228:231], v[204:207], v[92:95]
  s_waitcnt lgkmcnt(6)
  v_mfma_f32_16x16x32_bf16 v[144:147], v[208:211], v[192:195], v[144:147]
  v_mfma_f32_16x16x32_bf16 v[148:151], v[208:211], v[196:199], v[148:151]
  s_waitcnt lgkmcnt(4)
  v_mfma_f32_16x16x32_bf16 v[152:155], v[212:215], v[192:195], v[152:155]
  v_mfma_f32_16x16x32_bf16 v[156:159], v[212:215], v[196:199], v[156:159]
  s_waitcnt lgkmcnt(2)
  v_mfma_f32_16x16x32_bf16 v[144:147], v[216:219], v[200:203], v[144:147]
  v_mfma_f32_16x16x32_bf16 v[148:151], v[216:219], v[204:207], v[148:151]
  s_waitcnt lgkmcnt(0)
  v_mfma_f32_16x16x32_bf16 v[152:155], v[220:223], v[200:203], v[152:155]
  v_mfma_f32_16x16x32_bf16 v[156:159], v[220:223], v[204:207], v[156:159]
L_skipE_B8:
  s_waitcnt vmcnt(0)
  s_mov_b32 s38, s37
  s_add_u32 s37, s37, 49152
  s_cmp_eq_u32 s37, 147456
  s_cselect_b32 s37, 0, s37
  s_sub_u32 s42, s37, s38
  v_add_u32 v232, s42, v232
  v_add_u32 v233, s42, v233
  v_add_u32 v234, s42, v234
  v_add_u32 v235, s42, v235
  v_add_u32 v254, s42, v254
  s_barrier
  s_add_u32 s43, s68, s38
  s_mov_b32 s40, 0
  s_add_u32 m0, s43, 24576
  s_nop 0
  buffer_load_dwordx4 v240, s[8:11], s40 offen lds
  s_add_u32 m0, s43, 25600
  s_nop 0
  buffer_load_dwordx4 v241, s[8:11], s40 offen lds
  s_add_u32 m0, s43, 26624
  s_nop 0
  buffer_load_dwordx4 v242, s[8:11], s40 offen lds
  s_add_u32 s69, s40, 12288
  s_add_u32 m0, s43, 36864
  s_nop 0
  buffer_load_dwordx4 v240, s[8:11], s69 offen lds
  s_add_u32 m0, s43, 37888
  s_nop 0
  buffer_load_dwordx4 v241, s[8:11], s69 offen lds
  s_add_u32 m0, s43, 38912
  s_nop 0
  buffer_load_dwordx4 v242, s[8:11], s69 offen lds
  s_cmp_eq_u32 s65, 0
  s_cbranch_scc1 L_skipB_B9
  ds_read_b64_tr_b16 v[208:209], v232 offset:0
  ds_read_b64_tr_b16 v[210:211], v232 offset:6144
  ds_read_b64_tr_b16 v[212:213], v233 offset:0
  ds_read_b64_tr_b16 v[214:215], v233 offset:6144
  ds_read_b64_tr_b16 v[216:217], v234 offset:0
  ds_read_b64_tr_b16 v[218:219], v234 offset:6144
  ds_read_b64_tr_b16 v[220:221], v235 offset:0
  ds_read_b64_tr_b16 v[222:223], v235 offset:6144
  ds_read_b64_tr_b16 v[224:225], v232 offset:128
  ds_read_b64_tr_b16 v[226:227], v232 offset:6272
  s_waitcnt lgkmcnt(8)
  v_mfma_f32_16x16x32_bf16 v[0:3], v[208:211], v[96:99], v[0:3]
  ds_read_b64_tr_b16 v[228:229], v233 offset:128
  v_mfma_f32_16x16x32_bf16 v[4:7], v[208:211], v[100:103], v[4:7]
  ds_read_b64_tr_b16 v[230:231], v233 offset:6272
  s_waitcnt lgkmcnt(8)
  v_mfma_f32_16x16x32_bf16 v[8:11], v[212:215], v[96:99], v[8:11]
  ds_read_b64_tr_b16 v[208:209], v234 offset:128
  v_mfma_f32_16x16x32_bf16 v[12:15], v[212:215], v[100:103], v[12:15]
  ds_read_b64_tr_b16 v[210:211], v234 offset:6272
  s_waitcnt lgkmcnt(8)
  v_mfma_f32_16x16x32_bf16 v[16:19], v[216:219], v[96:99], v[16:19]
  ds_read_b64_tr_b16 v[212:213], v235 offset:128
  v_mfma_f32_16x16x32_bf16 v[20:23], v[216:219], v[100:103], v[20:23]
  ds_read_b64_tr_b16 v[214:215], v235 offset:6272
  s_waitcnt lgkmcnt(8)
  v_mfma_f32_16x16x32_bf16 v[24:27], v[220:223], v[96:99], v[24:27]
  ds_read_b64_tr_b16 v[216:217], v232 offset:256
  v_mfma_f32_16x16x32_bf16 v[28:31], v[220:223], v[100:103], v[28:31]
  ds_read_b64_tr_b16 v[218:219], v232 offset:6400
  s_waitcnt lgkmcnt(8)
  v_mfma_f32_16x16x32_bf16 v[32:35], v[224:227], v[96:99], v[32:35]
  ds_read_b64_tr_b16 v[220:221], v233 offset:256
  v_mfma_f32_16x16x32_bf16 v[36:39], v[224:227], v[100:103], v[36:39]
  ds_read_b64_tr_b16 v[222:223], v233 offset:6400
  s_waitcnt lgkmcnt(8)
  v_mfma_f32_16x16x32_bf16 v[40:43], v[228:231], v[96:99], v[40:43]
  ds_read_b64_tr_b16 v[224:225], v234 offset:256
  v_mfma_f32_16x16x32_bf16 v[44:47], v[228:231], v[100:103], v[44:47]
  ds_read_b64_tr_b16 v[226:227], v234 offset:6400
  s_waitcnt lgkmcnt(8)
  v_mfma_f32_16x16x32_bf16 v[48:51], v[208:211], v[96:99], v[48:51]
  ds_read_b64_tr_b16 v[228:229], v235 offset:256
  v_mfma_f32_16x16x32_bf16 v[52:55], v[208:211], v[100:103], v[52:55]
  ds_read_b64_tr_b16 v[230:231], v235 offset:6400
  s_waitcnt lgkmcnt(8)
  v_mfma_f32_16x16x32_bf16 v[56:59], v[212:215], v[96:99], v[56:59]
  ds_read_b64_tr_b16 v[208:209], v232 offset:12288
  v_mfma_f32_16x16x32_bf16 v[60:63], v[212:215], v[100:103], v[60:63]
  ds_read_b64_tr_b16 v[210:211], v232 offset:18432
  s_waitcnt lgkmcnt(8)
  v_mfma_f32_16x16x32_bf16 v[64:67], v[216:219], v[96:99], v[64:67]
  ds_read_b64_tr_b16 v[212:213], v233 offset:12288
  v_mfma_f32_16x16x32_bf16 v[68:71], v[216:219], v[100:103], v[68:71]
  ds_read_b64_tr_b16 v[214:215], v233 offset:18432
  s_waitcnt lgkmcnt(8)
  v_mfma_f32_16x16x32_bf16 v[72:75], v[220:223], v[96:99], v[72:75]
  ds_read_b64_tr_b16 v[216:217], v234 offset:12288
  v_mfma_f32_16x16x32_bf16 v[76:79], v[220:223], v[100:103], v[76:79]
  ds_read_b64_tr_b16 v[218:219], v234 offset:18432
  s_waitcnt lgkmcnt(8)
  v_mfma_f32_16x16x32_bf16 v[80:83], v[224:227], v[96:99], v[80:83]
  ds_read_b64_tr_b16 v[220:221], v235 offset:12288
  v_mfma_f32_16x16x32_bf16 v[84:87], v[224:227], v[100:103], v[84:87]
  ds_read_b64_tr_b16 v[222:223], v235 offset:18432
  s_waitcnt lgkmcnt(8)
  v_mfma_f32_16x16x32_bf16 v[88:91], v[228:231], v[96:99], v[88:91]
  ds_read_b64_tr_b16 v[224:225], v232 offset:12416
  v_mfma_f32_16x16x32_bf16 v[92:95], v[228:231], v[100:103], v[92:95]
  ds_read_b64_tr_b16 v[226:227], v232 offset:18560
  s_waitcnt lgkmcnt(8)
  v_mfma_f32_16x16x32_bf16 v[0:3], v[208:211], v[104:107], v[0:3]
  ds_read_b64_tr_b16 v[228:229], v233 offset:12416
  v_mfma_f32_16x16x32_bf16 v[4:7], v[208:211], v[108:111], v[4:7]
  ds_read_b64_tr_b16 v[230:231], v233 offset:18560
  s_waitcnt lgkmcnt(8)
  v_mfma_f32_16x16x32_bf16 v[8:11], v[212:215], v[104:107], v[8:11]
  ds_read_b64_tr_b16 v[208:209], v234 offset:12416
  v_mfma_f32_16x16x32_bf16 v[12:15], v[212:215], v[108:111], v[12:15]
  ds_read_b64_tr_b16 v[210:211], v234 offset:18560
  s_waitcnt lgkmcnt(8)
  v_mfma_f32_16x16x32_bf16 v[16:19], v[216:219], v[104:107], v[16:19]
  ds_read_b64_tr_b16 v[212:213], v235 offset:12416
  v_mfma_f32_16x16x32_bf16 v[20:23], v[216:219], v[108:111], v[20:23]
  ds_read_b64_tr_b16 v[214:215], v235 offset:18560
  s_waitcnt lgkmcnt(8)
  v_mfma_f32_16x16x32_bf16 v[24:27], v[220:223], v[104:107], v[24:27]
  ds_read_b64_tr_b16 v[216:217], v232 offset:12544
  v_mfma_f32_16x16x32_bf16 v[28:31], v[220:223], v[108:111], v[28:31]
  ds_read_b64_tr_b16 v[218:219], v232 offset:18688
  s_waitcnt lgkmcnt(8)
  v_mfma_f32_16x16x32_bf16 v[32:35], v[224:227], v[104:107], v[32:35]
  ds_read_b64_tr_b16 v[220:221], v233 offset:12544
  v_mfma_f32_16x16x32_bf16 v[36:39], v[224:227], v[108:111], v[36:39]
  ds_read_b64_tr_b16 v[222:223], v233 offset:18688
  s_waitcnt lgkmcnt(8)
  v_mfma_f32_16x16x32_bf16 v[40:43], v[228:231], v[104:107], v[40:43]
  ds_read_b64_tr_b16 v[224:225], v234 offset:12544
  v_mfma_f32_16x16x32_bf16 v[44:47], v[228:231], v[108:111], v[44:47]
  ds_read_b64_tr_b16 v[226:227], v234 offset:18688
  s_waitcnt lgkmcnt(8)
  v_mfma_f32_16x16x32_bf16 v[48:51], v[208:211], v[104:107], v[48:51]
  ds_read_b64_tr_b16 v[228:229], v235 offset:12544
  v_mfma_f32_16x16x32_bf16 v[52:55], v[208:211], v[108:111], v[52:55]
  ds_read_b64_tr_b16 v[230:231], v235 offset:18688
  s_waitcnt lgkmcnt(8)
  v_mfma_f32_16x16x32_bf16 v[56:59], v[212:215], v[104:107], v[56:59]
  ds_read_b64_tr_b16 v[208:209], v254 offset:0
  v_mfma_f32_16x16x32_bf16 v[60:63], v[212:215], v[108:111], v[60:63]
  ds_read_b64_tr_b16 v[210:211], v254 offset:1024
  s_waitcnt lgkmcnt(8)
  v_mfma_f32_16x16x32_bf16 v[64:67], v[216:219], v[104:107], v[64:67]
  ds_read_b64_tr_b16 v[212:213], v254 offset:32
  v_mfma_f32_16x16x32_bf16 v[68:71], v[216:219], v[108:111], v[68:71]
  ds_read_b64_tr_b16 v[214:215], v254 offset:1056
  s_waitcnt lgkmcnt(8)
  v_mfma_f32_16x16x32_bf16 v[72:75], v[220:223], v[104:107], v[72:75]
  ds_read_b64_tr_b16 v[216:217], v254 offset:2048
  v_mfma_f32_16x16x32_bf16 v[76:79], v[220:223], v[108:111], v[76:79]
  ds_read_b64_tr_b16 v[218:219], v254 offset:3072
  s_waitcnt lgkmcnt(8)
  v_mfma_f32_16x16x32_bf16 v[80:83], v[224:227], v[104:107], v[80:83]
  ds_read_b64_tr_b16 v[220:221], v254 offset:2080
  v_mfma_f32_16x16x32_bf16 v[84:87], v[224:227], v[108:111], v[84:87]
  ds_read_b64_tr_b16 v[222:223], v254 offset:3104
  s_waitcnt lgkmcnt(8)
  v_mfma_f32_16x16x32_bf16 v[88:91], v[228:231], v[104:107], v[88:91]
  ds_read_b64_tr_b16 v[224:225], v254 offset:4096
  v_mfma_f32_16x16x32_bf16 v[92:95], v[228:231], v[108:111], v[92:95]
  ds_read_b64_tr_b16 v[226:227], v254 offset:5120
  s_waitcnt lgkmcnt(8)
  v_mfma_f32_16x16x32_bf16 v[144:147], v[208:211], v[96:99], v[144:147]
  ds_read_b64_tr_b16 v[228:229], v254 offset:4128
  v_mfma_f32_16x16x32_bf16 v[148:151], v[208:211], v[100:103], v[148:151]
  ds_read_b64_tr_b16 v[230:231], v254 offset:5152
  s_waitcnt lgkmcnt(8)
  v_mfma_f32_16x16x32_bf16 v[152:155], v[212:215], v[96:99], v[152:155]
  ds_read_b64_tr_b16 v[208:209], v254 offset:6144
  v_mfma_f32_16x16x32_bf16 v[156:159], v[212:215], v[100:103], v[156:159]
  ds_read_b64_tr_b16 v[210:211], v254 offset:7168
  s_waitcnt lgkmcnt(8)
  v_mfma_f32_16x16x32_bf16 v[144:147], v[216:219], v[104:107], v[144:147]
  ds_read_b64_tr_b16 v[212:213], v254 offset:6176
  v_mfma_f32_16x16x32_bf16 v[148:151], v[216:219], v[108:111], v[148:151]
  ds_read_b64_tr_b16 v[214:215], v254 offset:7200
  s_waitcnt lgkmcnt(8)
  v_mfma_f32_16x16x32_bf16 v[152:155], v[220:223], v[104:107], v[152:155]
  v_mfma_f32_16x16x32_bf16 v[156:159], v[220:223], v[108:111], v[156:159]
  s_waitcnt lgkmcnt(6)
  v_mfma_f32_16x16x32_bf16 v[160:163], v[224:227], v[96:99], v[160:163]
  v_mfma_f32_16x16x32_bf16 v[164:167], v[224:227], v[100:103], v[164:167]
  s_waitcnt lgkmcnt(4)
  v_mfma_f32_16x16x32_bf16 v[168:171], v[228:231], v[96:99], v[168:171]
  v_mfma_f32_16x16x32_bf16 v[172:175], v[228:231], v[100:103], v[172:175]
  s_waitcnt lgkmcnt(2)
  v_mfma_f32_16x16x32_bf16 v[160:163], v[208:211], v[104:107], v[160:163]
  v_mfma_f32_16x16x32_bf16 v[164:167], v[208:211], v[108:111], v[164:167]
  s_waitcnt lgkmcnt(0)
  v_mfma_f32_16x16x32_bf16 v[168:171], v[212:215], v[104:107], v[168:171]
  v_mfma_f32_16x16x32_bf16 v[172:175], v[212:215], v[108:111], v[172:175]
  s_branch L_skipE_B9
L_skipB_B9:
  ds_read_b64_tr_b16 v[208:209], v232 offset:0
  ds_read_b64_tr_b16 v[210:211], v232 offset:6144
  ds_read_b64_tr_b16 v[212:213], v233 offset:0
  ds_read_b64_tr_b16 v[214:215], v233 offset:6144
  ds_read_b64_tr_b16 v[216:217], v234 offset:0
  ds_read_b64_tr_b16 v[218:219], v234 offset:6144
  ds_read_b64_tr_b16 v[220:221], v235 offset:0
  ds_read_b64_tr_b16 v[222:223], v235 offset:6144
  ds_read_b64_tr_b16 v[224:225], v232 offset:128
  ds_read_b64_tr_b16 v[226:227], v232 offset:6272
  s_waitcnt lgkmcnt(8)
  v_mfma_f32_16x16x32_bf16 v[0:3], v[208:211], v[96:99], v[0:3]
  ds_read_b64_tr_b16 v[228:229], v233 offset:128
  v_mfma_f32_16x16x32_bf16 v[4:7], v[208:211], v[100:103], v[4:7]
  ds_read_b64_tr_b16 v[230:231], v233 offset:6272
  s_waitcnt lgkmcnt(8)
  v_mfma_f32_16x16x32_bf16 v[8:11], v[212:215], v[96:99], v[8:11]
  ds_read_b64_tr_b16 v[208:209], v234 offset:128
  v_mfma_f32_16x16x32_bf16 v[12:15], v[212:215], v[100:103], v[12:15]
  ds_read_b64_tr_b16 v[210:211], v234 offset:6272
  s_waitcnt lgkmcnt(8)
  v_mfma_f32_16x16x32_bf16 v[16:19], v[216:219], v[96:99], v[16:19]
  ds_read_b64_tr_b16 v[212:213], v235 offset:128
  v_mfma_f32_16x16x32_bf16 v[20:23], v[216:219], v[100:103], v[20:23]
  ds_read_b64_tr_b16 v[214:215], v235 offset:6272
  s_waitcnt lgkmcnt(8)
  v_mfma_f32_16x16x32_bf16 v[24:27], v[220:223], v[96:99], v[24:27]
  ds_read_b64_tr_b16 v[216:217], v232 offset:256
  v_mfma_f32_16x16x32_bf16 v[28:31], v[220:223], v[100:103], v[28:31]
  ds_read_b64_tr_b16 v[218:219], v232 offset:6400
  s_waitcnt lgkmcnt(8)
  v_mfma_f32_16x16x32_bf16 v[32:35], v[224:227], v[96:99], v[32:35]
  ds_read_b64_tr_b16 v[220:221], v233 offset:256
  v_mfma_f32_16x16x32_bf16 v[36:39], v[224:227], v[100:103], v[36:39]
  ds_read_b64_tr_b16 v[222:223], v233 offset:6400
  s_waitcnt lgkmcnt(8)
  v_mfma_f32_16x16x32_bf16 v[40:43], v[228:231], v[96:99], v[40:43]
  ds_read_b64_tr_b16 v[224:225], v234 offset:256
  v_mfma_f32_16x16x32_bf16 v[44:47], v[228:231], v[100:103], v[44:47]
  ds_read_b64_tr_b16 v[226:227], v234 offset:6400
  s_waitcnt lgkmcnt(8)
  v_mfma_f32_16x16x32_bf16 v[48:51], v[208:211], v[96:99], v[48:51]
  ds_read_b64_tr_b16 v[228:229], v235 offset:256
  v_mfma_f32_16x16x32_bf16 v[52:55], v[208:211], v[100:103], v[52:55]
  ds_read_b64_tr_b16 v[230:231], v235 offset:6400
  s_waitcnt lgkmcnt(8)
  v_mfma_f32_16x16x32_bf16 v[56:59], v[212:215], v[96:99], v[56:59]
  ds_read_b64_tr_b16 v[208:209], v232 offset:12288
  v_mfma_f32_16x16x32_bf16 v[60:63], v[212:215], v[100:103], v[60:63]
  ds_read_b64_tr_b16 v[210:211], v232 offset:18432
  s_waitcnt lgkmcnt(8)
  v_mfma_f32_16x16x32_bf16 v[64:67], v[216:219], v[96:99], v[64:67]
  ds_read_b64_tr_b16 v[212:213], v233 offset:12288
  v_mfma_f32_16x16x32_bf16 v[68:71], v[216:219], v[100:103], v[68:71]
  ds_read_b64_tr_b16 v[214:215], v233 offset:18432
  s_waitcnt lgkmcnt(8)
  v_mfma_f32_16x16x32_bf16 v[72:75], v[220:223], v[96:99], v[72:75]
  ds_read_b64_tr_b16 v[216:217], v234 offset:12288
  v_mfma_f32_16x16x32_bf16 v[76:79], v[220:223], v[100:103], v[76:79]
  ds_read_b64_tr_b16 v[218:219], v234 offset:18432
  s_waitcnt lgkmcnt(8)
  v_mfma_f32_16x16x32_bf16 v[80:83], v[224:227], v[96:99], v[80:83]
  ds_read_b64_tr_b16 v[220:221], v235 offset:12288
  v_mfma_f32_16x16x32_bf16 v[84:87], v[224:227], v[100:103], v[84:87]
  ds_read_b64_tr_b16 v[222:223], v235 offset:18432
  s_waitcnt lgkmcnt(8)
  v_mfma_f32_16x16x32_bf16 v[88:91], v[228:231], v[96:99], v[88:91]
  ds_read_b64_tr_b16 v[224:225], v232 offset:12416
  v_mfma_f32_16x16x32_bf16 v[92:95], v[228:231], v[100:103], v[92:95]
  ds_read_b64_tr_b16 v[226:227], v232 offset:18560
  s_waitcnt lgkmcnt(8)
  v_mfma_f32_16x16x32_bf16 v[0:3], v[208:211], v[104:107], v[0:3]
  ds_read_b64_tr_b16 v[228:229], v233 offset:12416
  v_mfma_f32_16x16x32_bf16 v[4:7], v[208:211], v[108:111], v[4:7]
  ds_read_b64_tr_b16 v[230:231], v233 offset:18560
  s_waitcnt lgkmcnt(8)
  v_mfma_f32_16x16x32_bf16 v[8:11], v[212:215], v[104:107], v[8:11]
  ds_read_b64_tr_b16 v[208:209], v234 offset:12416
  v_mfma_f32_16x16x32_bf16 v[12:15], v[212:215], v[108:111], v[12:15]
  ds_read_b64_tr_b16 v[210:211], v234 offset:18560
  s_waitcnt lgkmcnt(8)
  v_mfma_f32_16x16x32_bf16 v[16:19], v[216:219], v[104:107], v[16:19]
  ds_read_b64_tr_b16 v[212:213], v235 offset:12416
  v_mfma_f32_16x16x32_bf16 v[20:23], v[216:219], v[108:111], v[20:23]
  ds_read_b64_tr_b16 v[214:215], v235 offset:18560
  s_waitcnt lgkmcnt(8)
  v_mfma_f32_16x16x32_bf16 v[24:27], v[220:223], v[104:107], v[24:27]
  ds_read_b64_tr_b16 v[216:217], v232 offset:12544
  v_mfma_f32_16x16x32_bf16 v[28:31], v[220:223], v[108:111], v[28:31]
  ds_read_b64_tr_b16 v[218:219], v232 offset:18688
  s_waitcnt lgkmcnt(8)
  v_mfma_f32_16x16x32_bf16 v[32:35], v[224:227], v[104:107], v[32:35]
  ds_read_b64_tr_b16 v[220:221], v233 offset:12544
  v_mfma_f32_16x16x32_bf16 v[36:39], v[224:227], v[108:111], v[36:39]
  ds_read_b64_tr_b16 v[222:223], v233 offset:18688
  s_waitcnt lgkmcnt(8)
  v_mfma_f32_16x16x32_bf16 v[40:43], v[228:231], v[104:107], v[40:43]
  ds_read_b64_tr_b16 v[224:225], v234 offset:12544
  v_mfma_f32_16x16x32_bf16 v[44:47], v[228:231], v[108:111], v[44:47]
  ds_read_b64_tr_b16 v[226:227], v234 offset:18688
  s_waitcnt lgkmcnt(8)
  v_mfma_f32_16x16x32_bf16 v[48:51], v[208:211], v[104:107], v[48:51]
  ds_read_b64_tr_b16 v[228:229], v235 offset:12544
  v_mfma_f32_16x16x32_bf16 v[52:55], v[208:211], v[108:111], v[52:55]
  ds_read_b64_tr_b16 v[230:231], v235 offset:18688
  s_waitcnt lgkmcnt(8)
  v_mfma_f32_16x16x32_bf16 v[56:59], v[212:215], v[104:107], v[56:59]
  ds_read_b64_tr_b16 v[208:209], v254 offset:0
  v_mfma_f32_16x16x32_bf16 v[60:63], v[212:215], v[108:111], v[60:63]
  ds_read_b64_tr_b16 v[210:211], v254 offset:1024
  s_waitcnt lgkmcnt(8)
  v_mfma_f32_16x16x32_bf16 v[64:67], v[216:219], v[104:107], v[64:67]
  ds_read_b64_tr_b16 v[212:213], v254 offset:32
  v_mfma_f32_16x16x32_bf16 v[68:71], v[216:219], v[108:111], v[68:71]
  ds_read_b64_tr_b16 v[214:215], v254 offset:1056
  s_waitcnt lgkmcnt(8)
  v_mfma_f32_16x16x32_bf16 v[72:75], v[220:223], v[104:107], v[72:75]
  ds_read_b64_tr_b16 v[216:217], v254 offset:2048
  v_mfma_f32_16x16x32_bf16 v[76:79], v[220:223], v[108:111], v[76:79]
  ds_read_b64_tr_b16 v[218:219], v254 offset:3072
  s_waitcnt lgkmcnt(8)
  v_mfma_f32_16x16x32_bf16 v[80:83], v[224:227], v[104:107], v[80:83]
  ds_read_b64_tr_b16 v[220:221], v254 offset:2080
  v_mfma_f32_16x16x32_bf16 v[84:87], v[224:227], v[108:111], v[84:87]
  ds_read_b64_tr_b16 v[222:223], v254 offset:3104
  s_waitcnt lgkmcnt(8)
  v_mfma_f32_16x16x32_bf16 v[88:91], v[228:231], v[104:107], v[88:91]
  v_mfma_f32_16x16x32_bf16 v[92:95], v[228:231], v[108:111], v[92:95]
  s_waitcnt lgkmcnt(6)
  v_mfma_f32_16x16x32_bf16 v[144:147], v[208:211], v[96:99], v[144:147]
  v_mfma_f32_16x16x32_bf16 v[148:151], v[208:211], v[100:103], v[148:151]
  s_waitcnt lgkmcnt(4)
  v_mfma_f32_16x16x32_bf16 v[152:155], v[212:215], v[96:99], v[152:155]
  v_mfma_f32_16x16x32_bf16 v[156:159], v[212:215], v[100:103], v[156:159]
  s_waitcnt lgkmcnt(2)
  v_mfma_f32_16x16x32_bf16 v[144:147], v[216:219], v[104:107], v[144:147]
  v_mfma_f32_16x16x32_bf16 v[148:151], v[216:219], v[108:111], v[148:151]
  s_waitcnt lgkmcnt(0)
  v_mfma_f32_16x16x32_bf16 v[152:155], v[220:223], v[104:107], v[152:155]
  v_mfma_f32_16x16x32_bf16 v[156:159], v[220:223], v[108:111], v[156:159]
L_skipE_B9:
  s_waitcnt vmcnt(0)
  s_mov_b32 s38, s37
  s_add_u32 s37, s37, 49152
  s_cmp_eq_u32 s37, 147456
  s_cselect_b32 s37, 0, s37
  s_sub_u32 s42, s37, s38
  v_add_u32 v232, s42, v232
  v_add_u32 v233, s42, v233
  v_add_u32 v234, s42, v234
  v_add_u32 v235, s42, v235
  v_add_u32 v254, s42, v254
  s_barrier
L_conv:
  s_nop 7
  s_mov_b32 s56, 0x3dd53b95
  s_mov_b32 s57, 0x3dd53b95
  s_mul_i32 s62, s32, 4608
  s_add_u32 s62, s62, s38
  v_lshrrev_b32 v208, 4, v251
  v_and_b32 v209, 15, v208
  v_lshrrev_b32 v210, 4, v208
  v_bfe_u32 v211, v208, 2, 2
  v_and_b32 v212, 3, v208
  s_movk_i32 s63, 144
  v_mul_lo_u32 v214, v209, s63
  v_add_u32 v214, s62, v214
  v_lshl_add_u32 v218, v210, 3, v214
  v_lshl_add_u32 v219, v210, 4, v214
  v_pk_mul_f32 v[0:1], v[0:1], s[56:57]
  v_pk_mul_f32 v[2:3], v[2:3], s[56:57]
  v_cvt_pk_bf16_f32 v0, v0, v1
  v_cvt_pk_bf16_f32 v1, v2, v3
  ds_write_b64 v218, v[0:1] offset:0
  v_pk_mul_f32 v[8:9], v[8:9], s[56:57]
  v_pk_mul_f32 v[10:11], v[10:11], s[56:57]
  v_cvt_pk_bf16_f32 v8, v8, v9
  v_cvt_pk_bf16_f32 v9, v10, v11
  ds_write_b64 v218, v[8:9] offset:32
  v_pk_mul_f32 v[16:17], v[16:17], s[56:57]
  v_pk_mul_f32 v[18:19], v[18:19], s[56:57]
  v_cvt_pk_bf16_f32 v16, v16, v17
  v_cvt_pk_bf16_f32 v17, v18, v19
  ds_write_b64 v218, v[16:17] offset:64
  v_pk_mul_f32 v[24:25], v[24:25], s[56:57]
  v_pk_mul_f32 v[26:27], v[26:27], s[56:57]
  v_cvt_pk_bf16_f32 v24, v24, v25
  v_cvt_pk_bf16_f32 v25, v26, v27
  ds_write_b64 v218, v[24:25] offset:96
  v_pk_mul_f32 v[4:5], v[4:5], s[56:57]
  v_pk_mul_f32 v[6:7], v[6:7], s[56:57]
  v_cvt_pk_bf16_f32 v4, v4, v5
  v_cvt_pk_bf16_f32 v5, v6, v7
  ds_write_b64 v218, v[4:5] offset:2304
  v_pk_mul_f32 v[12:13], v[12:13], s[56:57]
  v_pk_mul_f32 v[14:15], v[14:15], s[56:57]
  v_cvt_pk_bf16_f32 v12, v12, v13
  v_cvt_pk_bf16_f32 v13, v14, v15
  ds_write_b64 v218, v[12:13] offset:2336
  v_pk_mul_f32 v[20:21], v[20:21], s[56:57]
  v_pk_mul_f32 v[22:23], v[22:23], s[56:57]
  v_cvt_pk_bf16_f32 v20, v20, v21
  v_cvt_pk_bf16_f32 v21, v22, v23
  ds_write_b64 v218, v[20:21] offset:2368
  v_pk_mul_f32 v[28:29], v[28:29], s[56:57]
  v_pk_mul_f32 v[30:31], v[30:31], s[56:57]
  v_cvt_pk_bf16_f32 v28, v28, v29
  v_cvt_pk_bf16_f32 v29, v30, v31
  ds_write_b64 v218, v[28:29] offset:2400
  s_waitcnt lgkmcnt(0)
  ds_read_b128 v[96:99], v219 offset:0
  ds_read_b128 v[104:107], v219 offset:64
  ds_read_b128 v[100:103], v219 offset:2304
  ds_read_b128 v[108:111], v219 offset:2368
  s_waitcnt lgkmcnt(0)
  v_pk_mul_f32 v[32:33], v[32:33], s[56:57]
  v_pk_mul_f32 v[34:35], v[34:35], s[56:57]
  v_cvt_pk_bf16_f32 v32, v32, v33
  v_cvt_pk_bf16_f32 v33, v34, v35
  ds_write_b64 v218, v[32:33] offset:0
  v_pk_mul_f32 v[40:41], v[40:41], s[56:57]
  v_pk_mul_f32 v[42:43], v[42:43], s[56:57]
  v_cvt_pk_bf16_f32 v40, v40, v41
  v_cvt_pk_bf16_f32 v41, v42, v43
  ds_write_b64 v218, v[40:41] offset:32
  v_pk_mul_f32 v[48:49], v[48:49], s[56:57]
  v_pk_mul_f32 v[50:51], v[50:51], s[56:57]
  v_cvt_pk_bf16_f32 v48, v48, v49
  v_cvt_pk_bf16_f32 v49, v50, v51
  ds_write_b64 v218, v[48:49] offset:64
  v_pk_mul_f32 v[56:57], v[56:57], s[56:57]
  v_pk_mul_f32 v[58:59], v[58:59], s[56:57]
  v_cvt_pk_bf16_f32 v56, v56, v57
  v_cvt_pk_bf16_f32 v57, v58, v59
  ds_write_b64 v218, v[56:57] offset:96
  v_pk_mul_f32 v[36:37], v[36:37], s[56:57]
  v_pk_mul_f32 v[38:39], v[38:39], s[56:57]
  v_cvt_pk_bf16_f32 v36, v36, v37
  v_cvt_pk_bf16_f32 v37, v38, v39
  ds_write_b64 v218, v[36:37] offset:2304
  v_pk_mul_f32 v[44:45], v[44:45], s[56:57]
  v_pk_mul_f32 v[46:47], v[46:47], s[56:57]
  v_cvt_pk_bf16_f32 v44, v44, v45
  v_cvt_pk_bf16_f32 v45, v46, v47
  ds_write_b64 v218, v[44:45] offset:2336
  v_pk_mul_f32 v[52:53], v[52:53], s[56:57]
  v_pk_mul_f32 v[54:55], v[54:55], s[56:57]
  v_cvt_pk_bf16_f32 v52, v52, v53
  v_cvt_pk_bf16_f32 v53, v54, v55
  ds_write_b64 v218, v[52:53] offset:2368
  v_pk_mul_f32 v[60:61], v[60:61], s[56:57]
  v_pk_mul_f32 v[62:63], v[62:63], s[56:57]
  v_cvt_pk_bf16_f32 v60, v60, v61
  v_cvt_pk_bf16_f32 v61, v62, v63
  ds_write_b64 v218, v[60:61] offset:2400
  s_waitcnt lgkmcnt(0)
  ds_read_b128 v[112:115], v219 offset:0
  ds_read_b128 v[120:123], v219 offset:64
  ds_read_b128 v[116:119], v219 offset:2304
  ds_read_b128 v[124:127], v219 offset:2368
  s_waitcnt lgkmcnt(0)
  v_pk_mul_f32 v[64:65], v[64:65], s[56:57]
  v_pk_mul_f32 v[66:67], v[66:67], s[56:57]
  v_cvt_pk_bf16_f32 v64, v64, v65
  v_cvt_pk_bf16_f32 v65, v66, v67
  ds_write_b64 v218, v[64:65] offset:0
  v_pk_mul_f32 v[72:73], v[72:73], s[56:57]
  v_pk_mul_f32 v[74:75], v[74:75], s[56:57]
  v_cvt_pk_bf16_f32 v72, v72, v73
  v_cvt_pk_bf16_f32 v73, v74, v75
  ds_write_b64 v218, v[72:73] offset:32
  v_pk_mul_f32 v[80:81], v[80:81], s[56:57]
  v_pk_mul_f32 v[82:83], v[82:83], s[56:57]
  v_cvt_pk_bf16_f32 v80, v80, v81
  v_cvt_pk_bf16_f32 v81, v82, v83
  ds_write_b64 v218, v[80:81] offset:64
  v_pk_mul_f32 v[88:89], v[88:89], s[56:57]
  v_pk_mul_f32 v[90:91], v[90:91], s[56:57]
  v_cvt_pk_bf16_f32 v88, v88, v89
  v_cvt_pk_bf16_f32 v89, v90, v91
  ds_write_b64 v218, v[88:89] offset:96
  v_pk_mul_f32 v[68:69], v[68:69], s[56:57]
  v_pk_mul_f32 v[70:71], v[70:71], s[56:57]
  v_cvt_pk_bf16_f32 v68, v68, v69
  v_cvt_pk_bf16_f32 v69, v70, v71
  ds_write_b64 v218, v[68:69] offset:2304
  v_pk_mul_f32 v[76:77], v[76:77], s[56:57]
  v_pk_mul_f32 v[78:79], v[78:79], s[56:57]
  v_cvt_pk_bf16_f32 v76, v76, v77
  v_cvt_pk_bf16_f32 v77, v78, v79
  ds_write_b64 v218, v[76:77] offset:2336
  v_pk_mul_f32 v[84:85], v[84:85], s[56:57]
  v_pk_mul_f32 v[86:87], v[86:87], s[56:57]
  v_cvt_pk_bf16_f32 v84, v84, v85
  v_cvt_pk_bf16_f32 v85, v86, v87
  ds_write_b64 v218, v[84:85] offset:2368
  v_pk_mul_f32 v[92:93], v[92:93], s[56:57]
  v_pk_mul_f32 v[94:95], v[94:95], s[56:57]
  v_cvt_pk_bf16_f32 v92, v92, v93
  v_cvt_pk_bf16_f32 v93, v94, v95
  ds_write_b64 v218, v[92:93] offset:2400
  s_waitcnt lgkmcnt(0)
  ds_read_b128 v[128:131], v219 offset:0
  ds_read_b128 v[136:139], v219 offset:64
  ds_read_b128 v[132:135], v219 offset:2304
  ds_read_b128 v[140:143], v219 offset:2368
  s_waitcnt lgkmcnt(0)
  s_barrier
  v_mov_b64 v[0:1], 0
  v_mov_b64 v[2:3], 0
  v_mov_b64 v[4:5], 0
  v_mov_b64 v[6:7], 0
  v_mov_b64 v[8:9], 0
  v_mov_b64 v[10:11], 0
  v_mov_b64 v[12:13], 0
  v_mov_b64 v[14:15], 0
  v_mov_b64 v[16:17], 0
  v_mov_b64 v[18:19], 0
  v_mov_b64 v[20:21], 0
  v_mov_b64 v[22:23], 0
  v_mov_b64 v[24:25], 0
  v_mov_b64 v[26:27], 0
  v_mov_b64 v[28:29], 0
  v_mov_b64 v[30:31], 0
  v_mov_b64 v[32:33], 0
  v_mov_b64 v[34:35], 0
  v_mov_b64 v[36:37], 0
  v_mov_b64 v[38:39], 0
  v_mov_b64 v[40:41], 0
  v_mov_b64 v[42:43], 0
  v_mov_b64 v[44:45], 0
  v_mov_b64 v[46:47], 0
  v_mov_b64 v[48:49], 0
  v_mov_b64 v[50:51], 0
  v_mov_b64 v[52:53], 0
  v_mov_b64 v[54:55], 0
  v_mov_b64 v[56:57], 0
  v_mov_b64 v[58:59], 0
  v_mov_b64 v[60:61], 0
  v_mov_b64 v[62:63], 0
  v_mov_b64 v[64:65], 0
  v_mov_b64 v[66:67], 0
  v_mov_b64 v[68:69], 0
  v_mov_b64 v[70:71], 0
  v_mov_b64 v[72:73], 0
  v_mov_b64 v[74:75], 0
  v_mov_b64 v[76:77], 0
  v_mov_b64 v[78:79], 0
  v_mov_b64 v[80:81], 0
  v_mov_b64 v[82:83], 0
  v_mov_b64 v[84:85], 0
  v_mov_b64 v[86:87], 0
  v_mov_b64 v[88:89], 0
  v_mov_b64 v[90:91], 0
  v_mov_b64 v[92:93], 0
  v_mov_b64 v[94:95], 0
  s_mov_b32 s62, 0xffff0000
  v_cvt_pk_bf16_f32 v219, v144, v145
  v_lshlrev_b32 v144, 16, v219
  v_and_b32 v145, s62, v219
  v_lshlrev_b32 v217, 16, v176
  v_and_b32 v218, s62, v176
  v_add_f32 v144, v144, v217
  v_add_f32 v145, v145, v218
  v_cvt_pk_bf16_f32 v219, v144, v145
  v_lshlrev_b32 v144, 16, v219
  v_and_b32 v145, s62, v219
  v_max_f32 v144, 0, v144
  v_max_f32 v145, 0, v145
  v_mul_f32 v144, v144, v144
  v_mul_f32 v145, v145, v145
  v_cvt_pk_bf16_f32 v220, v144, v145
  v_cvt_pk_bf16_f32 v219, v146, v147
  v_lshlrev_b32 v146, 16, v219
  v_and_b32 v147, s62, v219
  v_lshlrev_b32 v217, 16, v177
  v_and_b32 v218, s62, v177
  v_add_f32 v146, v146, v217
  v_add_f32 v147, v147, v218
  v_cvt_pk_bf16_f32 v219, v146, v147
  v_lshlrev_b32 v146, 16, v219
  v_and_b32 v147, s62, v219
  v_max_f32 v146, 0, v146
  v_max_f32 v147, 0, v147
  v_mul_f32 v146, v146, v146
  v_mul_f32 v147, v147, v147
  v_cvt_pk_bf16_f32 v221, v146, v147
  v_cvt_pk_bf16_f32 v219, v152, v153
  v_lshlrev_b32 v152, 16, v219
  v_and_b32 v153, s62, v219
  v_lshlrev_b32 v217, 16, v178
  v_and_b32 v218, s62, v178
  v_add_f32 v152, v152, v217
  v_add_f32 v153, v153, v218
  v_cvt_pk_bf16_f32 v219, v152, v153
  v_lshlrev_b32 v152, 16, v219
  v_and_b32 v153, s62, v219
  v_max_f32 v152, 0, v152
  v_max_f32 v153, 0, v153
  v_mul_f32 v152, v152, v152
  v_mul_f32 v153, v153, v153
  v_cvt_pk_bf16_f32 v222, v152, v153
  v_cvt_pk_bf16_f32 v219, v154, v155
  v_lshlrev_b32 v154, 16, v219
  v_and_b32 v155, s62, v219
  v_lshlrev_b32 v217, 16, v179
  v_and_b32 v218, s62, v179
  v_add_f32 v154, v154, v217
  v_add_f32 v155, v155, v218
  v_cvt_pk_bf16_f32 v219, v154, v155
  v_lshlrev_b32 v154, 16, v219
  v_and_b32 v155, s62, v219
  v_max_f32 v154, 0, v154
  v_max_f32 v155, 0, v155
  v_mul_f32 v154, v154, v154
  v_mul_f32 v155, v155, v155
  v_cvt_pk_bf16_f32 v223, v154, v155
  s_lshl_b32 s42, s36, 10
  s_lshl_b32 s63, s33, 17
  s_add_u32 s42, s42, s63
  s_add_u32 s42, s42, 25165824
  buffer_store_dwordx4 v[220:223], v251, s[20:23], s42 offen offset:0
  v_cvt_pk_bf16_f32 v219, v148, v149
  v_lshlrev_b32 v148, 16, v219
  v_and_b32 v149, s62, v219
  v_lshlrev_b32 v217, 16, v176
  v_and_b32 v218, s62, v176
  v_add_f32 v148, v148, v217
  v_add_f32 v149, v149, v218
  v_cvt_pk_bf16_f32 v219, v148, v149
  v_lshlrev_b32 v148, 16, v219
  v_and_b32 v149, s62, v219
  v_max_f32 v148, 0, v148
  v_max_f32 v149, 0, v149
  v_mul_f32 v148, v148, v148
  v_mul_f32 v149, v149, v149
  v_cvt_pk_bf16_f32 v224, v148, v149
  v_cvt_pk_bf16_f32 v219, v150, v151
  v_lshlrev_b32 v150, 16, v219
  v_and_b32 v151, s62, v219
  v_lshlrev_b32 v217, 16, v177
  v_and_b32 v218, s62, v177
  v_add_f32 v150, v150, v217
  v_add_f32 v151, v151, v218
  v_cvt_pk_bf16_f32 v219, v150, v151
  v_lshlrev_b32 v150, 16, v219
  v_and_b32 v151, s62, v219
  v_max_f32 v150, 0, v150
  v_max_f32 v151, 0, v151
  v_mul_f32 v150, v150, v150
  v_mul_f32 v151, v151, v151
  v_cvt_pk_bf16_f32 v225, v150, v151
  v_cvt_pk_bf16_f32 v219, v156, v157
  v_lshlrev_b32 v156, 16, v219
  v_and_b32 v157, s62, v219
  v_lshlrev_b32 v217, 16, v178
  v_and_b32 v218, s62, v178
  v_add_f32 v156, v156, v217
  v_add_f32 v157, v157, v218
  v_cvt_pk_bf16_f32 v219, v156, v157
  v_lshlrev_b32 v156, 16, v219
  v_and_b32 v157, s62, v219
  v_max_f32 v156, 0, v156
  v_max_f32 v157, 0, v157
  v_mul_f32 v156, v156, v156
  v_mul_f32 v157, v157, v157
  v_cvt_pk_bf16_f32 v226, v156, v157
  v_cvt_pk_bf16_f32 v219, v158, v159
  v_lshlrev_b32 v158, 16, v219
  v_and_b32 v159, s62, v219
  v_lshlrev_b32 v217, 16, v179
  v_and_b32 v218, s62, v179
  v_add_f32 v158, v158, v217
  v_add_f32 v159, v159, v218
  v_cvt_pk_bf16_f32 v219, v158, v159
  v_lshlrev_b32 v158, 16, v219
  v_and_b32 v159, s62, v219
  v_max_f32 v158, 0, v158
  v_max_f32 v159, 0, v159
  v_mul_f32 v158, v158, v158
  v_mul_f32 v159, v159, v159
  v_cvt_pk_bf16_f32 v227, v158, v159
  s_lshl_b32 s42, s36, 10
  s_lshl_b32 s63, s33, 17
  s_add_u32 s42, s42, s63
  s_add_u32 s42, s42, 25165824
  buffer_store_dwordx4 v[224:227], v251, s[20:23], s42 offen offset:1024
  s_cmp_eq_u32 s65, 0
  s_cbranch_scc1 L_skipBeX
  s_mov_b32 s62, 0xffff0000
  v_cvt_pk_bf16_f32 v219, v160, v161
  v_lshlrev_b32 v160, 16, v219
  v_and_b32 v161, s62, v219
  v_lshlrev_b32 v217, 16, v180
  v_and_b32 v218, s62, v180
  v_add_f32 v160, v160, v217
  v_add_f32 v161, v161, v218
  v_cvt_pk_bf16_f32 v219, v160, v161
  v_lshlrev_b32 v160, 16, v219
  v_and_b32 v161, s62, v219
  v_max_f32 v160, 0, v160
  v_max_f32 v161, 0, v161
  v_mul_f32 v160, v160, v160
  v_mul_f32 v161, v161, v161
  v_cvt_pk_bf16_f32 v220, v160, v161
  v_cvt_pk_bf16_f32 v219, v162, v163
  v_lshlrev_b32 v162, 16, v219
  v_and_b32 v163, s62, v219
  v_lshlrev_b32 v217, 16, v181
  v_and_b32 v218, s62, v181
  v_add_f32 v162, v162, v217
  v_add_f32 v163, v163, v218
  v_cvt_pk_bf16_f32 v219, v162, v163
  v_lshlrev_b32 v162, 16, v219
  v_and_b32 v163, s62, v219
  v_max_f32 v162, 0, v162
  v_max_f32 v163, 0, v163
  v_mul_f32 v162, v162, v162
  v_mul_f32 v163, v163, v163
  v_cvt_pk_bf16_f32 v221, v162, v163
  v_cvt_pk_bf16_f32 v219, v168, v169
  v_lshlrev_b32 v168, 16, v219
  v_and_b32 v169, s62, v219
  v_lshlrev_b32 v217, 16, v182
  v_and_b32 v218, s62, v182
  v_add_f32 v168, v168, v217
  v_add_f32 v169, v169, v218
  v_cvt_pk_bf16_f32 v219, v168, v169
  v_lshlrev_b32 v168, 16, v219
  v_and_b32 v169, s62, v219
  v_max_f32 v168, 0, v168
  v_max_f32 v169, 0, v169
  v_mul_f32 v168, v168, v168
  v_mul_f32 v169, v169, v169
  v_cvt_pk_bf16_f32 v222, v168, v169
  v_cvt_pk_bf16_f32 v219, v170, v171
  v_lshlrev_b32 v170, 16, v219
  v_and_b32 v171, s62, v219
  v_lshlrev_b32 v217, 16, v183
  v_and_b32 v218, s62, v183
  v_add_f32 v170, v170, v217
  v_add_f32 v171, v171, v218
  v_cvt_pk_bf16_f32 v219, v170, v171
  v_lshlrev_b32 v170, 16, v219
  v_and_b32 v171, s62, v219
  v_max_f32 v170, 0, v170
  v_max_f32 v171, 0, v171
  v_mul_f32 v170, v170, v170
  v_mul_f32 v171, v171, v171
  v_cvt_pk_bf16_f32 v223, v170, v171
  s_lshl_b32 s42, s36, 10
  s_lshl_b32 s63, s47, 17
  s_add_u32 s42, s42, s63
  s_add_u32 s42, s42, 25165824
  buffer_store_dwordx4 v[220:223], v251, s[20:23], s42 offen offset:0
  v_cvt_pk_bf16_f32 v219, v164, v165
  v_lshlrev_b32 v164, 16, v219
  v_and_b32 v165, s62, v219
  v_lshlrev_b32 v217, 16, v180
  v_and_b32 v218, s62, v180
  v_add_f32 v164, v164, v217
  v_add_f32 v165, v165, v218
  v_cvt_pk_bf16_f32 v219, v164, v165
  v_lshlrev_b32 v164, 16, v219
  v_and_b32 v165, s62, v219
  v_max_f32 v164, 0, v164
  v_max_f32 v165, 0, v165
  v_mul_f32 v164, v164, v164
  v_mul_f32 v165, v165, v165
  v_cvt_pk_bf16_f32 v224, v164, v165
  v_cvt_pk_bf16_f32 v219, v166, v167
  v_lshlrev_b32 v166, 16, v219
  v_and_b32 v167, s62, v219
  v_lshlrev_b32 v217, 16, v181
  v_and_b32 v218, s62, v181
  v_add_f32 v166, v166, v217
  v_add_f32 v167, v167, v218
  v_cvt_pk_bf16_f32 v219, v166, v167
  v_lshlrev_b32 v166, 16, v219
  v_and_b32 v167, s62, v219
  v_max_f32 v166, 0, v166
  v_max_f32 v167, 0, v167
  v_mul_f32 v166, v166, v166
  v_mul_f32 v167, v167, v167
  v_cvt_pk_bf16_f32 v225, v166, v167
  v_cvt_pk_bf16_f32 v219, v172, v173
  v_lshlrev_b32 v172, 16, v219
  v_and_b32 v173, s62, v219
  v_lshlrev_b32 v217, 16, v182
  v_and_b32 v218, s62, v182
  v_add_f32 v172, v172, v217
  v_add_f32 v173, v173, v218
  v_cvt_pk_bf16_f32 v219, v172, v173
  v_lshlrev_b32 v172, 16, v219
  v_and_b32 v173, s62, v219
  v_max_f32 v172, 0, v172
  v_max_f32 v173, 0, v173
  v_mul_f32 v172, v172, v172
  v_mul_f32 v173, v173, v173
  v_cvt_pk_bf16_f32 v226, v172, v173
  v_cvt_pk_bf16_f32 v219, v174, v175
  v_lshlrev_b32 v174, 16, v219
  v_and_b32 v175, s62, v219
  v_lshlrev_b32 v217, 16, v183
  v_and_b32 v218, s62, v183
  v_add_f32 v174, v174, v217
  v_add_f32 v175, v175, v218
  v_cvt_pk_bf16_f32 v219, v174, v175
  v_lshlrev_b32 v174, 16, v219
  v_and_b32 v175, s62, v219
  v_max_f32 v174, 0, v174
  v_max_f32 v175, 0, v175
  v_mul_f32 v174, v174, v174
  v_mul_f32 v175, v175, v175
  v_cvt_pk_bf16_f32 v227, v174, v175
  s_lshl_b32 s42, s36, 10
  s_lshl_b32 s63, s47, 17
  s_add_u32 s42, s42, s63
  s_add_u32 s42, s42, 25165824
  buffer_store_dwordx4 v[224:227], v251, s[20:23], s42 offen offset:1024
L_skipBeX:
  v_lshrrev_b32 v208, 4, v251
  v_and_b32 v209, 15, v208
  v_lshrrev_b32 v210, 4, v208
  v_bfe_u32 v211, v208, 2, 2
  v_and_b32 v212, 3, v208
  s_movk_i32 s42, 384
  v_and_b32 v214, 6, v209
  v_xor_b32 v214, v214, v210
  v_lshlrev_b32 v214, 4, v214
  v_mul_lo_u32 v215, v209, s42
  v_add3_u32 v232, v214, v215, s37
  v_xor_b32 v233, 64, v232
  s_movk_i32 s42, 384
  v_lshl_add_u32 v214, v210, 2, v211
  v_and_b32 v215, 6, v214
  v_lshrrev_b32 v216, 1, v212
  v_xor_b32 v215, v215, v216
  v_lshlrev_b32 v215, 4, v215
  v_and_b32 v216, 1, v212
  v_lshl_add_u32 v215, v216, 3, v215
  v_mul_lo_u32 v214, v214, s42
  v_add_u32 v214, 24576, v214
  v_add_u32 v236, v214, v215
  v_xor_b32 v237, 32, v236
  v_xor_b32 v238, 64, v236
  v_xor_b32 v239, 96, v236
  v_add_u32 v236, s37, v236
  v_add_u32 v237, s37, v237
  v_add_u32 v238, s37, v238
  v_add_u32 v239, s37, v239
  v_mov_b32 v176, 0
  v_mov_b32 v177, 0
  v_mov_b32 v178, 0
  v_mov_b32 v179, 0
  v_mov_b32 v180, 0
  v_mov_b32 v181, 0
  v_mov_b32 v182, 0
  v_mov_b32 v183, 0
  v_mov_b32 v243, 0
  v_mov_b32 v244, 0
  s_mov_b32 s45, 0xbf800000
  s_mov_b32 s46, 0xff7fffff
  s_mov_b32 s39, 1
  s_mov_b32 s40, 49152
  s_mov_b32 s41, 24576
  s_load_dwordx2 s[48:49], s[0:1], 32
  s_load_dwordx2 s[50:51], s[0:1], 64
  s_and_b32 s42, s2, 7
  s_lshr_b32 s42, s42, 1
  s_lshr_b32 s43, s2, 3
  s_lshl_b32 s43, s43, 2
  s_and_b32 s62, s32, 3
  s_add_u32 s43, s43, s62
  s_lshl_b32 s59, s43, 13
  s_waitcnt lgkmcnt(0)
  s_cmp_eq_u32 s42, 3
  s_cselect_b32 s48, s50, s48
  s_cselect_b32 s49, s51, s49
  s_cselect_b32 s42, 0, s42
  s_cselect_b32 s46, 24, 32
  s_mul_i32 s42, s42, 2621440
  s_add_u32 s12, s48, s42
  s_addc_u32 s13, s49, 0
  s_and_b32 s13, s13, 0xffff
  s_mov_b32 s14, 0
  s_mov_b32 s15, 0x00020000
  s_mul_i32 s14, s46, 81920
  s_mov_b32 s46, 0xff7fffff
  s_cmp_eq_u32 s35, 1
  s_cbranch_scc1 L_grpB
  ds_read_b128 v[208:211], v232 offset:0
  ds_read_b128 v[212:215], v233 offset:0
  ds_read_b128 v[216:219], v232 offset:128
  ds_read_b128 v[220:223], v233 offset:128
  ds_read_b128 v[224:227], v232 offset:256
  s_waitcnt lgkmcnt(4)
  v_mfma_f32_16x16x32_bf16 v[144:147], v[208:211], v[96:99], v[176:179]
  ds_read_b128 v[228:231], v233 offset:256
  v_mfma_f32_16x16x32_bf16 v[148:151], v[208:211], v[100:103], v[180:183]
  s_waitcnt lgkmcnt(4)
  v_mfma_f32_16x16x32_bf16 v[144:147], v[212:215], v[104:107], v[144:147]
  ds_read_b128 v[208:211], v232 offset:6144
  v_mfma_f32_16x16x32_bf16 v[148:151], v[212:215], v[108:111], v[148:151]
  s_waitcnt lgkmcnt(4)
  v_mfma_f32_16x16x32_bf16 v[144:147], v[216:219], v[112:115], v[144:147]
  ds_read_b128 v[212:215], v233 offset:6144
  v_mfma_f32_16x16x32_bf16 v[148:151], v[216:219], v[116:119], v[148:151]
  s_waitcnt lgkmcnt(4)
  v_mfma_f32_16x16x32_bf16 v[144:147], v[220:223], v[120:123], v[144:147]
  ds_read_b128 v[216:219], v232 offset:6272
  v_mfma_f32_16x16x32_bf16 v[148:151], v[220:223], v[124:127], v[148:151]
  s_waitcnt lgkmcnt(4)
  v_mfma_f32_16x16x32_bf16 v[144:147], v[224:227], v[128:131], v[144:147]
  ds_read_b128 v[220:223], v233 offset:6272
  v_mfma_f32_16x16x32_bf16 v[148:151], v[224:227], v[132:135], v[148:151]
  s_waitcnt lgkmcnt(4)
  v_mfma_f32_16x16x32_bf16 v[144:147], v[228:231], v[136:139], v[144:147]
  ds_read_b128 v[224:227], v232 offset:6400
  v_mfma_f32_16x16x32_bf16 v[148:151], v[228:231], v[140:143], v[148:151]
  s_waitcnt lgkmcnt(4)
  v_mfma_f32_16x16x32_bf16 v[152:155], v[208:211], v[96:99], v[176:179]
  ds_read_b128 v[228:231], v233 offset:6400
  v_mfma_f32_16x16x32_bf16 v[156:159], v[208:211], v[100:103], v[180:183]
  s_waitcnt lgkmcnt(4)
  v_mfma_f32_16x16x32_bf16 v[152:155], v[212:215], v[104:107], v[152:155]
  ds_read_b128 v[208:211], v232 offset:12288
  v_mfma_f32_16x16x32_bf16 v[156:159], v[212:215], v[108:111], v[156:159]
  s_waitcnt lgkmcnt(4)
  v_mfma_f32_16x16x32_bf16 v[152:155], v[216:219], v[112:115], v[152:155]
  ds_read_b128 v[212:215], v233 offset:12288
  v_mfma_f32_16x16x32_bf16 v[156:159], v[216:219], v[116:119], v[156:159]
  s_waitcnt lgkmcnt(4)
  v_mfma_f32_16x16x32_bf16 v[152:155], v[220:223], v[120:123], v[152:155]
  ds_read_b128 v[216:219], v232 offset:12416
  v_mfma_f32_16x16x32_bf16 v[156:159], v[220:223], v[124:127], v[156:159]
  s_waitcnt lgkmcnt(4)
  v_mfma_f32_16x16x32_bf16 v[152:155], v[224:227], v[128:131], v[152:155]
  ds_read_b128 v[220:223], v233 offset:12416
  v_mfma_f32_16x16x32_bf16 v[156:159], v[224:227], v[132:135], v[156:159]
  s_waitcnt lgkmcnt(4)
  v_mfma_f32_16x16x32_bf16 v[152:155], v[228:231], v[136:139], v[152:155]
  ds_read_b128 v[224:227], v232 offset:12544
  v_mfma_f32_16x16x32_bf16 v[156:159], v[228:231], v[140:143], v[156:159]
  s_waitcnt lgkmcnt(4)
  v_mfma_f32_16x16x32_bf16 v[160:163], v[208:211], v[96:99], v[176:179]
  ds_read_b128 v[228:231], v233 offset:12544
  v_mfma_f32_16x16x32_bf16 v[164:167], v[208:211], v[100:103], v[180:183]
  s_waitcnt lgkmcnt(4)
  v_mfma_f32_16x16x32_bf16 v[160:163], v[212:215], v[104:107], v[160:163]
  ds_read_b128 v[208:211], v232 offset:18432
  v_mfma_f32_16x16x32_bf16 v[164:167], v[212:215], v[108:111], v[164:167]
  s_waitcnt lgkmcnt(4)
  v_mfma_f32_16x16x32_bf16 v[160:163], v[216:219], v[112:115], v[160:163]
  ds_read_b128 v[212:215], v233 offset:18432
  v_mfma_f32_16x16x32_bf16 v[164:167], v[216:219], v[116:119], v[164:167]
  s_waitcnt lgkmcnt(4)
  v_mfma_f32_16x16x32_bf16 v[160:163], v[220:223], v[120:123], v[160:163]
  ds_read_b128 v[216:219], v232 offset:18560
  v_mfma_f32_16x16x32_bf16 v[164:167], v[220:223], v[124:127], v[164:167]
  s_waitcnt lgkmcnt(4)
  v_mfma_f32_16x16x32_bf16 v[160:163], v[224:227], v[128:131], v[160:163]
  ds_read_b128 v[220:223], v233 offset:18560
  v_mfma_f32_16x16x32_bf16 v[164:167], v[224:227], v[132:135], v[164:167]
  s_waitcnt lgkmcnt(4)
  v_mfma_f32_16x16x32_bf16 v[160:163], v[228:231], v[136:139], v[160:163]
  ds_read_b128 v[224:227], v232 offset:18688
  v_mfma_f32_16x16x32_bf16 v[164:167], v[228:231], v[140:143], v[164:167]
  s_waitcnt lgkmcnt(4)
  v_mfma_f32_16x16x32_bf16 v[168:171], v[208:211], v[96:99], v[176:179]
  ds_read_b128 v[228:231], v233 offset:18688
  v_mfma_f32_16x16x32_bf16 v[172:175], v[208:211], v[100:103], v[180:183]
  s_waitcnt lgkmcnt(4)
  v_mfma_f32_16x16x32_bf16 v[168:171], v[212:215], v[104:107], v[168:171]
  v_mfma_f32_16x16x32_bf16 v[172:175], v[212:215], v[108:111], v[172:175]
  s_waitcnt lgkmcnt(3)
  v_mfma_f32_16x16x32_bf16 v[168:171], v[216:219], v[112:115], v[168:171]
  v_mfma_f32_16x16x32_bf16 v[172:175], v[216:219], v[116:119], v[172:175]
  s_waitcnt lgkmcnt(2)
  v_mfma_f32_16x16x32_bf16 v[168:171], v[220:223], v[120:123], v[168:171]
  v_mfma_f32_16x16x32_bf16 v[172:175], v[220:223], v[124:127], v[172:175]
  s_waitcnt lgkmcnt(1)
  v_mfma_f32_16x16x32_bf16 v[168:171], v[224:227], v[128:131], v[168:171]
  v_mfma_f32_16x16x32_bf16 v[172:175], v[224:227], v[132:135], v[172:175]
  s_waitcnt lgkmcnt(0)
  v_mfma_f32_16x16x32_bf16 v[168:171], v[228:231], v[136:139], v[168:171]
  v_mfma_f32_16x16x32_bf16 v[172:175], v[228:231], v[140:143], v[172:175]
  s_setprio 0
  s_nop 7
  v_mov_b32 v245, 0
  v_mov_b32 v246, 0
  s_add_u32 s43, s68, s38
  s_add_u32 m0, s43, 0
  s_nop 0
  buffer_load_dwordx4 v240, s[4:7], s40 offen lds
  v_exp_f32 v184, v144
  v_exp_f32 v185, v145
  v_exp_f32 v186, v146
  v_exp_f32 v187, v147
  s_add_u32 m0, s43, 1024
  s_nop 0
  buffer_load_dwordx4 v241, s[4:7], s40 offen lds
  v_exp_f32 v188, v148
  v_exp_f32 v189, v149
  v_exp_f32 v190, v150
  v_exp_f32 v191, v151
  v_add_f32 v245, v245, v184
  v_add_f32 v245, v245, v186
  v_cvt_pk_bf16_f32 v192, v184, v185
  v_cvt_pk_bf16_f32 v193, v186, v187
  v_add_f32 v245, v245, v185
  v_add_f32 v245, v245, v187
  s_add_u32 m0, s43, 2048
  s_nop 0
  buffer_load_dwordx4 v242, s[4:7], s40 offen lds
  v_exp_f32 v184, v152
  v_exp_f32 v185, v153
  v_exp_f32 v186, v154
  v_exp_f32 v187, v155
  v_add_f32 v246, v246, v188
  v_add_f32 v246, v246, v190
  v_cvt_pk_bf16_f32 v196, v188, v189
  v_cvt_pk_bf16_f32 v197, v190, v191
  v_add_f32 v246, v246, v189
  v_add_f32 v246, v246, v191
  s_add_u32 s69, s40, 12288
  s_add_u32 m0, s43, 12288
  s_nop 0
  buffer_load_dwordx4 v240, s[4:7], s69 offen lds
  v_exp_f32 v188, v156
  v_exp_f32 v189, v157
  v_exp_f32 v190, v158
  v_exp_f32 v191, v159
  v_add_f32 v245, v245, v184
  v_add_f32 v245, v245, v186
  v_cvt_pk_bf16_f32 v194, v184, v185
  v_cvt_pk_bf16_f32 v195, v186, v187
  v_add_f32 v245, v245, v185
  v_add_f32 v245, v245, v187
  s_add_u32 m0, s43, 13312
  s_nop 0
  buffer_load_dwordx4 v241, s[4:7], s69 offen lds
  v_exp_f32 v184, v160
  v_exp_f32 v185, v161
  v_exp_f32 v186, v162
  v_exp_f32 v187, v163
  v_add_f32 v246, v246, v188
  v_add_f32 v246, v246, v190
  v_cvt_pk_bf16_f32 v198, v188, v189
  v_cvt_pk_bf16_f32 v199, v190, v191
  v_add_f32 v246, v246, v189
  v_add_f32 v246, v246, v191
  s_add_u32 m0, s43, 14336
  s_nop 0
  buffer_load_dwordx4 v242, s[4:7], s69 offen lds
  s_add_u32 s40, s40, 24576
  v_exp_f32 v188, v164
  v_exp_f32 v189, v165
  v_exp_f32 v190, v166
  v_exp_f32 v191, v167
  v_add_f32 v245, v245, v184
  v_add_f32 v245, v245, v186
  v_cvt_pk_bf16_f32 v200, v184, v185
  v_cvt_pk_bf16_f32 v201, v186, v187
  v_add_f32 v245, v245, v185
  v_add_f32 v245, v245, v187
  v_exp_f32 v184, v168
  v_exp_f32 v185, v169
  v_exp_f32 v186, v170
  v_exp_f32 v187, v171
  v_add_f32 v246, v246, v188
  v_add_f32 v246, v246, v190
  v_cvt_pk_bf16_f32 v204, v188, v189
  v_cvt_pk_bf16_f32 v205, v190, v191
  v_add_f32 v246, v246, v189
  v_add_f32 v246, v246, v191
  v_exp_f32 v188, v172
  v_exp_f32 v189, v173
  v_exp_f32 v190, v174
  v_exp_f32 v191, v175
  v_add_f32 v245, v245, v184
  v_add_f32 v245, v245, v186
  v_cvt_pk_bf16_f32 v202, v184, v185
  v_cvt_pk_bf16_f32 v203, v186, v187
  v_add_f32 v245, v245, v185
  v_add_f32 v245, v245, v187
  s_nop 0
  v_add_f32 v246, v246, v188
  v_add_f32 v246, v246, v190
  v_cvt_pk_bf16_f32 v206, v188, v189
  v_cvt_pk_bf16_f32 v207, v190, v191
  v_add_f32 v246, v246, v189
  v_add_f32 v246, v246, v191
  v_add_f32 v253, v245, v246
  v_cmp_nge_f32 vcc, s45, v253
  s_cbranch_vccz L_sm_ok_A0
  v_max3_f32 v252, v144, v145, v146
  v_max3_f32 v252, v252, v147, v152
  v_max3_f32 v252, v252, v153, v154
  v_max3_f32 v252, v252, v155, v160
  v_max3_f32 v252, v252, v161, v162
  v_max3_f32 v252, v252, v163, v168
  v_max3_f32 v252, v252, v169, v170
  v_max_f32 v252, v252, v171
  ds_swizzle_b32 v253, v252 offset:0x401F
  s_waitcnt lgkmcnt(0)
  v_max_f32 v252, v252, v253
  v_mov_b32 v253, v252
  s_nop 1
  v_permlane32_swap_b32 v252, v253
  s_nop 1
  v_max_f32 v252, v252, v253
  v_max_f32 v252, s46, v252
  v_sub_f32 v253, v176, v252
  v_mov_b32 v176, v253
  v_mov_b32 v177, v253
  v_mov_b32 v178, v253
  v_mov_b32 v179, v253
  v_sub_f32 v144, v144, v252
  v_sub_f32 v145, v145, v252
  v_sub_f32 v146, v146, v252
  v_sub_f32 v147, v147, v252
  v_sub_f32 v152, v152, v252
  v_sub_f32 v153, v153, v252
  v_sub_f32 v154, v154, v252
  v_sub_f32 v155, v155, v252
  v_sub_f32 v160, v160, v252
  v_sub_f32 v161, v161, v252
  v_sub_f32 v162, v162, v252
  v_sub_f32 v163, v163, v252
  v_sub_f32 v168, v168, v252
  v_sub_f32 v169, v169, v252
  v_sub_f32 v170, v170, v252
  v_sub_f32 v171, v171, v252
  v_max_f32 v252, 0, v252
  v_sub_f32 v252, 0, v252
  v_exp_f32 v252, v252
  s_nop 0
  v_mul_f32 v0, v0, v252
  v_mul_f32 v1, v1, v252
  v_mul_f32 v2, v2, v252
  v_mul_f32 v3, v3, v252
  v_mul_f32 v8, v8, v252
  v_mul_f32 v9, v9, v252
  v_mul_f32 v10, v10, v252
  v_mul_f32 v11, v11, v252
  v_mul_f32 v16, v16, v252
  v_mul_f32 v17, v17, v252
  v_mul_f32 v18, v18, v252
  v_mul_f32 v19, v19, v252
  v_mul_f32 v24, v24, v252
  v_mul_f32 v25, v25, v252
  v_mul_f32 v26, v26, v252
  v_mul_f32 v27, v27, v252
  v_mul_f32 v32, v32, v252
  v_mul_f32 v33, v33, v252
  v_mul_f32 v34, v34, v252
  v_mul_f32 v35, v35, v252
  v_mul_f32 v40, v40, v252
  v_mul_f32 v41, v41, v252
  v_mul_f32 v42, v42, v252
  v_mul_f32 v43, v43, v252
  v_mul_f32 v48, v48, v252
  v_mul_f32 v49, v49, v252
  v_mul_f32 v50, v50, v252
  v_mul_f32 v51, v51, v252
  v_mul_f32 v56, v56, v252
  v_mul_f32 v57, v57, v252
  v_mul_f32 v58, v58, v252
  v_mul_f32 v59, v59, v252
  v_mul_f32 v64, v64, v252
  v_mul_f32 v65, v65, v252
  v_mul_f32 v66, v66, v252
  v_mul_f32 v67, v67, v252
  v_mul_f32 v72, v72, v252
  v_mul_f32 v73, v73, v252
  v_mul_f32 v74, v74, v252
  v_mul_f32 v75, v75, v252
  v_mul_f32 v80, v80, v252
  v_mul_f32 v81, v81, v252
  v_mul_f32 v82, v82, v252
  v_mul_f32 v83, v83, v252
  v_mul_f32 v88, v88, v252
  v_mul_f32 v89, v89, v252
  v_mul_f32 v90, v90, v252
  v_mul_f32 v91, v91, v252
  v_mul_f32 v243, v243, v252
  v_max3_f32 v252, v148, v149, v150
  v_max3_f32 v252, v252, v151, v156
  v_max3_f32 v252, v252, v157, v158
  v_max3_f32 v252, v252, v159, v164
  v_max3_f32 v252, v252, v165, v166
  v_max3_f32 v252, v252, v167, v172
  v_max3_f32 v252, v252, v173, v174
  v_max_f32 v252, v252, v175
  ds_swizzle_b32 v253, v252 offset:0x401F
  s_waitcnt lgkmcnt(0)
  v_max_f32 v252, v252, v253
  v_mov_b32 v253, v252
  s_nop 1
  v_permlane32_swap_b32 v252, v253
  s_nop 1
  v_max_f32 v252, v252, v253
  v_max_f32 v252, s46, v252
  v_sub_f32 v253, v180, v252
  v_mov_b32 v180, v253
  v_mov_b32 v181, v253
  v_mov_b32 v182, v253
  v_mov_b32 v183, v253
  v_sub_f32 v148, v148, v252
  v_sub_f32 v149, v149, v252
  v_sub_f32 v150, v150, v252
  v_sub_f32 v151, v151, v252
  v_sub_f32 v156, v156, v252
  v_sub_f32 v157, v157, v252
  v_sub_f32 v158, v158, v252
  v_sub_f32 v159, v159, v252
  v_sub_f32 v164, v164, v252
  v_sub_f32 v165, v165, v252
  v_sub_f32 v166, v166, v252
  v_sub_f32 v167, v167, v252
  v_sub_f32 v172, v172, v252
  v_sub_f32 v173, v173, v252
  v_sub_f32 v174, v174, v252
  v_sub_f32 v175, v175, v252
  v_max_f32 v252, 0, v252
  v_sub_f32 v252, 0, v252
  v_exp_f32 v252, v252
  s_nop 0
  v_mul_f32 v4, v4, v252
  v_mul_f32 v5, v5, v252
  v_mul_f32 v6, v6, v252
  v_mul_f32 v7, v7, v252
  v_mul_f32 v12, v12, v252
  v_mul_f32 v13, v13, v252
  v_mul_f32 v14, v14, v252
  v_mul_f32 v15, v15, v252
  v_mul_f32 v20, v20, v252
  v_mul_f32 v21, v21, v252
  v_mul_f32 v22, v22, v252
  v_mul_f32 v23, v23, v252
  v_mul_f32 v28, v28, v252
  v_mul_f32 v29, v29, v252
  v_mul_f32 v30, v30, v252
  v_mul_f32 v31, v31, v252
  v_mul_f32 v36, v36, v252
  v_mul_f32 v37, v37, v252
  v_mul_f32 v38, v38, v252
  v_mul_f32 v39, v39, v252
  v_mul_f32 v44, v44, v252
  v_mul_f32 v45, v45, v252
  v_mul_f32 v46, v46, v252
  v_mul_f32 v47, v47, v252
  v_mul_f32 v52, v52, v252
  v_mul_f32 v53, v53, v252
  v_mul_f32 v54, v54, v252
  v_mul_f32 v55, v55, v252
  v_mul_f32 v60, v60, v252
  v_mul_f32 v61, v61, v252
  v_mul_f32 v62, v62, v252
  v_mul_f32 v63, v63, v252
  v_mul_f32 v68, v68, v252
  v_mul_f32 v69, v69, v252
  v_mul_f32 v70, v70, v252
  v_mul_f32 v71, v71, v252
  v_mul_f32 v76, v76, v252
  v_mul_f32 v77, v77, v252
  v_mul_f32 v78, v78, v252
  v_mul_f32 v79, v79, v252
  v_mul_f32 v84, v84, v252
  v_mul_f32 v85, v85, v252
  v_mul_f32 v86, v86, v252
  v_mul_f32 v87, v87, v252
  v_mul_f32 v92, v92, v252
  v_mul_f32 v93, v93, v252
  v_mul_f32 v94, v94, v252
  v_mul_f32 v95, v95, v252
  v_mul_f32 v244, v244, v252
  v_mov_b32 v245, 0
  v_mov_b32 v246, 0
  v_exp_f32 v184, v144
  v_exp_f32 v185, v145
  v_exp_f32 v186, v146
  v_exp_f32 v187, v147
  v_exp_f32 v188, v148
  v_exp_f32 v189, v149
  v_exp_f32 v190, v150
  v_exp_f32 v191, v151
  v_add_f32 v245, v245, v184
  v_add_f32 v245, v245, v186
  v_cvt_pk_bf16_f32 v192, v184, v185
  v_cvt_pk_bf16_f32 v193, v186, v187
  v_add_f32 v245, v245, v185
  v_add_f32 v245, v245, v187
  v_exp_f32 v184, v152
  v_exp_f32 v185, v153
  v_exp_f32 v186, v154
  v_exp_f32 v187, v155
  v_add_f32 v246, v246, v188
  v_add_f32 v246, v246, v190
  v_cvt_pk_bf16_f32 v196, v188, v189
  v_cvt_pk_bf16_f32 v197, v190, v191
  v_add_f32 v246, v246, v189
  v_add_f32 v246, v246, v191
  v_exp_f32 v188, v156
  v_exp_f32 v189, v157
  v_exp_f32 v190, v158
  v_exp_f32 v191, v159
  v_add_f32 v245, v245, v184
  v_add_f32 v245, v245, v186
  v_cvt_pk_bf16_f32 v194, v184, v185
  v_cvt_pk_bf16_f32 v195, v186, v187
  v_add_f32 v245, v245, v185
  v_add_f32 v245, v245, v187
  v_exp_f32 v184, v160
  v_exp_f32 v185, v161
  v_exp_f32 v186, v162
  v_exp_f32 v187, v163
  v_add_f32 v246, v246, v188
  v_add_f32 v246, v246, v190
  v_cvt_pk_bf16_f32 v198, v188, v189
  v_cvt_pk_bf16_f32 v199, v190, v191
  v_add_f32 v246, v246, v189
  v_add_f32 v246, v246, v191
  v_exp_f32 v188, v164
  v_exp_f32 v189, v165
  v_exp_f32 v190, v166
  v_exp_f32 v191, v167
  v_add_f32 v245, v245, v184
  v_add_f32 v245, v245, v186
  v_cvt_pk_bf16_f32 v200, v184, v185
  v_cvt_pk_bf16_f32 v201, v186, v187
  v_add_f32 v245, v245, v185
  v_add_f32 v245, v245, v187
  v_exp_f32 v184, v168
  v_exp_f32 v185, v169
  v_exp_f32 v186, v170
  v_exp_f32 v187, v171
  v_add_f32 v246, v246, v188
  v_add_f32 v246, v246, v190
  v_cvt_pk_bf16_f32 v204, v188, v189
  v_cvt_pk_bf16_f32 v205, v190, v191
  v_add_f32 v246, v246, v189
  v_add_f32 v246, v246, v191
  v_exp_f32 v188, v172
  v_exp_f32 v189, v173
  v_exp_f32 v190, v174
  v_exp_f32 v191, v175
  v_add_f32 v245, v245, v184
  v_add_f32 v245, v245, v186
  v_cvt_pk_bf16_f32 v202, v184, v185
  v_cvt_pk_bf16_f32 v203, v186, v187
  v_add_f32 v245, v245, v185
  v_add_f32 v245, v245, v187
  s_nop 0
  v_add_f32 v246, v246, v188
  v_add_f32 v246, v246, v190
  v_cvt_pk_bf16_f32 v206, v188, v189
  v_cvt_pk_bf16_f32 v207, v190, v191
  v_add_f32 v246, v246, v189
  v_add_f32 v246, v246, v191
  s_mov_b32 s45, 1199570944
  s_mov_b32 s46, 0
  s_nop 1
L_sm_ok_A0:
  v_add_f32 v243, v243, v245
  v_add_f32 v244, v244, v246
  s_setprio 1
  s_mov_b32 s38, s37
  s_add_u32 s37, s37, 49152
  s_cmp_eq_u32 s37, 147456
  s_cselect_b32 s37, 0, s37
  s_sub_u32 s42, s37, s38
  v_add_u32 v232, s42, v232
  v_add_u32 v233, s42, v233
  v_add_u32 v236, s42, v236
  v_add_u32 v237, s42, v237
  v_add_u32 v238, s42, v238
  v_add_u32 v239, s42, v239
  ds_read_b64_tr_b16 v[208:209], v236 offset:0
  ds_read_b64_tr_b16 v[210:211], v236 offset:6144
  ds_read_b64_tr_b16 v[212:213], v237 offset:0
  ds_read_b64_tr_b16 v[214:215], v237 offset:6144
  ds_read_b64_tr_b16 v[216:217], v238 offset:0
  ds_read_b64_tr_b16 v[218:219], v238 offset:6144
  ds_read_b64_tr_b16 v[220:221], v239 offset:0
  ds_read_b64_tr_b16 v[222:223], v239 offset:6144
  ds_read_b64_tr_b16 v[224:225], v236 offset:128
  ds_read_b64_tr_b16 v[226:227], v236 offset:6272
  s_waitcnt vmcnt(6)
  s_barrier
L_loopA:
  s_waitcnt lgkmcnt(8)
  v_mfma_f32_16x16x32_bf16 v[0:3], v[208:211], v[192:195], v[0:3]
  ds_read_b64_tr_b16 v[228:229], v237 offset:128
  v_mfma_f32_16x16x32_bf16 v[4:7], v[208:211], v[196:199], v[4:7]
  ds_read_b64_tr_b16 v[230:231], v237 offset:6272
  s_waitcnt lgkmcnt(8)
  v_mfma_f32_16x16x32_bf16 v[8:11], v[212:215], v[192:195], v[8:11]
  ds_read_b64_tr_b16 v[208:209], v238 offset:128
  v_mfma_f32_16x16x32_bf16 v[12:15], v[212:215], v[196:199], v[12:15]
  ds_read_b64_tr_b16 v[210:211], v238 offset:6272
  s_waitcnt lgkmcnt(8)
  v_mfma_f32_16x16x32_bf16 v[16:19], v[216:219], v[192:195], v[16:19]
  ds_read_b64_tr_b16 v[212:213], v239 offset:128
  v_mfma_f32_16x16x32_bf16 v[20:23], v[216:219], v[196:199], v[20:23]
  ds_read_b64_tr_b16 v[214:215], v239 offset:6272
  s_waitcnt lgkmcnt(8)
  v_mfma_f32_16x16x32_bf16 v[24:27], v[220:223], v[192:195], v[24:27]
  ds_read_b64_tr_b16 v[216:217], v236 offset:256
  v_mfma_f32_16x16x32_bf16 v[28:31], v[220:223], v[196:199], v[28:31]
  ds_read_b64_tr_b16 v[218:219], v236 offset:6400
  s_waitcnt lgkmcnt(8)
  v_mfma_f32_16x16x32_bf16 v[32:35], v[224:227], v[192:195], v[32:35]
  ds_read_b64_tr_b16 v[220:221], v237 offset:256
  v_mfma_f32_16x16x32_bf16 v[36:39], v[224:227], v[196:199], v[36:39]
  ds_read_b64_tr_b16 v[222:223], v237 offset:6400
  s_waitcnt lgkmcnt(8)
  v_mfma_f32_16x16x32_bf16 v[40:43], v[228:231], v[192:195], v[40:43]
  ds_read_b64_tr_b16 v[224:225], v238 offset:256
  v_mfma_f32_16x16x32_bf16 v[44:47], v[228:231], v[196:199], v[44:47]
  ds_read_b64_tr_b16 v[226:227], v238 offset:6400
  s_waitcnt lgkmcnt(8)
  v_mfma_f32_16x16x32_bf16 v[48:51], v[208:211], v[192:195], v[48:51]
  ds_read_b64_tr_b16 v[228:229], v239 offset:256
  v_mfma_f32_16x16x32_bf16 v[52:55], v[208:211], v[196:199], v[52:55]
  ds_read_b64_tr_b16 v[230:231], v239 offset:6400
  s_waitcnt lgkmcnt(8)
  v_mfma_f32_16x16x32_bf16 v[56:59], v[212:215], v[192:195], v[56:59]
  ds_read_b64_tr_b16 v[208:209], v236 offset:12288
  v_mfma_f32_16x16x32_bf16 v[60:63], v[212:215], v[196:199], v[60:63]
  ds_read_b64_tr_b16 v[210:211], v236 offset:18432
  s_waitcnt lgkmcnt(8)
  v_mfma_f32_16x16x32_bf16 v[64:67], v[216:219], v[192:195], v[64:67]
  ds_read_b64_tr_b16 v[212:213], v237 offset:12288
  v_mfma_f32_16x16x32_bf16 v[68:71], v[216:219], v[196:199], v[68:71]
  ds_read_b64_tr_b16 v[214:215], v237 offset:18432
  s_waitcnt lgkmcnt(8)
  v_mfma_f32_16x16x32_bf16 v[72:75], v[220:223], v[192:195], v[72:75]
  ds_read_b64_tr_b16 v[216:217], v238 offset:12288
  v_mfma_f32_16x16x32_bf16 v[76:79], v[220:223], v[196:199], v[76:79]
  ds_read_b64_tr_b16 v[218:219], v238 offset:18432
  s_waitcnt lgkmcnt(8)
  v_mfma_f32_16x16x32_bf16 v[80:83], v[224:227], v[192:195], v[80:83]
  ds_read_b64_tr_b16 v[220:221], v239 offset:12288
  v_mfma_f32_16x16x32_bf16 v[84:87], v[224:227], v[196:199], v[84:87]
  ds_read_b64_tr_b16 v[222:223], v239 offset:18432
  s_waitcnt lgkmcnt(8)
  v_mfma_f32_16x16x32_bf16 v[88:91], v[228:231], v[192:195], v[88:91]
  ds_read_b64_tr_b16 v[224:225], v236 offset:12416
  v_mfma_f32_16x16x32_bf16 v[92:95], v[228:231], v[196:199], v[92:95]
  ds_read_b64_tr_b16 v[226:227], v236 offset:18560
  s_waitcnt lgkmcnt(8)
  v_mfma_f32_16x16x32_bf16 v[0:3], v[208:211], v[200:203], v[0:3]
  ds_read_b64_tr_b16 v[228:229], v237 offset:12416
  v_mfma_f32_16x16x32_bf16 v[4:7], v[208:211], v[204:207], v[4:7]
  ds_read_b64_tr_b16 v[230:231], v237 offset:18560
  s_waitcnt lgkmcnt(8)
  v_mfma_f32_16x16x32_bf16 v[8:11], v[212:215], v[200:203], v[8:11]
  ds_read_b64_tr_b16 v[208:209], v238 offset:12416
  v_mfma_f32_16x16x32_bf16 v[12:15], v[212:215], v[204:207], v[12:15]
  ds_read_b64_tr_b16 v[210:211], v238 offset:18560
  s_waitcnt lgkmcnt(8)
  v_mfma_f32_16x16x32_bf16 v[16:19], v[216:219], v[200:203], v[16:19]
  ds_read_b64_tr_b16 v[212:213], v239 offset:12416
  v_mfma_f32_16x16x32_bf16 v[20:23], v[216:219], v[204:207], v[20:23]
  ds_read_b64_tr_b16 v[214:215], v239 offset:18560
  s_waitcnt lgkmcnt(8)
  v_mfma_f32_16x16x32_bf16 v[24:27], v[220:223], v[200:203], v[24:27]
  ds_read_b64_tr_b16 v[216:217], v236 offset:12544
  v_mfma_f32_16x16x32_bf16 v[28:31], v[220:223], v[204:207], v[28:31]
  ds_read_b64_tr_b16 v[218:219], v236 offset:18688
  s_waitcnt lgkmcnt(8)
  v_mfma_f32_16x16x32_bf16 v[32:35], v[224:227], v[200:203], v[32:35]
  ds_read_b64_tr_b16 v[220:221], v237 offset:12544
  v_mfma_f32_16x16x32_bf16 v[36:39], v[224:227], v[204:207], v[36:39]
  ds_read_b64_tr_b16 v[222:223], v237 offset:18688
  s_waitcnt lgkmcnt(8)
  v_mfma_f32_16x16x32_bf16 v[40:43], v[228:231], v[200:203], v[40:43]
  ds_read_b64_tr_b16 v[224:225], v238 offset:12544
  v_mfma_f32_16x16x32_bf16 v[44:47], v[228:231], v[204:207], v[44:47]
  ds_read_b64_tr_b16 v[226:227], v238 offset:18688
  s_waitcnt lgkmcnt(8)
  v_mfma_f32_16x16x32_bf16 v[48:51], v[208:211], v[200:203], v[48:51]
  ds_read_b64_tr_b16 v[228:229], v239 offset:12544
  v_mfma_f32_16x16x32_bf16 v[52:55], v[208:211], v[204:207], v[52:55]
  ds_read_b64_tr_b16 v[230:231], v239 offset:18688
  s_waitcnt lgkmcnt(8)
  v_mfma_f32_16x16x32_bf16 v[56:59], v[212:215], v[200:203], v[56:59]
  ds_read_b128 v[208:211], v232 offset:0
  v_mfma_f32_16x16x32_bf16 v[60:63], v[212:215], v[204:207], v[60:63]
  s_waitcnt lgkmcnt(7)
  v_mfma_f32_16x16x32_bf16 v[64:67], v[216:219], v[200:203], v[64:67]
  ds_read_b128 v[212:215], v233 offset:0
  v_mfma_f32_16x16x32_bf16 v[68:71], v[216:219], v[204:207], v[68:71]
  s_waitcnt lgkmcnt(6)
  v_mfma_f32_16x16x32_bf16 v[72:75], v[220:223], v[200:203], v[72:75]
  ds_read_b128 v[216:219], v232 offset:128
  v_mfma_f32_16x16x32_bf16 v[76:79], v[220:223], v[204:207], v[76:79]
  s_waitcnt lgkmcnt(5)
  v_mfma_f32_16x16x32_bf16 v[80:83], v[224:227], v[200:203], v[80:83]
  ds_read_b128 v[220:223], v233 offset:128
  v_mfma_f32_16x16x32_bf16 v[84:87], v[224:227], v[204:207], v[84:87]
  s_waitcnt lgkmcnt(4)
  v_mfma_f32_16x16x32_bf16 v[88:91], v[228:231], v[200:203], v[88:91]
  ds_read_b128 v[224:227], v232 offset:256
  v_mfma_f32_16x16x32_bf16 v[92:95], v[228:231], v[204:207], v[92:95]
  s_waitcnt lgkmcnt(4)
  v_mfma_f32_16x16x32_bf16 v[144:147], v[208:211], v[96:99], v[176:179]
  ds_read_b128 v[228:231], v233 offset:256
  v_mfma_f32_16x16x32_bf16 v[148:151], v[208:211], v[100:103], v[180:183]
  s_waitcnt lgkmcnt(4)
  v_mfma_f32_16x16x32_bf16 v[144:147], v[212:215], v[104:107], v[144:147]
  ds_read_b128 v[208:211], v232 offset:6144
  v_mfma_f32_16x16x32_bf16 v[148:151], v[212:215], v[108:111], v[148:151]
  s_waitcnt lgkmcnt(4)
  v_mfma_f32_16x16x32_bf16 v[144:147], v[216:219], v[112:115], v[144:147]
  ds_read_b128 v[212:215], v233 offset:6144
  v_mfma_f32_16x16x32_bf16 v[148:151], v[216:219], v[116:119], v[148:151]
  s_waitcnt lgkmcnt(4)
  v_mfma_f32_16x16x32_bf16 v[144:147], v[220:223], v[120:123], v[144:147]
  ds_read_b128 v[216:219], v232 offset:6272
  v_mfma_f32_16x16x32_bf16 v[148:151], v[220:223], v[124:127], v[148:151]
  s_waitcnt lgkmcnt(4)
  v_mfma_f32_16x16x32_bf16 v[144:147], v[224:227], v[128:131], v[144:147]
  ds_read_b128 v[220:223], v233 offset:6272
  v_mfma_f32_16x16x32_bf16 v[148:151], v[224:227], v[132:135], v[148:151]
  s_waitcnt lgkmcnt(4)
  v_mfma_f32_16x16x32_bf16 v[144:147], v[228:231], v[136:139], v[144:147]
  ds_read_b128 v[224:227], v232 offset:6400
  v_mfma_f32_16x16x32_bf16 v[148:151], v[228:231], v[140:143], v[148:151]
  s_waitcnt lgkmcnt(4)
  v_mfma_f32_16x16x32_bf16 v[152:155], v[208:211], v[96:99], v[176:179]
  ds_read_b128 v[228:231], v233 offset:6400
  v_mfma_f32_16x16x32_bf16 v[156:159], v[208:211], v[100:103], v[180:183]
  s_waitcnt lgkmcnt(4)
  v_mfma_f32_16x16x32_bf16 v[152:155], v[212:215], v[104:107], v[152:155]
  ds_read_b128 v[208:211], v232 offset:12288
  v_mfma_f32_16x16x32_bf16 v[156:159], v[212:215], v[108:111], v[156:159]
  s_waitcnt lgkmcnt(4)
  v_mfma_f32_16x16x32_bf16 v[152:155], v[216:219], v[112:115], v[152:155]
  ds_read_b128 v[212:215], v233 offset:12288
  v_mfma_f32_16x16x32_bf16 v[156:159], v[216:219], v[116:119], v[156:159]
  s_waitcnt lgkmcnt(4)
  v_mfma_f32_16x16x32_bf16 v[152:155], v[220:223], v[120:123], v[152:155]
  ds_read_b128 v[216:219], v232 offset:12416
  v_mfma_f32_16x16x32_bf16 v[156:159], v[220:223], v[124:127], v[156:159]
  s_waitcnt lgkmcnt(4)
  v_mfma_f32_16x16x32_bf16 v[152:155], v[224:227], v[128:131], v[152:155]
  ds_read_b128 v[220:223], v233 offset:12416
  v_mfma_f32_16x16x32_bf16 v[156:159], v[224:227], v[132:135], v[156:159]
  s_waitcnt lgkmcnt(4)
  v_mfma_f32_16x16x32_bf16 v[152:155], v[228:231], v[136:139], v[152:155]
  ds_read_b128 v[224:227], v232 offset:12544
  v_mfma_f32_16x16x32_bf16 v[156:159], v[228:231], v[140:143], v[156:159]
  s_waitcnt lgkmcnt(4)
  v_mfma_f32_16x16x32_bf16 v[160:163], v[208:211], v[96:99], v[176:179]
  ds_read_b128 v[228:231], v233 offset:12544
  v_mfma_f32_16x16x32_bf16 v[164:167], v[208:211], v[100:103], v[180:183]
  s_waitcnt lgkmcnt(4)
  v_mfma_f32_16x16x32_bf16 v[160:163], v[212:215], v[104:107], v[160:163]
  ds_read_b128 v[208:211], v232 offset:18432
  v_mfma_f32_16x16x32_bf16 v[164:167], v[212:215], v[108:111], v[164:167]
  s_waitcnt lgkmcnt(4)
  v_mfma_f32_16x16x32_bf16 v[160:163], v[216:219], v[112:115], v[160:163]
  ds_read_b128 v[212:215], v233 offset:18432
  v_mfma_f32_16x16x32_bf16 v[164:167], v[216:219], v[116:119], v[164:167]
  s_waitcnt lgkmcnt(4)
  v_mfma_f32_16x16x32_bf16 v[160:163], v[220:223], v[120:123], v[160:163]
  ds_read_b128 v[216:219], v232 offset:18560
  v_mfma_f32_16x16x32_bf16 v[164:167], v[220:223], v[124:127], v[164:167]
  s_waitcnt lgkmcnt(4)
  v_mfma_f32_16x16x32_bf16 v[160:163], v[224:227], v[128:131], v[160:163]
  ds_read_b128 v[220:223], v233 offset:18560
  v_mfma_f32_16x16x32_bf16 v[164:167], v[224:227], v[132:135], v[164:167]
  s_waitcnt lgkmcnt(4)
  v_mfma_f32_16x16x32_bf16 v[160:163], v[228:231], v[136:139], v[160:163]
  ds_read_b128 v[224:227], v232 offset:18688
  v_mfma_f32_16x16x32_bf16 v[164:167], v[228:231], v[140:143], v[164:167]
  s_waitcnt lgkmcnt(4)
  v_mfma_f32_16x16x32_bf16 v[168:171], v[208:211], v[96:99], v[176:179]
  ds_read_b128 v[228:231], v233 offset:18688
  v_mfma_f32_16x16x32_bf16 v[172:175], v[208:211], v[100:103], v[180:183]
  s_waitcnt lgkmcnt(4)
  v_mfma_f32_16x16x32_bf16 v[168:171], v[212:215], v[104:107], v[168:171]
  v_mfma_f32_16x16x32_bf16 v[172:175], v[212:215], v[108:111], v[172:175]
  s_waitcnt lgkmcnt(3)
  v_mfma_f32_16x16x32_bf16 v[168:171], v[216:219], v[112:115], v[168:171]
  v_mfma_f32_16x16x32_bf16 v[172:175], v[216:219], v[116:119], v[172:175]
  s_waitcnt lgkmcnt(2)
  v_mfma_f32_16x16x32_bf16 v[168:171], v[220:223], v[120:123], v[168:171]
  v_mfma_f32_16x16x32_bf16 v[172:175], v[220:223], v[124:127], v[172:175]
  s_waitcnt lgkmcnt(1)
  v_mfma_f32_16x16x32_bf16 v[168:171], v[224:227], v[128:131], v[168:171]
  v_mfma_f32_16x16x32_bf16 v[172:175], v[224:227], v[132:135], v[172:175]
  s_waitcnt lgkmcnt(0)
  v_mfma_f32_16x16x32_bf16 v[168:171], v[228:231], v[136:139], v[168:171]
  v_mfma_f32_16x16x32_bf16 v[172:175], v[228:231], v[140:143], v[172:175]
  s_setprio 0
  s_nop 7
  v_mov_b32 v245, 0
  v_mov_b32 v246, 0
  s_add_u32 s43, s68, s38
  s_add_u32 m0, s43, 0
  s_nop 0
  buffer_load_dwordx4 v240, s[4:7], s40 offen lds
  v_exp_f32 v184, v144
  v_exp_f32 v185, v145
  v_exp_f32 v186, v146
  v_exp_f32 v187, v147
  s_add_u32 m0, s43, 1024
  s_nop 0
  buffer_load_dwordx4 v241, s[4:7], s40 offen lds
  v_exp_f32 v188, v148
  v_exp_f32 v189, v149
  v_exp_f32 v190, v150
  v_exp_f32 v191, v151
  v_add_f32 v245, v245, v184
  v_add_f32 v245, v245, v186
  v_cvt_pk_bf16_f32 v192, v184, v185
  v_cvt_pk_bf16_f32 v193, v186, v187
  v_add_f32 v245, v245, v185
  v_add_f32 v245, v245, v187
  s_add_u32 m0, s43, 2048
  s_nop 0
  buffer_load_dwordx4 v242, s[4:7], s40 offen lds
  v_exp_f32 v184, v152
  v_exp_f32 v185, v153
  v_exp_f32 v186, v154
  v_exp_f32 v187, v155
  v_add_f32 v246, v246, v188
  v_add_f32 v246, v246, v190
  v_cvt_pk_bf16_f32 v196, v188, v189
  v_cvt_pk_bf16_f32 v197, v190, v191
  v_add_f32 v246, v246, v189
  v_add_f32 v246, v246, v191
  s_add_u32 s69, s40, 12288
  s_add_u32 m0, s43, 12288
  s_nop 0
  buffer_load_dwordx4 v240, s[4:7], s69 offen lds
  v_exp_f32 v188, v156
  v_exp_f32 v189, v157
  v_exp_f32 v190, v158
  v_exp_f32 v191, v159
  v_add_f32 v245, v245, v184
  v_add_f32 v245, v245, v186
  v_cvt_pk_bf16_f32 v194, v184, v185
  v_cvt_pk_bf16_f32 v195, v186, v187
  v_add_f32 v245, v245, v185
  v_add_f32 v245, v245, v187
  s_add_u32 m0, s43, 13312
  s_nop 0
  buffer_load_dwordx4 v241, s[4:7], s69 offen lds
  v_exp_f32 v184, v160
  v_exp_f32 v185, v161
  v_exp_f32 v186, v162
  v_exp_f32 v187, v163
  v_add_f32 v246, v246, v188
  v_add_f32 v246, v246, v190
  v_cvt_pk_bf16_f32 v198, v188, v189
  v_cvt_pk_bf16_f32 v199, v190, v191
  v_add_f32 v246, v246, v189
  v_add_f32 v246, v246, v191
  s_add_u32 m0, s43, 14336
  s_nop 0
  buffer_load_dwordx4 v242, s[4:7], s69 offen lds
  s_add_u32 s40, s40, 24576
  v_exp_f32 v188, v164
  v_exp_f32 v189, v165
  v_exp_f32 v190, v166
  v_exp_f32 v191, v167
  v_add_f32 v245, v245, v184
  v_add_f32 v245, v245, v186
  v_cvt_pk_bf16_f32 v200, v184, v185
  v_cvt_pk_bf16_f32 v201, v186, v187
  v_add_f32 v245, v245, v185
  v_add_f32 v245, v245, v187
  v_exp_f32 v184, v168
  v_exp_f32 v185, v169
  v_exp_f32 v186, v170
  v_exp_f32 v187, v171
  v_add_f32 v246, v246, v188
  v_add_f32 v246, v246, v190
  v_cvt_pk_bf16_f32 v204, v188, v189
  v_cvt_pk_bf16_f32 v205, v190, v191
  v_add_f32 v246, v246, v189
  v_add_f32 v246, v246, v191
  v_exp_f32 v188, v172
  v_exp_f32 v189, v173
  v_exp_f32 v190, v174
  v_exp_f32 v191, v175
  v_add_f32 v245, v245, v184
  v_add_f32 v245, v245, v186
  v_cvt_pk_bf16_f32 v202, v184, v185
  v_cvt_pk_bf16_f32 v203, v186, v187
  v_add_f32 v245, v245, v185
  v_add_f32 v245, v245, v187
  s_nop 0
  v_add_f32 v246, v246, v188
  v_add_f32 v246, v246, v190
  v_cvt_pk_bf16_f32 v206, v188, v189
  v_cvt_pk_bf16_f32 v207, v190, v191
  v_add_f32 v246, v246, v189
  v_add_f32 v246, v246, v191
  v_add_f32 v253, v245, v246
  v_cmp_nge_f32 vcc, s45, v253
  s_cbranch_vccz L_sm_ok_A1
  v_max3_f32 v252, v144, v145, v146
  v_max3_f32 v252, v252, v147, v152
  v_max3_f32 v252, v252, v153, v154
  v_max3_f32 v252, v252, v155, v160
  v_max3_f32 v252, v252, v161, v162
  v_max3_f32 v252, v252, v163, v168
  v_max3_f32 v252, v252, v169, v170
  v_max_f32 v252, v252, v171
  ds_swizzle_b32 v253, v252 offset:0x401F
  s_waitcnt lgkmcnt(0)
  v_max_f32 v252, v252, v253
  v_mov_b32 v253, v252
  s_nop 1
  v_permlane32_swap_b32 v252, v253
  s_nop 1
  v_max_f32 v252, v252, v253
  v_max_f32 v252, s46, v252
  v_sub_f32 v253, v176, v252
  v_mov_b32 v176, v253
  v_mov_b32 v177, v253
  v_mov_b32 v178, v253
  v_mov_b32 v179, v253
  v_sub_f32 v144, v144, v252
  v_sub_f32 v145, v145, v252
  v_sub_f32 v146, v146, v252
  v_sub_f32 v147, v147, v252
  v_sub_f32 v152, v152, v252
  v_sub_f32 v153, v153, v252
  v_sub_f32 v154, v154, v252
  v_sub_f32 v155, v155, v252
  v_sub_f32 v160, v160, v252
  v_sub_f32 v161, v161, v252
  v_sub_f32 v162, v162, v252
  v_sub_f32 v163, v163, v252
  v_sub_f32 v168, v168, v252
  v_sub_f32 v169, v169, v252
  v_sub_f32 v170, v170, v252
  v_sub_f32 v171, v171, v252
  v_max_f32 v252, 0, v252
  v_sub_f32 v252, 0, v252
  v_exp_f32 v252, v252
  s_nop 0
  v_mul_f32 v0, v0, v252
  v_mul_f32 v1, v1, v252
  v_mul_f32 v2, v2, v252
  v_mul_f32 v3, v3, v252
  v_mul_f32 v8, v8, v252
  v_mul_f32 v9, v9, v252
  v_mul_f32 v10, v10, v252
  v_mul_f32 v11, v11, v252
  v_mul_f32 v16, v16, v252
  v_mul_f32 v17, v17, v252
  v_mul_f32 v18, v18, v252
  v_mul_f32 v19, v19, v252
  v_mul_f32 v24, v24, v252
  v_mul_f32 v25, v25, v252
  v_mul_f32 v26, v26, v252
  v_mul_f32 v27, v27, v252
  v_mul_f32 v32, v32, v252
  v_mul_f32 v33, v33, v252
  v_mul_f32 v34, v34, v252
  v_mul_f32 v35, v35, v252
  v_mul_f32 v40, v40, v252
  v_mul_f32 v41, v41, v252
  v_mul_f32 v42, v42, v252
  v_mul_f32 v43, v43, v252
  v_mul_f32 v48, v48, v252
  v_mul_f32 v49, v49, v252
  v_mul_f32 v50, v50, v252
  v_mul_f32 v51, v51, v252
  v_mul_f32 v56, v56, v252
  v_mul_f32 v57, v57, v252
  v_mul_f32 v58, v58, v252
  v_mul_f32 v59, v59, v252
  v_mul_f32 v64, v64, v252
  v_mul_f32 v65, v65, v252
  v_mul_f32 v66, v66, v252
  v_mul_f32 v67, v67, v252
  v_mul_f32 v72, v72, v252
  v_mul_f32 v73, v73, v252
  v_mul_f32 v74, v74, v252
  v_mul_f32 v75, v75, v252
  v_mul_f32 v80, v80, v252
  v_mul_f32 v81, v81, v252
  v_mul_f32 v82, v82, v252
  v_mul_f32 v83, v83, v252
  v_mul_f32 v88, v88, v252
  v_mul_f32 v89, v89, v252
  v_mul_f32 v90, v90, v252
  v_mul_f32 v91, v91, v252
  v_mul_f32 v243, v243, v252
  v_max3_f32 v252, v148, v149, v150
  v_max3_f32 v252, v252, v151, v156
  v_max3_f32 v252, v252, v157, v158
  v_max3_f32 v252, v252, v159, v164
  v_max3_f32 v252, v252, v165, v166
  v_max3_f32 v252, v252, v167, v172
  v_max3_f32 v252, v252, v173, v174
  v_max_f32 v252, v252, v175
  ds_swizzle_b32 v253, v252 offset:0x401F
  s_waitcnt lgkmcnt(0)
  v_max_f32 v252, v252, v253
  v_mov_b32 v253, v252
  s_nop 1
  v_permlane32_swap_b32 v252, v253
  s_nop 1
  v_max_f32 v252, v252, v253
  v_max_f32 v252, s46, v252
  v_sub_f32 v253, v180, v252
  v_mov_b32 v180, v253
  v_mov_b32 v181, v253
  v_mov_b32 v182, v253
  v_mov_b32 v183, v253
  v_sub_f32 v148, v148, v252
  v_sub_f32 v149, v149, v252
  v_sub_f32 v150, v150, v252
  v_sub_f32 v151, v151, v252
  v_sub_f32 v156, v156, v252
  v_sub_f32 v157, v157, v252
  v_sub_f32 v158, v158, v252
  v_sub_f32 v159, v159, v252
  v_sub_f32 v164, v164, v252
  v_sub_f32 v165, v165, v252
  v_sub_f32 v166, v166, v252
  v_sub_f32 v167, v167, v252
  v_sub_f32 v172, v172, v252
  v_sub_f32 v173, v173, v252
  v_sub_f32 v174, v174, v252
  v_sub_f32 v175, v175, v252
  v_max_f32 v252, 0, v252
  v_sub_f32 v252, 0, v252
  v_exp_f32 v252, v252
  s_nop 0
  v_mul_f32 v4, v4, v252
  v_mul_f32 v5, v5, v252
  v_mul_f32 v6, v6, v252
  v_mul_f32 v7, v7, v252
  v_mul_f32 v12, v12, v252
  v_mul_f32 v13, v13, v252
  v_mul_f32 v14, v14, v252
  v_mul_f32 v15, v15, v252
  v_mul_f32 v20, v20, v252
  v_mul_f32 v21, v21, v252
  v_mul_f32 v22, v22, v252
  v_mul_f32 v23, v23, v252
  v_mul_f32 v28, v28, v252
  v_mul_f32 v29, v29, v252
  v_mul_f32 v30, v30, v252
  v_mul_f32 v31, v31, v252
  v_mul_f32 v36, v36, v252
  v_mul_f32 v37, v37, v252
  v_mul_f32 v38, v38, v252
  v_mul_f32 v39, v39, v252
  v_mul_f32 v44, v44, v252
  v_mul_f32 v45, v45, v252
  v_mul_f32 v46, v46, v252
  v_mul_f32 v47, v47, v252
  v_mul_f32 v52, v52, v252
  v_mul_f32 v53, v53, v252
  v_mul_f32 v54, v54, v252
  v_mul_f32 v55, v55, v252
  v_mul_f32 v60, v60, v252
  v_mul_f32 v61, v61, v252
  v_mul_f32 v62, v62, v252
  v_mul_f32 v63, v63, v252
  v_mul_f32 v68, v68, v252
  v_mul_f32 v69, v69, v252
  v_mul_f32 v70, v70, v252
  v_mul_f32 v71, v71, v252
  v_mul_f32 v76, v76, v252
  v_mul_f32 v77, v77, v252
  v_mul_f32 v78, v78, v252
  v_mul_f32 v79, v79, v252
  v_mul_f32 v84, v84, v252
  v_mul_f32 v85, v85, v252
  v_mul_f32 v86, v86, v252
  v_mul_f32 v87, v87, v252
  v_mul_f32 v92, v92, v252
  v_mul_f32 v93, v93, v252
  v_mul_f32 v94, v94, v252
  v_mul_f32 v95, v95, v252
  v_mul_f32 v244, v244, v252
  v_mov_b32 v245, 0
  v_mov_b32 v246, 0
  v_exp_f32 v184, v144
  v_exp_f32 v185, v145
  v_exp_f32 v186, v146
  v_exp_f32 v187, v147
  v_exp_f32 v188, v148
  v_exp_f32 v189, v149
  v_exp_f32 v190, v150
  v_exp_f32 v191, v151
  v_add_f32 v245, v245, v184
  v_add_f32 v245, v245, v186
  v_cvt_pk_bf16_f32 v192, v184, v185
  v_cvt_pk_bf16_f32 v193, v186, v187
  v_add_f32 v245, v245, v185
  v_add_f32 v245, v245, v187
  v_exp_f32 v184, v152
  v_exp_f32 v185, v153
  v_exp_f32 v186, v154
  v_exp_f32 v187, v155
  v_add_f32 v246, v246, v188
  v_add_f32 v246, v246, v190
  v_cvt_pk_bf16_f32 v196, v188, v189
  v_cvt_pk_bf16_f32 v197, v190, v191
  v_add_f32 v246, v246, v189
  v_add_f32 v246, v246, v191
  v_exp_f32 v188, v156
  v_exp_f32 v189, v157
  v_exp_f32 v190, v158
  v_exp_f32 v191, v159
  v_add_f32 v245, v245, v184
  v_add_f32 v245, v245, v186
  v_cvt_pk_bf16_f32 v194, v184, v185
  v_cvt_pk_bf16_f32 v195, v186, v187
  v_add_f32 v245, v245, v185
  v_add_f32 v245, v245, v187
  v_exp_f32 v184, v160
  v_exp_f32 v185, v161
  v_exp_f32 v186, v162
  v_exp_f32 v187, v163
  v_add_f32 v246, v246, v188
  v_add_f32 v246, v246, v190
  v_cvt_pk_bf16_f32 v198, v188, v189
  v_cvt_pk_bf16_f32 v199, v190, v191
  v_add_f32 v246, v246, v189
  v_add_f32 v246, v246, v191
  v_exp_f32 v188, v164
  v_exp_f32 v189, v165
  v_exp_f32 v190, v166
  v_exp_f32 v191, v167
  v_add_f32 v245, v245, v184
  v_add_f32 v245, v245, v186
  v_cvt_pk_bf16_f32 v200, v184, v185
  v_cvt_pk_bf16_f32 v201, v186, v187
  v_add_f32 v245, v245, v185
  v_add_f32 v245, v245, v187
  v_exp_f32 v184, v168
  v_exp_f32 v185, v169
  v_exp_f32 v186, v170
  v_exp_f32 v187, v171
  v_add_f32 v246, v246, v188
  v_add_f32 v246, v246, v190
  v_cvt_pk_bf16_f32 v204, v188, v189
  v_cvt_pk_bf16_f32 v205, v190, v191
  v_add_f32 v246, v246, v189
  v_add_f32 v246, v246, v191
  v_exp_f32 v188, v172
  v_exp_f32 v189, v173
  v_exp_f32 v190, v174
  v_exp_f32 v191, v175
  v_add_f32 v245, v245, v184
  v_add_f32 v245, v245, v186
  v_cvt_pk_bf16_f32 v202, v184, v185
  v_cvt_pk_bf16_f32 v203, v186, v187
  v_add_f32 v245, v245, v185
  v_add_f32 v245, v245, v187
  s_nop 0
  v_add_f32 v246, v246, v188
  v_add_f32 v246, v246, v190
  v_cvt_pk_bf16_f32 v206, v188, v189
  v_cvt_pk_bf16_f32 v207, v190, v191
  v_add_f32 v246, v246, v189
  v_add_f32 v246, v246, v191
  s_mov_b32 s45, 1199570944
  s_mov_b32 s46, 0
  s_nop 1
L_sm_ok_A1:
  v_add_f32 v243, v243, v245
  v_add_f32 v244, v244, v246
  s_setprio 1
  s_mov_b32 s38, s37
  s_add_u32 s37, s37, 49152
  s_cmp_eq_u32 s37, 147456
  s_cselect_b32 s37, 0, s37
  s_sub_u32 s42, s37, s38
  v_add_u32 v232, s42, v232
  v_add_u32 v233, s42, v233
  v_add_u32 v236, s42, v236
  v_add_u32 v237, s42, v237
  v_add_u32 v238, s42, v238
  v_add_u32 v239, s42, v239
  ds_read_b64_tr_b16 v[208:209], v236 offset:0
  ds_read_b64_tr_b16 v[210:211], v236 offset:6144
  ds_read_b64_tr_b16 v[212:213], v237 offset:0
  ds_read_b64_tr_b16 v[214:215], v237 offset:6144
  ds_read_b64_tr_b16 v[216:217], v238 offset:0
  ds_read_b64_tr_b16 v[218:219], v238 offset:6144
  ds_read_b64_tr_b16 v[220:221], v239 offset:0
  ds_read_b64_tr_b16 v[222:223], v239 offset:6144
  ds_read_b64_tr_b16 v[224:225], v236 offset:128
  ds_read_b64_tr_b16 v[226:227], v236 offset:6272
  s_waitcnt vmcnt(6)
  s_barrier
  s_add_u32 s39, s39, 1
  s_cmp_lt_u32 s39, 32
  s_cbranch_scc1 L_loopA
  s_waitcnt lgkmcnt(8)
  v_mfma_f32_16x16x32_bf16 v[0:3], v[208:211], v[192:195], v[0:3]
  ds_read_b64_tr_b16 v[228:229], v237 offset:128
  v_mfma_f32_16x16x32_bf16 v[4:7], v[208:211], v[196:199], v[4:7]
  ds_read_b64_tr_b16 v[230:231], v237 offset:6272
  s_waitcnt lgkmcnt(8)
  v_mfma_f32_16x16x32_bf16 v[8:11], v[212:215], v[192:195], v[8:11]
  ds_read_b64_tr_b16 v[208:209], v238 offset:128
  v_mfma_f32_16x16x32_bf16 v[12:15], v[212:215], v[196:199], v[12:15]
  ds_read_b64_tr_b16 v[210:211], v238 offset:6272
  s_waitcnt lgkmcnt(8)
  v_mfma_f32_16x16x32_bf16 v[16:19], v[216:219], v[192:195], v[16:19]
  ds_read_b64_tr_b16 v[212:213], v239 offset:128
  v_mfma_f32_16x16x32_bf16 v[20:23], v[216:219], v[196:199], v[20:23]
  ds_read_b64_tr_b16 v[214:215], v239 offset:6272
  s_waitcnt lgkmcnt(8)
  v_mfma_f32_16x16x32_bf16 v[24:27], v[220:223], v[192:195], v[24:27]
  ds_read_b64_tr_b16 v[216:217], v236 offset:256
  v_mfma_f32_16x16x32_bf16 v[28:31], v[220:223], v[196:199], v[28:31]
  ds_read_b64_tr_b16 v[218:219], v236 offset:6400
  s_waitcnt lgkmcnt(8)
  v_mfma_f32_16x16x32_bf16 v[32:35], v[224:227], v[192:195], v[32:35]
  ds_read_b64_tr_b16 v[220:221], v237 offset:256
  v_mfma_f32_16x16x32_bf16 v[36:39], v[224:227], v[196:199], v[36:39]
  ds_read_b64_tr_b16 v[222:223], v237 offset:6400
  s_waitcnt lgkmcnt(8)
  v_mfma_f32_16x16x32_bf16 v[40:43], v[228:231], v[192:195], v[40:43]
  ds_read_b64_tr_b16 v[224:225], v238 offset:256
  v_mfma_f32_16x16x32_bf16 v[44:47], v[228:231], v[196:199], v[44:47]
  ds_read_b64_tr_b16 v[226:227], v238 offset:6400
  s_waitcnt lgkmcnt(8)
  v_mfma_f32_16x16x32_bf16 v[48:51], v[208:211], v[192:195], v[48:51]
  ds_read_b64_tr_b16 v[228:229], v239 offset:256
  v_mfma_f32_16x16x32_bf16 v[52:55], v[208:211], v[196:199], v[52:55]
  ds_read_b64_tr_b16 v[230:231], v239 offset:6400
  s_waitcnt lgkmcnt(8)
  v_mfma_f32_16x16x32_bf16 v[56:59], v[212:215], v[192:195], v[56:59]
  ds_read_b64_tr_b16 v[208:209], v236 offset:12288
  v_mfma_f32_16x16x32_bf16 v[60:63], v[212:215], v[196:199], v[60:63]
  ds_read_b64_tr_b16 v[210:211], v236 offset:18432
  s_waitcnt lgkmcnt(8)
  v_mfma_f32_16x16x32_bf16 v[64:67], v[216:219], v[192:195], v[64:67]
  ds_read_b64_tr_b16 v[212:213], v237 offset:12288
  v_mfma_f32_16x16x32_bf16 v[68:71], v[216:219], v[196:199], v[68:71]
  ds_read_b64_tr_b16 v[214:215], v237 offset:18432
  s_waitcnt lgkmcnt(8)
  v_mfma_f32_16x16x32_bf16 v[72:75], v[220:223], v[192:195], v[72:75]
  ds_read_b64_tr_b16 v[216:217], v238 offset:12288
  v_mfma_f32_16x16x32_bf16 v[76:79], v[220:223], v[196:199], v[76:79]
  ds_read_b64_tr_b16 v[218:219], v238 offset:18432
  s_waitcnt lgkmcnt(8)
  v_mfma_f32_16x16x32_bf16 v[80:83], v[224:227], v[192:195], v[80:83]
  ds_read_b64_tr_b16 v[220:221], v239 offset:12288
  v_mfma_f32_16x16x32_bf16 v[84:87], v[224:227], v[196:199], v[84:87]
  ds_read_b64_tr_b16 v[222:223], v239 offset:18432
  s_waitcnt lgkmcnt(8)
  v_mfma_f32_16x16x32_bf16 v[88:91], v[228:231], v[192:195], v[88:91]
  ds_read_b64_tr_b16 v[224:225], v236 offset:12416
  v_mfma_f32_16x16x32_bf16 v[92:95], v[228:231], v[196:199], v[92:95]
  ds_read_b64_tr_b16 v[226:227], v236 offset:18560
  s_waitcnt lgkmcnt(8)
  v_mfma_f32_16x16x32_bf16 v[0:3], v[208:211], v[200:203], v[0:3]
  ds_read_b64_tr_b16 v[228:229], v237 offset:12416
  v_mfma_f32_16x16x32_bf16 v[4:7], v[208:211], v[204:207], v[4:7]
  ds_read_b64_tr_b16 v[230:231], v237 offset:18560
  s_waitcnt lgkmcnt(8)
  v_mfma_f32_16x16x32_bf16 v[8:11], v[212:215], v[200:203], v[8:11]
  ds_read_b64_tr_b16 v[208:209], v238 offset:12416
  v_mfma_f32_16x16x32_bf16 v[12:15], v[212:215], v[204:207], v[12:15]
  ds_read_b64_tr_b16 v[210:211], v238 offset:18560
  s_waitcnt lgkmcnt(8)
  v_mfma_f32_16x16x32_bf16 v[16:19], v[216:219], v[200:203], v[16:19]
  ds_read_b64_tr_b16 v[212:213], v239 offset:12416
  v_mfma_f32_16x16x32_bf16 v[20:23], v[216:219], v[204:207], v[20:23]
  ds_read_b64_tr_b16 v[214:215], v239 offset:18560
  s_waitcnt lgkmcnt(8)
  v_mfma_f32_16x16x32_bf16 v[24:27], v[220:223], v[200:203], v[24:27]
  ds_read_b64_tr_b16 v[216:217], v236 offset:12544
  v_mfma_f32_16x16x32_bf16 v[28:31], v[220:223], v[204:207], v[28:31]
  ds_read_b64_tr_b16 v[218:219], v236 offset:18688
  s_waitcnt lgkmcnt(8)
  v_mfma_f32_16x16x32_bf16 v[32:35], v[224:227], v[200:203], v[32:35]
  ds_read_b64_tr_b16 v[220:221], v237 offset:12544
  v_mfma_f32_16x16x32_bf16 v[36:39], v[224:227], v[204:207], v[36:39]
  ds_read_b64_tr_b16 v[222:223], v237 offset:18688
  s_waitcnt lgkmcnt(8)
  v_mfma_f32_16x16x32_bf16 v[40:43], v[228:231], v[200:203], v[40:43]
  ds_read_b64_tr_b16 v[224:225], v238 offset:12544
  v_mfma_f32_16x16x32_bf16 v[44:47], v[228:231], v[204:207], v[44:47]
  ds_read_b64_tr_b16 v[226:227], v238 offset:18688
  s_waitcnt lgkmcnt(8)
  v_mfma_f32_16x16x32_bf16 v[48:51], v[208:211], v[200:203], v[48:51]
  ds_read_b64_tr_b16 v[228:229], v239 offset:12544
  v_mfma_f32_16x16x32_bf16 v[52:55], v[208:211], v[204:207], v[52:55]
  ds_read_b64_tr_b16 v[230:231], v239 offset:18688
  s_waitcnt lgkmcnt(8)
  v_mfma_f32_16x16x32_bf16 v[56:59], v[212:215], v[200:203], v[56:59]
  v_mfma_f32_16x16x32_bf16 v[60:63], v[212:215], v[204:207], v[60:63]
  s_waitcnt lgkmcnt(6)
  v_mfma_f32_16x16x32_bf16 v[64:67], v[216:219], v[200:203], v[64:67]
  v_mfma_f32_16x16x32_bf16 v[68:71], v[216:219], v[204:207], v[68:71]
  s_waitcnt lgkmcnt(4)
  v_mfma_f32_16x16x32_bf16 v[72:75], v[220:223], v[200:203], v[72:75]
  v_mfma_f32_16x16x32_bf16 v[76:79], v[220:223], v[204:207], v[76:79]
  s_waitcnt lgkmcnt(2)
  v_mfma_f32_16x16x32_bf16 v[80:83], v[224:227], v[200:203], v[80:83]
  v_mfma_f32_16x16x32_bf16 v[84:87], v[224:227], v[204:207], v[84:87]
  s_waitcnt lgkmcnt(0)
  v_mfma_f32_16x16x32_bf16 v[88:91], v[228:231], v[200:203], v[88:91]
  v_mfma_f32_16x16x32_bf16 v[92:95], v[228:231], v[204:207], v[92:95]
  s_branch L_at_epi
L_grpB:
  s_add_u32 s43, s68, s38
  s_add_u32 m0, s43, 24576
  s_nop 0
  buffer_load_dwordx4 v240, s[8:11], s41 offen lds
  s_add_u32 m0, s43, 25600
  s_nop 0
  buffer_load_dwordx4 v241, s[8:11], s41 offen lds
  s_add_u32 m0, s43, 26624
  s_nop 0
  buffer_load_dwordx4 v242, s[8:11], s41 offen lds
  s_add_u32 s69, s41, 12288
  s_add_u32 m0, s43, 36864
  s_nop 0
  buffer_load_dwordx4 v240, s[8:11], s69 offen lds
  s_add_u32 m0, s43, 37888
  s_nop 0
  buffer_load_dwordx4 v241, s[8:11], s69 offen lds
  s_add_u32 m0, s43, 38912
  s_nop 0
  buffer_load_dwordx4 v242, s[8:11], s69 offen lds
  s_add_u32 s41, s41, 24576
  ds_read_b128 v[208:211], v232 offset:0
  ds_read_b128 v[212:215], v233 offset:0
  ds_read_b128 v[216:219], v232 offset:128
  ds_read_b128 v[220:223], v233 offset:128
  ds_read_b128 v[224:227], v232 offset:256
  s_waitcnt lgkmcnt(4)
  v_mfma_f32_16x16x32_bf16 v[144:147], v[208:211], v[96:99], v[176:179]
  ds_read_b128 v[228:231], v233 offset:256
  v_mfma_f32_16x16x32_bf16 v[148:151], v[208:211], v[100:103], v[180:183]
  s_waitcnt lgkmcnt(4)
  v_mfma_f32_16x16x32_bf16 v[144:147], v[212:215], v[104:107], v[144:147]
  ds_read_b128 v[208:211], v232 offset:6144
  v_mfma_f32_16x16x32_bf16 v[148:151], v[212:215], v[108:111], v[148:151]
  s_waitcnt lgkmcnt(4)
  v_mfma_f32_16x16x32_bf16 v[144:147], v[216:219], v[112:115], v[144:147]
  ds_read_b128 v[212:215], v233 offset:6144
  v_mfma_f32_16x16x32_bf16 v[148:151], v[216:219], v[116:119], v[148:151]
  s_waitcnt lgkmcnt(4)
  v_mfma_f32_16x16x32_bf16 v[144:147], v[220:223], v[120:123], v[144:147]
  ds_read_b128 v[216:219], v232 offset:6272
  v_mfma_f32_16x16x32_bf16 v[148:151], v[220:223], v[124:127], v[148:151]
  s_waitcnt lgkmcnt(4)
  v_mfma_f32_16x16x32_bf16 v[144:147], v[224:227], v[128:131], v[144:147]
  ds_read_b128 v[220:223], v233 offset:6272
  v_mfma_f32_16x16x32_bf16 v[148:151], v[224:227], v[132:135], v[148:151]
  s_waitcnt lgkmcnt(4)
  v_mfma_f32_16x16x32_bf16 v[144:147], v[228:231], v[136:139], v[144:147]
  ds_read_b128 v[224:227], v232 offset:6400
  v_mfma_f32_16x16x32_bf16 v[148:151], v[228:231], v[140:143], v[148:151]
  s_waitcnt lgkmcnt(4)
  v_mfma_f32_16x16x32_bf16 v[152:155], v[208:211], v[96:99], v[176:179]
  ds_read_b128 v[228:231], v233 offset:6400
  v_mfma_f32_16x16x32_bf16 v[156:159], v[208:211], v[100:103], v[180:183]
  s_waitcnt lgkmcnt(4)
  v_mfma_f32_16x16x32_bf16 v[152:155], v[212:215], v[104:107], v[152:155]
  ds_read_b128 v[208:211], v232 offset:12288
  v_mfma_f32_16x16x32_bf16 v[156:159], v[212:215], v[108:111], v[156:159]
  s_waitcnt lgkmcnt(4)
  v_mfma_f32_16x16x32_bf16 v[152:155], v[216:219], v[112:115], v[152:155]
  ds_read_b128 v[212:215], v233 offset:12288
  v_mfma_f32_16x16x32_bf16 v[156:159], v[216:219], v[116:119], v[156:159]
  s_waitcnt lgkmcnt(4)
  v_mfma_f32_16x16x32_bf16 v[152:155], v[220:223], v[120:123], v[152:155]
  ds_read_b128 v[216:219], v232 offset:12416
  v_mfma_f32_16x16x32_bf16 v[156:159], v[220:223], v[124:127], v[156:159]
  s_waitcnt lgkmcnt(4)
  v_mfma_f32_16x16x32_bf16 v[152:155], v[224:227], v[128:131], v[152:155]
  ds_read_b128 v[220:223], v233 offset:12416
  v_mfma_f32_16x16x32_bf16 v[156:159], v[224:227], v[132:135], v[156:159]
  s_waitcnt lgkmcnt(4)
  v_mfma_f32_16x16x32_bf16 v[152:155], v[228:231], v[136:139], v[152:155]
  ds_read_b128 v[224:227], v232 offset:12544
  v_mfma_f32_16x16x32_bf16 v[156:159], v[228:231], v[140:143], v[156:159]
  s_waitcnt lgkmcnt(4)
  v_mfma_f32_16x16x32_bf16 v[160:163], v[208:211], v[96:99], v[176:179]
  ds_read_b128 v[228:231], v233 offset:12544
  v_mfma_f32_16x16x32_bf16 v[164:167], v[208:211], v[100:103], v[180:183]
  s_waitcnt lgkmcnt(4)
  v_mfma_f32_16x16x32_bf16 v[160:163], v[212:215], v[104:107], v[160:163]
  ds_read_b128 v[208:211], v232 offset:18432
  v_mfma_f32_16x16x32_bf16 v[164:167], v[212:215], v[108:111], v[164:167]
  s_waitcnt lgkmcnt(4)
  v_mfma_f32_16x16x32_bf16 v[160:163], v[216:219], v[112:115], v[160:163]
  ds_read_b128 v[212:215], v233 offset:18432
  v_mfma_f32_16x16x32_bf16 v[164:167], v[216:219], v[116:119], v[164:167]
  s_waitcnt lgkmcnt(4)
  v_mfma_f32_16x16x32_bf16 v[160:163], v[220:223], v[120:123], v[160:163]
  ds_read_b128 v[216:219], v232 offset:18560
  v_mfma_f32_16x16x32_bf16 v[164:167], v[220:223], v[124:127], v[164:167]
  s_waitcnt lgkmcnt(4)
  v_mfma_f32_16x16x32_bf16 v[160:163], v[224:227], v[128:131], v[160:163]
  ds_read_b128 v[220:223], v233 offset:18560
  v_mfma_f32_16x16x32_bf16 v[164:167], v[224:227], v[132:135], v[164:167]
  s_waitcnt lgkmcnt(4)
  v_mfma_f32_16x16x32_bf16 v[160:163], v[228:231], v[136:139], v[160:163]
  ds_read_b128 v[224:227], v232 offset:18688
  v_mfma_f32_16x16x32_bf16 v[164:167], v[228:231], v[140:143], v[164:167]
  s_waitcnt lgkmcnt(4)
  v_mfma_f32_16x16x32_bf16 v[168:171], v[208:211], v[96:99], v[176:179]
  ds_read_b128 v[228:231], v233 offset:18688
  v_mfma_f32_16x16x32_bf16 v[172:175], v[208:211], v[100:103], v[180:183]
  s_waitcnt lgkmcnt(4)
  v_mfma_f32_16x16x32_bf16 v[168:171], v[212:215], v[104:107], v[168:171]
  v_mfma_f32_16x16x32_bf16 v[172:175], v[212:215], v[108:111], v[172:175]
  s_waitcnt lgkmcnt(3)
  v_mfma_f32_16x16x32_bf16 v[168:171], v[216:219], v[112:115], v[168:171]
  v_mfma_f32_16x16x32_bf16 v[172:175], v[216:219], v[116:119], v[172:175]
  s_waitcnt lgkmcnt(2)
  v_mfma_f32_16x16x32_bf16 v[168:171], v[220:223], v[120:123], v[168:171]
  v_mfma_f32_16x16x32_bf16 v[172:175], v[220:223], v[124:127], v[172:175]
  s_waitcnt lgkmcnt(1)
  v_mfma_f32_16x16x32_bf16 v[168:171], v[224:227], v[128:131], v[168:171]
  v_mfma_f32_16x16x32_bf16 v[172:175], v[224:227], v[132:135], v[172:175]
  s_waitcnt lgkmcnt(0)
  v_mfma_f32_16x16x32_bf16 v[168:171], v[228:231], v[136:139], v[168:171]
  v_mfma_f32_16x16x32_bf16 v[172:175], v[228:231], v[140:143], v[172:175]
  s_waitcnt vmcnt(0)
  s_mov_b32 s38, s37
  s_add_u32 s37, s37, 49152
  s_cmp_eq_u32 s37, 147456
  s_cselect_b32 s37, 0, s37
  s_sub_u32 s42, s37, s38
  v_add_u32 v232, s42, v232
  v_add_u32 v233, s42, v233
  v_add_u32 v236, s42, v236
  v_add_u32 v237, s42, v237
  v_add_u32 v238, s42, v238
  v_add_u32 v239, s42, v239
  s_barrier
L_loopB:
  s_sub_u32 s42, s39, 20
  s_cmp_ge_u32 s42, 3
  s_cbranch_scc1 L_nowpf
  v_lshlrev_b32 v254, 3, v251
  buffer_load_dword v255, v254, s[12:15], s59 offen
  s_add_u32 s59, s59, 1048576
L_nowpf:
  s_setprio 0
  s_nop 7
  v_mov_b32 v245, 0
  v_mov_b32 v246, 0
  s_add_u32 s43, s68, s38
  s_add_u32 m0, s43, 24576
  s_nop 0
  buffer_load_dwordx4 v240, s[8:11], s41 offen lds
  v_exp_f32 v184, v144
  v_exp_f32 v185, v145
  v_exp_f32 v186, v146
  v_exp_f32 v187, v147
  s_add_u32 m0, s43, 25600
  s_nop 0
  buffer_load_dwordx4 v241, s[8:11], s41 offen lds
  v_exp_f32 v188, v148
  v_exp_f32 v189, v149
  v_exp_f32 v190, v150
  v_exp_f32 v191, v151
  v_add_f32 v245, v245, v184
  v_add_f32 v245, v245, v186
  v_cvt_pk_bf16_f32 v192, v184, v185
  v_cvt_pk_bf16_f32 v193, v186, v187
  v_add_f32 v245, v245, v185
  v_add_f32 v245, v245, v187
  s_add_u32 m0, s43, 26624
  s_nop 0
  buffer_load_dwordx4 v242, s[8:11], s41 offen lds
  v_exp_f32 v184, v152
  v_exp_f32 v185, v153
  v_exp_f32 v186, v154
  v_exp_f32 v187, v155
  v_add_f32 v246, v246, v188
  v_add_f32 v246, v246, v190
  v_cvt_pk_bf16_f32 v196, v188, v189
  v_cvt_pk_bf16_f32 v197, v190, v191
  v_add_f32 v246, v246, v189
  v_add_f32 v246, v246, v191
  s_add_u32 s69, s41, 12288
  s_add_u32 m0, s43, 36864
  s_nop 0
  buffer_load_dwordx4 v240, s[8:11], s69 offen lds
  v_exp_f32 v188, v156
  v_exp_f32 v189, v157
  v_exp_f32 v190, v158
  v_exp_f32 v191, v159
  v_add_f32 v245, v245, v184
  v_add_f32 v245, v245, v186
  v_cvt_pk_bf16_f32 v194, v184, v185
  v_cvt_pk_bf16_f32 v195, v186, v187
  v_add_f32 v245, v245, v185
  v_add_f32 v245, v245, v187
  s_add_u32 m0, s43, 37888
  s_nop 0
  buffer_load_dwordx4 v241, s[8:11], s69 offen lds
  v_exp_f32 v184, v160
  v_exp_f32 v185, v161
  v_exp_f32 v186, v162
  v_exp_f32 v187, v163
  v_add_f32 v246, v246, v188
  v_add_f32 v246, v246, v190
  v_cvt_pk_bf16_f32 v198, v188, v189
  v_cvt_pk_bf16_f32 v199, v190, v191
  v_add_f32 v246, v246, v189
  v_add_f32 v246, v246, v191
  s_add_u32 m0, s43, 38912
  s_nop 0
  buffer_load_dwordx4 v242, s[8:11], s69 offen lds
  s_add_u32 s41, s41, 24576
  v_exp_f32 v188, v164
  v_exp_f32 v189, v165
  v_exp_f32 v190, v166
  v_exp_f32 v191, v167
  v_add_f32 v245, v245, v184
  v_add_f32 v245, v245, v186
  v_cvt_pk_bf16_f32 v200, v184, v185
  v_cvt_pk_bf16_f32 v201, v186, v187
  v_add_f32 v245, v245, v185
  v_add_f32 v245, v245, v187
  v_exp_f32 v184, v168
  v_exp_f32 v185, v169
  v_exp_f32 v186, v170
  v_exp_f32 v187, v171
  v_add_f32 v246, v246, v188
  v_add_f32 v246, v246, v190
  v_cvt_pk_bf16_f32 v204, v188, v189
  v_cvt_pk_bf16_f32 v205, v190, v191
  v_add_f32 v246, v246, v189
  v_add_f32 v246, v246, v191
  v_exp_f32 v188, v172
  v_exp_f32 v189, v173
  v_exp_f32 v190, v174
  v_exp_f32 v191, v175
  v_add_f32 v245, v245, v184
  v_add_f32 v245, v245, v186
  v_cvt_pk_bf16_f32 v202, v184, v185
  v_cvt_pk_bf16_f32 v203, v186, v187
  v_add_f32 v245, v245, v185
  v_add_f32 v245, v245, v187
  s_nop 0
  v_add_f32 v246, v246, v188
  v_add_f32 v246, v246, v190
  v_cvt_pk_bf16_f32 v206, v188, v189
  v_cvt_pk_bf16_f32 v207, v190, v191
  v_add_f32 v246, v246, v189
  v_add_f32 v246, v246, v191
  v_add_f32 v253, v245, v246
  v_cmp_nge_f32 vcc, s45, v253
  s_cbranch_vccz L_sm_ok_B1
  v_max3_f32 v252, v144, v145, v146
  v_max3_f32 v252, v252, v147, v152
  v_max3_f32 v252, v252, v153, v154
  v_max3_f32 v252, v252, v155, v160
  v_max3_f32 v252, v252, v161, v162
  v_max3_f32 v252, v252, v163, v168
  v_max3_f32 v252, v252, v169, v170
  v_max_f32 v252, v252, v171
  ds_swizzle_b32 v253, v252 offset:0x401F
  s_waitcnt lgkmcnt(0)
  v_max_f32 v252, v252, v253
  v_mov_b32 v253, v252
  s_nop 1
  v_permlane32_swap_b32 v252, v253
  s_nop 1
  v_max_f32 v252, v252, v253
  v_max_f32 v252, s46, v252
  v_sub_f32 v253, v176, v252
  v_mov_b32 v176, v253
  v_mov_b32 v177, v253
  v_mov_b32 v178, v253
  v_mov_b32 v179, v253
  v_sub_f32 v144, v144, v252
  v_sub_f32 v145, v145, v252
  v_sub_f32 v146, v146, v252
  v_sub_f32 v147, v147, v252
  v_sub_f32 v152, v152, v252
  v_sub_f32 v153, v153, v252
  v_sub_f32 v154, v154, v252
  v_sub_f32 v155, v155, v252
  v_sub_f32 v160, v160, v252
  v_sub_f32 v161, v161, v252
  v_sub_f32 v162, v162, v252
  v_sub_f32 v163, v163, v252
  v_sub_f32 v168, v168, v252
  v_sub_f32 v169, v169, v252
  v_sub_f32 v170, v170, v252
  v_sub_f32 v171, v171, v252
  v_max_f32 v252, 0, v252
  v_sub_f32 v252, 0, v252
  v_exp_f32 v252, v252
  s_nop 0
  v_mul_f32 v0, v0, v252
  v_mul_f32 v1, v1, v252
  v_mul_f32 v2, v2, v252
  v_mul_f32 v3, v3, v252
  v_mul_f32 v8, v8, v252
  v_mul_f32 v9, v9, v252
  v_mul_f32 v10, v10, v252
  v_mul_f32 v11, v11, v252
  v_mul_f32 v16, v16, v252
  v_mul_f32 v17, v17, v252
  v_mul_f32 v18, v18, v252
  v_mul_f32 v19, v19, v252
  v_mul_f32 v24, v24, v252
  v_mul_f32 v25, v25, v252
  v_mul_f32 v26, v26, v252
  v_mul_f32 v27, v27, v252
  v_mul_f32 v32, v32, v252
  v_mul_f32 v33, v33, v252
  v_mul_f32 v34, v34, v252
  v_mul_f32 v35, v35, v252
  v_mul_f32 v40, v40, v252
  v_mul_f32 v41, v41, v252
  v_mul_f32 v42, v42, v252
  v_mul_f32 v43, v43, v252
  v_mul_f32 v48, v48, v252
  v_mul_f32 v49, v49, v252
  v_mul_f32 v50, v50, v252
  v_mul_f32 v51, v51, v252
  v_mul_f32 v56, v56, v252
  v_mul_f32 v57, v57, v252
  v_mul_f32 v58, v58, v252
  v_mul_f32 v59, v59, v252
  v_mul_f32 v64, v64, v252
  v_mul_f32 v65, v65, v252
  v_mul_f32 v66, v66, v252
  v_mul_f32 v67, v67, v252
  v_mul_f32 v72, v72, v252
  v_mul_f32 v73, v73, v252
  v_mul_f32 v74, v74, v252
  v_mul_f32 v75, v75, v252
  v_mul_f32 v80, v80, v252
  v_mul_f32 v81, v81, v252
  v_mul_f32 v82, v82, v252
  v_mul_f32 v83, v83, v252
  v_mul_f32 v88, v88, v252
  v_mul_f32 v89, v89, v252
  v_mul_f32 v90, v90, v252
  v_mul_f32 v91, v91, v252
  v_mul_f32 v243, v243, v252
  v_max3_f32 v252, v148, v149, v150
  v_max3_f32 v252, v252, v151, v156
  v_max3_f32 v252, v252, v157, v158
  v_max3_f32 v252, v252, v159, v164
  v_max3_f32 v252, v252, v165, v166
  v_max3_f32 v252, v252, v167, v172
  v_max3_f32 v252, v252, v173, v174
  v_max_f32 v252, v252, v175
  ds_swizzle_b32 v253, v252 offset:0x401F
  s_waitcnt lgkmcnt(0)
  v_max_f32 v252, v252, v253
  v_mov_b32 v253, v252
  s_nop 1
  v_permlane32_swap_b32 v252, v253
  s_nop 1
  v_max_f32 v252, v252, v253
  v_max_f32 v252, s46, v252
  v_sub_f32 v253, v180, v252
  v_mov_b32 v180, v253
  v_mov_b32 v181, v253
  v_mov_b32 v182, v253
  v_mov_b32 v183, v253
  v_sub_f32 v148, v148, v252
  v_sub_f32 v149, v149, v252
  v_sub_f32 v150, v150, v252
  v_sub_f32 v151, v151, v252
  v_sub_f32 v156, v156, v252
  v_sub_f32 v157, v157, v252
  v_sub_f32 v158, v158, v252
  v_sub_f32 v159, v159, v252
  v_sub_f32 v164, v164, v252
  v_sub_f32 v165, v165, v252
  v_sub_f32 v166, v166, v252
  v_sub_f32 v167, v167, v252
  v_sub_f32 v172, v172, v252
  v_sub_f32 v173, v173, v252
  v_sub_f32 v174, v174, v252
  v_sub_f32 v175, v175, v252
  v_max_f32 v252, 0, v252
  v_sub_f32 v252, 0, v252
  v_exp_f32 v252, v252
  s_nop 0
  v_mul_f32 v4, v4, v252
  v_mul_f32 v5, v5, v252
  v_mul_f32 v6, v6, v252
  v_mul_f32 v7, v7, v252
  v_mul_f32 v12, v12, v252
  v_mul_f32 v13, v13, v252
  v_mul_f32 v14, v14, v252
  v_mul_f32 v15, v15, v252
  v_mul_f32 v20, v20, v252
  v_mul_f32 v21, v21, v252
  v_mul_f32 v22, v22, v252
  v_mul_f32 v23, v23, v252
  v_mul_f32 v28, v28, v252
  v_mul_f32 v29, v29, v252
  v_mul_f32 v30, v30, v252
  v_mul_f32 v31, v31, v252
  v_mul_f32 v36, v36, v252
  v_mul_f32 v37, v37, v252
  v_mul_f32 v38, v38, v252
  v_mul_f32 v39, v39, v252
  v_mul_f32 v44, v44, v252
  v_mul_f32 v45, v45, v252
  v_mul_f32 v46, v46, v252
  v_mul_f32 v47, v47, v252
  v_mul_f32 v52, v52, v252
  v_mul_f32 v53, v53, v252
  v_mul_f32 v54, v54, v252
  v_mul_f32 v55, v55, v252
  v_mul_f32 v60, v60, v252
  v_mul_f32 v61, v61, v252
  v_mul_f32 v62, v62, v252
  v_mul_f32 v63, v63, v252
  v_mul_f32 v68, v68, v252
  v_mul_f32 v69, v69, v252
  v_mul_f32 v70, v70, v252
  v_mul_f32 v71, v71, v252
  v_mul_f32 v76, v76, v252
  v_mul_f32 v77, v77, v252
  v_mul_f32 v78, v78, v252
  v_mul_f32 v79, v79, v252
  v_mul_f32 v84, v84, v252
  v_mul_f32 v85, v85, v252
  v_mul_f32 v86, v86, v252
  v_mul_f32 v87, v87, v252
  v_mul_f32 v92, v92, v252
  v_mul_f32 v93, v93, v252
  v_mul_f32 v94, v94, v252
  v_mul_f32 v95, v95, v252
  v_mul_f32 v244, v244, v252
  v_mov_b32 v245, 0
  v_mov_b32 v246, 0
  v_exp_f32 v184, v144
  v_exp_f32 v185, v145
  v_exp_f32 v186, v146
  v_exp_f32 v187, v147
  v_exp_f32 v188, v148
  v_exp_f32 v189, v149
  v_exp_f32 v190, v150
  v_exp_f32 v191, v151
  v_add_f32 v245, v245, v184
  v_add_f32 v245, v245, v186
  v_cvt_pk_bf16_f32 v192, v184, v185
  v_cvt_pk_bf16_f32 v193, v186, v187
  v_add_f32 v245, v245, v185
  v_add_f32 v245, v245, v187
  v_exp_f32 v184, v152
  v_exp_f32 v185, v153
  v_exp_f32 v186, v154
  v_exp_f32 v187, v155
  v_add_f32 v246, v246, v188
  v_add_f32 v246, v246, v190
  v_cvt_pk_bf16_f32 v196, v188, v189
  v_cvt_pk_bf16_f32 v197, v190, v191
  v_add_f32 v246, v246, v189
  v_add_f32 v246, v246, v191
  v_exp_f32 v188, v156
  v_exp_f32 v189, v157
  v_exp_f32 v190, v158
  v_exp_f32 v191, v159
  v_add_f32 v245, v245, v184
  v_add_f32 v245, v245, v186
  v_cvt_pk_bf16_f32 v194, v184, v185
  v_cvt_pk_bf16_f32 v195, v186, v187
  v_add_f32 v245, v245, v185
  v_add_f32 v245, v245, v187
  v_exp_f32 v184, v160
  v_exp_f32 v185, v161
  v_exp_f32 v186, v162
  v_exp_f32 v187, v163
  v_add_f32 v246, v246, v188
  v_add_f32 v246, v246, v190
  v_cvt_pk_bf16_f32 v198, v188, v189
  v_cvt_pk_bf16_f32 v199, v190, v191
  v_add_f32 v246, v246, v189
  v_add_f32 v246, v246, v191
  v_exp_f32 v188, v164
  v_exp_f32 v189, v165
  v_exp_f32 v190, v166
  v_exp_f32 v191, v167
  v_add_f32 v245, v245, v184
  v_add_f32 v245, v245, v186
  v_cvt_pk_bf16_f32 v200, v184, v185
  v_cvt_pk_bf16_f32 v201, v186, v187
  v_add_f32 v245, v245, v185
  v_add_f32 v245, v245, v187
  v_exp_f32 v184, v168
  v_exp_f32 v185, v169
  v_exp_f32 v186, v170
  v_exp_f32 v187, v171
  v_add_f32 v246, v246, v188
  v_add_f32 v246, v246, v190
  v_cvt_pk_bf16_f32 v204, v188, v189
  v_cvt_pk_bf16_f32 v205, v190, v191
  v_add_f32 v246, v246, v189
  v_add_f32 v246, v246, v191
  v_exp_f32 v188, v172
  v_exp_f32 v189, v173
  v_exp_f32 v190, v174
  v_exp_f32 v191, v175
  v_add_f32 v245, v245, v184
  v_add_f32 v245, v245, v186
  v_cvt_pk_bf16_f32 v202, v184, v185
  v_cvt_pk_bf16_f32 v203, v186, v187
  v_add_f32 v245, v245, v185
  v_add_f32 v245, v245, v187
  s_nop 0
  v_add_f32 v246, v246, v188
  v_add_f32 v246, v246, v190
  v_cvt_pk_bf16_f32 v206, v188, v189
  v_cvt_pk_bf16_f32 v207, v190, v191
  v_add_f32 v246, v246, v189
  v_add_f32 v246, v246, v191
  s_mov_b32 s45, 1199570944
  s_mov_b32 s46, 0
  s_nop 1
L_sm_ok_B1:
  v_add_f32 v243, v243, v245
  v_add_f32 v244, v244, v246
  s_setprio 1
  ds_read_b64_tr_b16 v[208:209], v236 offset:0
  ds_read_b64_tr_b16 v[210:211], v236 offset:6144
  ds_read_b64_tr_b16 v[212:213], v237 offset:0
  ds_read_b64_tr_b16 v[214:215], v237 offset:6144
  ds_read_b64_tr_b16 v[216:217], v238 offset:0
  ds_read_b64_tr_b16 v[218:219], v238 offset:6144
  ds_read_b64_tr_b16 v[220:221], v239 offset:0
  ds_read_b64_tr_b16 v[222:223], v239 offset:6144
  ds_read_b64_tr_b16 v[224:225], v236 offset:128
  ds_read_b64_tr_b16 v[226:227], v236 offset:6272
  s_waitcnt lgkmcnt(8)
  v_mfma_f32_16x16x32_bf16 v[0:3], v[208:211], v[192:195], v[0:3]
  ds_read_b64_tr_b16 v[228:229], v237 offset:128
  v_mfma_f32_16x16x32_bf16 v[4:7], v[208:211], v[196:199], v[4:7]
  ds_read_b64_tr_b16 v[230:231], v237 offset:6272
  s_waitcnt lgkmcnt(8)
  v_mfma_f32_16x16x32_bf16 v[8:11], v[212:215], v[192:195], v[8:11]
  ds_read_b64_tr_b16 v[208:209], v238 offset:128
  v_mfma_f32_16x16x32_bf16 v[12:15], v[212:215], v[196:199], v[12:15]
  ds_read_b64_tr_b16 v[210:211], v238 offset:6272
  s_waitcnt lgkmcnt(8)
  v_mfma_f32_16x16x32_bf16 v[16:19], v[216:219], v[192:195], v[16:19]
  ds_read_b64_tr_b16 v[212:213], v239 offset:128
  v_mfma_f32_16x16x32_bf16 v[20:23], v[216:219], v[196:199], v[20:23]
  ds_read_b64_tr_b16 v[214:215], v239 offset:6272
  s_waitcnt lgkmcnt(8)
  v_mfma_f32_16x16x32_bf16 v[24:27], v[220:223], v[192:195], v[24:27]
  ds_read_b64_tr_b16 v[216:217], v236 offset:256
  v_mfma_f32_16x16x32_bf16 v[28:31], v[220:223], v[196:199], v[28:31]
  ds_read_b64_tr_b16 v[218:219], v236 offset:6400
  s_waitcnt lgkmcnt(8)
  v_mfma_f32_16x16x32_bf16 v[32:35], v[224:227], v[192:195], v[32:35]
  ds_read_b64_tr_b16 v[220:221], v237 offset:256
  v_mfma_f32_16x16x32_bf16 v[36:39], v[224:227], v[196:199], v[36:39]
  ds_read_b64_tr_b16 v[222:223], v237 offset:6400
  s_waitcnt lgkmcnt(8)
  v_mfma_f32_16x16x32_bf16 v[40:43], v[228:231], v[192:195], v[40:43]
  ds_read_b64_tr_b16 v[224:225], v238 offset:256
  v_mfma_f32_16x16x32_bf16 v[44:47], v[228:231], v[196:199], v[44:47]
  ds_read_b64_tr_b16 v[226:227], v238 offset:6400
  s_waitcnt lgkmcnt(8)
  v_mfma_f32_16x16x32_bf16 v[48:51], v[208:211], v[192:195], v[48:51]
  ds_read_b64_tr_b16 v[228:229], v239 offset:256
  v_mfma_f32_16x16x32_bf16 v[52:55], v[208:211], v[196:199], v[52:55]
  ds_read_b64_tr_b16 v[230:231], v239 offset:6400
  s_waitcnt lgkmcnt(8)
  v_mfma_f32_16x16x32_bf16 v[56:59], v[212:215], v[192:195], v[56:59]
  ds_read_b64_tr_b16 v[208:209], v236 offset:12288
  v_mfma_f32_16x16x32_bf16 v[60:63], v[212:215], v[196:199], v[60:63]
  ds_read_b64_tr_b16 v[210:211], v236 offset:18432
  s_waitcnt lgkmcnt(8)
  v_mfma_f32_16x16x32_bf16 v[64:67], v[216:219], v[192:195], v[64:67]
  ds_read_b64_tr_b16 v[212:213], v237 offset:12288
  v_mfma_f32_16x16x32_bf16 v[68:71], v[216:219], v[196:199], v[68:71]
  ds_read_b64_tr_b16 v[214:215], v237 offset:18432
  s_waitcnt lgkmcnt(8)
  v_mfma_f32_16x16x32_bf16 v[72:75], v[220:223], v[192:195], v[72:75]
  ds_read_b64_tr_b16 v[216:217], v238 offset:12288
  v_mfma_f32_16x16x32_bf16 v[76:79], v[220:223], v[196:199], v[76:79]
  ds_read_b64_tr_b16 v[218:219], v238 offset:18432
  s_waitcnt lgkmcnt(8)
  v_mfma_f32_16x16x32_bf16 v[80:83], v[224:227], v[192:195], v[80:83]
  ds_read_b64_tr_b16 v[220:221], v239 offset:12288
  v_mfma_f32_16x16x32_bf16 v[84:87], v[224:227], v[196:199], v[84:87]
  ds_read_b64_tr_b16 v[222:223], v239 offset:18432
  s_waitcnt lgkmcnt(8)
  v_mfma_f32_16x16x32_bf16 v[88:91], v[228:231], v[192:195], v[88:91]
  ds_read_b64_tr_b16 v[224:225], v236 offset:12416
  v_mfma_f32_16x16x32_bf16 v[92:95], v[228:231], v[196:199], v[92:95]
  ds_read_b64_tr_b16 v[226:227], v236 offset:18560
  s_waitcnt lgkmcnt(8)
  v_mfma_f32_16x16x32_bf16 v[0:3], v[208:211], v[200:203], v[0:3]
  ds_read_b64_tr_b16 v[228:229], v237 offset:12416
  v_mfma_f32_16x16x32_bf16 v[4:7], v[208:211], v[204:207], v[4:7]
  ds_read_b64_tr_b16 v[230:231], v237 offset:18560
  s_waitcnt lgkmcnt(8)
  v_mfma_f32_16x16x32_bf16 v[8:11], v[212:215], v[200:203], v[8:11]
  ds_read_b64_tr_b16 v[208:209], v238 offset:12416
  v_mfma_f32_16x16x32_bf16 v[12:15], v[212:215], v[204:207], v[12:15]
  ds_read_b64_tr_b16 v[210:211], v238 offset:18560
  s_waitcnt lgkmcnt(8)
  v_mfma_f32_16x16x32_bf16 v[16:19], v[216:219], v[200:203], v[16:19]
  ds_read_b64_tr_b16 v[212:213], v239 offset:12416
  v_mfma_f32_16x16x32_bf16 v[20:23], v[216:219], v[204:207], v[20:23]
  ds_read_b64_tr_b16 v[214:215], v239 offset:18560
  s_waitcnt lgkmcnt(8)
  v_mfma_f32_16x16x32_bf16 v[24:27], v[220:223], v[200:203], v[24:27]
  ds_read_b64_tr_b16 v[216:217], v236 offset:12544
  v_mfma_f32_16x16x32_bf16 v[28:31], v[220:223], v[204:207], v[28:31]
  ds_read_b64_tr_b16 v[218:219], v236 offset:18688
  s_waitcnt lgkmcnt(8)
  v_mfma_f32_16x16x32_bf16 v[32:35], v[224:227], v[200:203], v[32:35]
  ds_read_b64_tr_b16 v[220:221], v237 offset:12544
  v_mfma_f32_16x16x32_bf16 v[36:39], v[224:227], v[204:207], v[36:39]
  ds_read_b64_tr_b16 v[222:223], v237 offset:18688
  s_waitcnt lgkmcnt(8)
  v_mfma_f32_16x16x32_bf16 v[40:43], v[228:231], v[200:203], v[40:43]
  ds_read_b64_tr_b16 v[224:225], v238 offset:12544
  v_mfma_f32_16x16x32_bf16 v[44:47], v[228:231], v[204:207], v[44:47]
  ds_read_b64_tr_b16 v[226:227], v238 offset:18688
  s_waitcnt lgkmcnt(8)
  v_mfma_f32_16x16x32_bf16 v[48:51], v[208:211], v[200:203], v[48:51]
  ds_read_b64_tr_b16 v[228:229], v239 offset:12544
  v_mfma_f32_16x16x32_bf16 v[52:55], v[208:211], v[204:207], v[52:55]
  ds_read_b64_tr_b16 v[230:231], v239 offset:18688
  s_waitcnt lgkmcnt(8)
  v_mfma_f32_16x16x32_bf16 v[56:59], v[212:215], v[200:203], v[56:59]
  ds_read_b128 v[208:211], v232 offset:0
  v_mfma_f32_16x16x32_bf16 v[60:63], v[212:215], v[204:207], v[60:63]
  s_waitcnt lgkmcnt(7)
  v_mfma_f32_16x16x32_bf16 v[64:67], v[216:219], v[200:203], v[64:67]
  ds_read_b128 v[212:215], v233 offset:0
  v_mfma_f32_16x16x32_bf16 v[68:71], v[216:219], v[204:207], v[68:71]
  s_waitcnt lgkmcnt(6)
  v_mfma_f32_16x16x32_bf16 v[72:75], v[220:223], v[200:203], v[72:75]
  ds_read_b128 v[216:219], v232 offset:128
  v_mfma_f32_16x16x32_bf16 v[76:79], v[220:223], v[204:207], v[76:79]
  s_waitcnt lgkmcnt(5)
  v_mfma_f32_16x16x32_bf16 v[80:83], v[224:227], v[200:203], v[80:83]
  ds_read_b128 v[220:223], v233 offset:128
  v_mfma_f32_16x16x32_bf16 v[84:87], v[224:227], v[204:207], v[84:87]
  s_waitcnt lgkmcnt(4)
  v_mfma_f32_16x16x32_bf16 v[88:91], v[228:231], v[200:203], v[88:91]
  ds_read_b128 v[224:227], v232 offset:256
  v_mfma_f32_16x16x32_bf16 v[92:95], v[228:231], v[204:207], v[92:95]
  s_waitcnt lgkmcnt(4)
  v_mfma_f32_16x16x32_bf16 v[144:147], v[208:211], v[96:99], v[176:179]
  ds_read_b128 v[228:231], v233 offset:256
  v_mfma_f32_16x16x32_bf16 v[148:151], v[208:211], v[100:103], v[180:183]
  s_waitcnt lgkmcnt(4)
  v_mfma_f32_16x16x32_bf16 v[144:147], v[212:215], v[104:107], v[144:147]
  ds_read_b128 v[208:211], v232 offset:6144
  v_mfma_f32_16x16x32_bf16 v[148:151], v[212:215], v[108:111], v[148:151]
  s_waitcnt lgkmcnt(4)
  v_mfma_f32_16x16x32_bf16 v[144:147], v[216:219], v[112:115], v[144:147]
  ds_read_b128 v[212:215], v233 offset:6144
  v_mfma_f32_16x16x32_bf16 v[148:151], v[216:219], v[116:119], v[148:151]
  s_waitcnt lgkmcnt(4)
  v_mfma_f32_16x16x32_bf16 v[144:147], v[220:223], v[120:123], v[144:147]
  ds_read_b128 v[216:219], v232 offset:6272
  v_mfma_f32_16x16x32_bf16 v[148:151], v[220:223], v[124:127], v[148:151]
  s_waitcnt lgkmcnt(4)
  v_mfma_f32_16x16x32_bf16 v[144:147], v[224:227], v[128:131], v[144:147]
  ds_read_b128 v[220:223], v233 offset:6272
  v_mfma_f32_16x16x32_bf16 v[148:151], v[224:227], v[132:135], v[148:151]
  s_waitcnt lgkmcnt(4)
  v_mfma_f32_16x16x32_bf16 v[144:147], v[228:231], v[136:139], v[144:147]
  ds_read_b128 v[224:227], v232 offset:6400
  v_mfma_f32_16x16x32_bf16 v[148:151], v[228:231], v[140:143], v[148:151]
  s_waitcnt lgkmcnt(4)
  v_mfma_f32_16x16x32_bf16 v[152:155], v[208:211], v[96:99], v[176:179]
  ds_read_b128 v[228:231], v233 offset:6400
  v_mfma_f32_16x16x32_bf16 v[156:159], v[208:211], v[100:103], v[180:183]
  s_waitcnt lgkmcnt(4)
  v_mfma_f32_16x16x32_bf16 v[152:155], v[212:215], v[104:107], v[152:155]
  ds_read_b128 v[208:211], v232 offset:12288
  v_mfma_f32_16x16x32_bf16 v[156:159], v[212:215], v[108:111], v[156:159]
  s_waitcnt lgkmcnt(4)
  v_mfma_f32_16x16x32_bf16 v[152:155], v[216:219], v[112:115], v[152:155]
  ds_read_b128 v[212:215], v233 offset:12288
  v_mfma_f32_16x16x32_bf16 v[156:159], v[216:219], v[116:119], v[156:159]
  s_waitcnt lgkmcnt(4)
  v_mfma_f32_16x16x32_bf16 v[152:155], v[220:223], v[120:123], v[152:155]
  ds_read_b128 v[216:219], v232 offset:12416
  v_mfma_f32_16x16x32_bf16 v[156:159], v[220:223], v[124:127], v[156:159]
  s_waitcnt lgkmcnt(4)
  v_mfma_f32_16x16x32_bf16 v[152:155], v[224:227], v[128:131], v[152:155]
  ds_read_b128 v[220:223], v233 offset:12416
  v_mfma_f32_16x16x32_bf16 v[156:159], v[224:227], v[132:135], v[156:159]
  s_waitcnt lgkmcnt(4)
  v_mfma_f32_16x16x32_bf16 v[152:155], v[228:231], v[136:139], v[152:155]
  ds_read_b128 v[224:227], v232 offset:12544
  v_mfma_f32_16x16x32_bf16 v[156:159], v[228:231], v[140:143], v[156:159]
  s_waitcnt lgkmcnt(4)
  v_mfma_f32_16x16x32_bf16 v[160:163], v[208:211], v[96:99], v[176:179]
  ds_read_b128 v[228:231], v233 offset:12544
  v_mfma_f32_16x16x32_bf16 v[164:167], v[208:211], v[100:103], v[180:183]
  s_waitcnt lgkmcnt(4)
  v_mfma_f32_16x16x32_bf16 v[160:163], v[212:215], v[104:107], v[160:163]
  ds_read_b128 v[208:211], v232 offset:18432
  v_mfma_f32_16x16x32_bf16 v[164:167], v[212:215], v[108:111], v[164:167]
  s_waitcnt lgkmcnt(4)
  v_mfma_f32_16x16x32_bf16 v[160:163], v[216:219], v[112:115], v[160:163]
  ds_read_b128 v[212:215], v233 offset:18432
  v_mfma_f32_16x16x32_bf16 v[164:167], v[216:219], v[116:119], v[164:167]
  s_waitcnt lgkmcnt(4)
  v_mfma_f32_16x16x32_bf16 v[160:163], v[220:223], v[120:123], v[160:163]
  ds_read_b128 v[216:219], v232 offset:18560
  v_mfma_f32_16x16x32_bf16 v[164:167], v[220:223], v[124:127], v[164:167]
  s_waitcnt lgkmcnt(4)
  v_mfma_f32_16x16x32_bf16 v[160:163], v[224:227], v[128:131], v[160:163]
  ds_read_b128 v[220:223], v233 offset:18560
  v_mfma_f32_16x16x32_bf16 v[164:167], v[224:227], v[132:135], v[164:167]
  s_waitcnt lgkmcnt(4)
  v_mfma_f32_16x16x32_bf16 v[160:163], v[228:231], v[136:139], v[160:163]
  ds_read_b128 v[224:227], v232 offset:18688
  v_mfma_f32_16x16x32_bf16 v[164:167], v[228:231], v[140:143], v[164:167]
  s_waitcnt lgkmcnt(4)
  v_mfma_f32_16x16x32_bf16 v[168:171], v[208:211], v[96:99], v[176:179]
  ds_read_b128 v[228:231], v233 offset:18688
  v_mfma_f32_16x16x32_bf16 v[172:175], v[208:211], v[100:103], v[180:183]
  s_waitcnt lgkmcnt(4)
  v_mfma_f32_16x16x32_bf16 v[168:171], v[212:215], v[104:107], v[168:171]
  v_mfma_f32_16x16x32_bf16 v[172:175], v[212:215], v[108:111], v[172:175]
  s_waitcnt lgkmcnt(3)
  v_mfma_f32_16x16x32_bf16 v[168:171], v[216:219], v[112:115], v[168:171]
  v_mfma_f32_16x16x32_bf16 v[172:175], v[216:219], v[116:119], v[172:175]
  s_waitcnt lgkmcnt(2)
  v_mfma_f32_16x16x32_bf16 v[168:171], v[220:223], v[120:123], v[168:171]
  v_mfma_f32_16x16x32_bf16 v[172:175], v[220:223], v[124:127], v[172:175]
  s_waitcnt lgkmcnt(1)
  v_mfma_f32_16x16x32_bf16 v[168:171], v[224:227], v[128:131], v[168:171]
  v_mfma_f32_16x16x32_bf16 v[172:175], v[224:227], v[132:135], v[172:175]
  s_waitcnt lgkmcnt(0)
  v_mfma_f32_16x16x32_bf16 v[168:171], v[228:231], v[136:139], v[168:171]
  v_mfma_f32_16x16x32_bf16 v[172:175], v[228:231], v[140:143], v[172:175]
  s_waitcnt vmcnt(0)
  s_mov_b32 s38, s37
  s_add_u32 s37, s37, 49152
  s_cmp_eq_u32 s37, 147456
  s_cselect_b32 s37, 0, s37
  s_sub_u32 s42, s37, s38
  v_add_u32 v232, s42, v232
  v_add_u32 v233, s42, v233
  v_add_u32 v236, s42, v236
  v_add_u32 v237, s42, v237
  v_add_u32 v238, s42, v238
  v_add_u32 v239, s42, v239
  s_barrier
  s_add_u32 s39, s39, 1
  s_cmp_lt_u32 s39, 32
  s_cbranch_scc1 L_loopB
  s_setprio 0
  s_nop 7
  v_mov_b32 v245, 0
  v_mov_b32 v246, 0
  v_exp_f32 v184, v144
  v_exp_f32 v185, v145
  v_exp_f32 v186, v146
  v_exp_f32 v187, v147
  v_exp_f32 v188, v148
  v_exp_f32 v189, v149
  v_exp_f32 v190, v150
  v_exp_f32 v191, v151
  v_add_f32 v245, v245, v184
  v_add_f32 v245, v245, v186
  v_cvt_pk_bf16_f32 v192, v184, v185
  v_cvt_pk_bf16_f32 v193, v186, v187
  v_add_f32 v245, v245, v185
  v_add_f32 v245, v245, v187
  v_exp_f32 v184, v152
  v_exp_f32 v185, v153
  v_exp_f32 v186, v154
  v_exp_f32 v187, v155
  v_add_f32 v246, v246, v188
  v_add_f32 v246, v246, v190
  v_cvt_pk_bf16_f32 v196, v188, v189
  v_cvt_pk_bf16_f32 v197, v190, v191
  v_add_f32 v246, v246, v189
  v_add_f32 v246, v246, v191
  v_exp_f32 v188, v156
  v_exp_f32 v189, v157
  v_exp_f32 v190, v158
  v_exp_f32 v191, v159
  v_add_f32 v245, v245, v184
  v_add_f32 v245, v245, v186
  v_cvt_pk_bf16_f32 v194, v184, v185
  v_cvt_pk_bf16_f32 v195, v186, v187
  v_add_f32 v245, v245, v185
  v_add_f32 v245, v245, v187
  v_exp_f32 v184, v160
  v_exp_f32 v185, v161
  v_exp_f32 v186, v162
  v_exp_f32 v187, v163
  v_add_f32 v246, v246, v188
  v_add_f32 v246, v246, v190
  v_cvt_pk_bf16_f32 v198, v188, v189
  v_cvt_pk_bf16_f32 v199, v190, v191
  v_add_f32 v246, v246, v189
  v_add_f32 v246, v246, v191
  v_exp_f32 v188, v164
  v_exp_f32 v189, v165
  v_exp_f32 v190, v166
  v_exp_f32 v191, v167
  v_add_f32 v245, v245, v184
  v_add_f32 v245, v245, v186
  v_cvt_pk_bf16_f32 v200, v184, v185
  v_cvt_pk_bf16_f32 v201, v186, v187
  v_add_f32 v245, v245, v185
  v_add_f32 v245, v245, v187
  v_exp_f32 v184, v168
  v_exp_f32 v185, v169
  v_exp_f32 v186, v170
  v_exp_f32 v187, v171
  v_add_f32 v246, v246, v188
  v_add_f32 v246, v246, v190
  v_cvt_pk_bf16_f32 v204, v188, v189
  v_cvt_pk_bf16_f32 v205, v190, v191
  v_add_f32 v246, v246, v189
  v_add_f32 v246, v246, v191
  v_exp_f32 v188, v172
  v_exp_f32 v189, v173
  v_exp_f32 v190, v174
  v_exp_f32 v191, v175
  v_add_f32 v245, v245, v184
  v_add_f32 v245, v245, v186
  v_cvt_pk_bf16_f32 v202, v184, v185
  v_cvt_pk_bf16_f32 v203, v186, v187
  v_add_f32 v245, v245, v185
  v_add_f32 v245, v245, v187
  s_nop 0
  v_add_f32 v246, v246, v188
  v_add_f32 v246, v246, v190
  v_cvt_pk_bf16_f32 v206, v188, v189
  v_cvt_pk_bf16_f32 v207, v190, v191
  v_add_f32 v246, v246, v189
  v_add_f32 v246, v246, v191
  v_add_f32 v253, v245, v246
  v_cmp_nge_f32 vcc, s45, v253
  s_cbranch_vccz L_sm_ok_B2
  v_max3_f32 v252, v144, v145, v146
  v_max3_f32 v252, v252, v147, v152
  v_max3_f32 v252, v252, v153, v154
  v_max3_f32 v252, v252, v155, v160
  v_max3_f32 v252, v252, v161, v162
  v_max3_f32 v252, v252, v163, v168
  v_max3_f32 v252, v252, v169, v170
  v_max_f32 v252, v252, v171
  ds_swizzle_b32 v253, v252 offset:0x401F
  s_waitcnt lgkmcnt(0)
  v_max_f32 v252, v252, v253
  v_mov_b32 v253, v252
  s_nop 1
  v_permlane32_swap_b32 v252, v253
  s_nop 1
  v_max_f32 v252, v252, v253
  v_max_f32 v252, s46, v252
  v_sub_f32 v253, v176, v252
  v_mov_b32 v176, v253
  v_mov_b32 v177, v253
  v_mov_b32 v178, v253
  v_mov_b32 v179, v253
  v_sub_f32 v144, v144, v252
  v_sub_f32 v145, v145, v252
  v_sub_f32 v146, v146, v252
  v_sub_f32 v147, v147, v252
  v_sub_f32 v152, v152, v252
  v_sub_f32 v153, v153, v252
  v_sub_f32 v154, v154, v252
  v_sub_f32 v155, v155, v252
  v_sub_f32 v160, v160, v252
  v_sub_f32 v161, v161, v252
  v_sub_f32 v162, v162, v252
  v_sub_f32 v163, v163, v252
  v_sub_f32 v168, v168, v252
  v_sub_f32 v169, v169, v252
  v_sub_f32 v170, v170, v252
  v_sub_f32 v171, v171, v252
  v_max_f32 v252, 0, v252
  v_sub_f32 v252, 0, v252
  v_exp_f32 v252, v252
  s_nop 0
  v_mul_f32 v0, v0, v252
  v_mul_f32 v1, v1, v252
  v_mul_f32 v2, v2, v252
  v_mul_f32 v3, v3, v252
  v_mul_f32 v8, v8, v252
  v_mul_f32 v9, v9, v252
  v_mul_f32 v10, v10, v252
  v_mul_f32 v11, v11, v252
  v_mul_f32 v16, v16, v252
  v_mul_f32 v17, v17, v252
  v_mul_f32 v18, v18, v252
  v_mul_f32 v19, v19, v252
  v_mul_f32 v24, v24, v252
  v_mul_f32 v25, v25, v252
  v_mul_f32 v26, v26, v252
  v_mul_f32 v27, v27, v252
  v_mul_f32 v32, v32, v252
  v_mul_f32 v33, v33, v252
  v_mul_f32 v34, v34, v252
  v_mul_f32 v35, v35, v252
  v_mul_f32 v40, v40, v252
  v_mul_f32 v41, v41, v252
  v_mul_f32 v42, v42, v252
  v_mul_f32 v43, v43, v252
  v_mul_f32 v48, v48, v252
  v_mul_f32 v49, v49, v252
  v_mul_f32 v50, v50, v252
  v_mul_f32 v51, v51, v252
  v_mul_f32 v56, v56, v252
  v_mul_f32 v57, v57, v252
  v_mul_f32 v58, v58, v252
  v_mul_f32 v59, v59, v252
  v_mul_f32 v64, v64, v252
  v_mul_f32 v65, v65, v252
  v_mul_f32 v66, v66, v252
  v_mul_f32 v67, v67, v252
  v_mul_f32 v72, v72, v252
  v_mul_f32 v73, v73, v252
  v_mul_f32 v74, v74, v252
  v_mul_f32 v75, v75, v252
  v_mul_f32 v80, v80, v252
  v_mul_f32 v81, v81, v252
  v_mul_f32 v82, v82, v252
  v_mul_f32 v83, v83, v252
  v_mul_f32 v88, v88, v252
  v_mul_f32 v89, v89, v252
  v_mul_f32 v90, v90, v252
  v_mul_f32 v91, v91, v252
  v_mul_f32 v243, v243, v252
  v_max3_f32 v252, v148, v149, v150
  v_max3_f32 v252, v252, v151, v156
  v_max3_f32 v252, v252, v157, v158
  v_max3_f32 v252, v252, v159, v164
  v_max3_f32 v252, v252, v165, v166
  v_max3_f32 v252, v252, v167, v172
  v_max3_f32 v252, v252, v173, v174
  v_max_f32 v252, v252, v175
  ds_swizzle_b32 v253, v252 offset:0x401F
  s_waitcnt lgkmcnt(0)
  v_max_f32 v252, v252, v253
  v_mov_b32 v253, v252
  s_nop 1
  v_permlane32_swap_b32 v252, v253
  s_nop 1
  v_max_f32 v252, v252, v253
  v_max_f32 v252, s46, v252
  v_sub_f32 v253, v180, v252
  v_mov_b32 v180, v253
  v_mov_b32 v181, v253
  v_mov_b32 v182, v253
  v_mov_b32 v183, v253
  v_sub_f32 v148, v148, v252
  v_sub_f32 v149, v149, v252
  v_sub_f32 v150, v150, v252
  v_sub_f32 v151, v151, v252
  v_sub_f32 v156, v156, v252
  v_sub_f32 v157, v157, v252
  v_sub_f32 v158, v158, v252
  v_sub_f32 v159, v159, v252
  v_sub_f32 v164, v164, v252
  v_sub_f32 v165, v165, v252
  v_sub_f32 v166, v166, v252
  v_sub_f32 v167, v167, v252
  v_sub_f32 v172, v172, v252
  v_sub_f32 v173, v173, v252
  v_sub_f32 v174, v174, v252
  v_sub_f32 v175, v175, v252
  v_max_f32 v252, 0, v252
  v_sub_f32 v252, 0, v252
  v_exp_f32 v252, v252
  s_nop 0
  v_mul_f32 v4, v4, v252
  v_mul_f32 v5, v5, v252
  v_mul_f32 v6, v6, v252
  v_mul_f32 v7, v7, v252
  v_mul_f32 v12, v12, v252
  v_mul_f32 v13, v13, v252
  v_mul_f32 v14, v14, v252
  v_mul_f32 v15, v15, v252
  v_mul_f32 v20, v20, v252
  v_mul_f32 v21, v21, v252
  v_mul_f32 v22, v22, v252
  v_mul_f32 v23, v23, v252
  v_mul_f32 v28, v28, v252
  v_mul_f32 v29, v29, v252
  v_mul_f32 v30, v30, v252
  v_mul_f32 v31, v31, v252
  v_mul_f32 v36, v36, v252
  v_mul_f32 v37, v37, v252
  v_mul_f32 v38, v38, v252
  v_mul_f32 v39, v39, v252
  v_mul_f32 v44, v44, v252
  v_mul_f32 v45, v45, v252
  v_mul_f32 v46, v46, v252
  v_mul_f32 v47, v47, v252
  v_mul_f32 v52, v52, v252
  v_mul_f32 v53, v53, v252
  v_mul_f32 v54, v54, v252
  v_mul_f32 v55, v55, v252
  v_mul_f32 v60, v60, v252
  v_mul_f32 v61, v61, v252
  v_mul_f32 v62, v62, v252
  v_mul_f32 v63, v63, v252
  v_mul_f32 v68, v68, v252
  v_mul_f32 v69, v69, v252
  v_mul_f32 v70, v70, v252
  v_mul_f32 v71, v71, v252
  v_mul_f32 v76, v76, v252
  v_mul_f32 v77, v77, v252
  v_mul_f32 v78, v78, v252
  v_mul_f32 v79, v79, v252
  v_mul_f32 v84, v84, v252
  v_mul_f32 v85, v85, v252
  v_mul_f32 v86, v86, v252
  v_mul_f32 v87, v87, v252
  v_mul_f32 v92, v92, v252
  v_mul_f32 v93, v93, v252
  v_mul_f32 v94, v94, v252
  v_mul_f32 v95, v95, v252
  v_mul_f32 v244, v244, v252
  v_mov_b32 v245, 0
  v_mov_b32 v246, 0
  v_exp_f32 v184, v144
  v_exp_f32 v185, v145
  v_exp_f32 v186, v146
  v_exp_f32 v187, v147
  v_exp_f32 v188, v148
  v_exp_f32 v189, v149
  v_exp_f32 v190, v150
  v_exp_f32 v191, v151
  v_add_f32 v245, v245, v184
  v_add_f32 v245, v245, v186
  v_cvt_pk_bf16_f32 v192, v184, v185
  v_cvt_pk_bf16_f32 v193, v186, v187
  v_add_f32 v245, v245, v185
  v_add_f32 v245, v245, v187
  v_exp_f32 v184, v152
  v_exp_f32 v185, v153
  v_exp_f32 v186, v154
  v_exp_f32 v187, v155
  v_add_f32 v246, v246, v188
  v_add_f32 v246, v246, v190
  v_cvt_pk_bf16_f32 v196, v188, v189
  v_cvt_pk_bf16_f32 v197, v190, v191
  v_add_f32 v246, v246, v189
  v_add_f32 v246, v246, v191
  v_exp_f32 v188, v156
  v_exp_f32 v189, v157
  v_exp_f32 v190, v158
  v_exp_f32 v191, v159
  v_add_f32 v245, v245, v184
  v_add_f32 v245, v245, v186
  v_cvt_pk_bf16_f32 v194, v184, v185
  v_cvt_pk_bf16_f32 v195, v186, v187
  v_add_f32 v245, v245, v185
  v_add_f32 v245, v245, v187
  v_exp_f32 v184, v160
  v_exp_f32 v185, v161
  v_exp_f32 v186, v162
  v_exp_f32 v187, v163
  v_add_f32 v246, v246, v188
  v_add_f32 v246, v246, v190
  v_cvt_pk_bf16_f32 v198, v188, v189
  v_cvt_pk_bf16_f32 v199, v190, v191
  v_add_f32 v246, v246, v189
  v_add_f32 v246, v246, v191
  v_exp_f32 v188, v164
  v_exp_f32 v189, v165
  v_exp_f32 v190, v166
  v_exp_f32 v191, v167
  v_add_f32 v245, v245, v184
  v_add_f32 v245, v245, v186
  v_cvt_pk_bf16_f32 v200, v184, v185
  v_cvt_pk_bf16_f32 v201, v186, v187
  v_add_f32 v245, v245, v185
  v_add_f32 v245, v245, v187
  v_exp_f32 v184, v168
  v_exp_f32 v185, v169
  v_exp_f32 v186, v170
  v_exp_f32 v187, v171
  v_add_f32 v246, v246, v188
  v_add_f32 v246, v246, v190
  v_cvt_pk_bf16_f32 v204, v188, v189
  v_cvt_pk_bf16_f32 v205, v190, v191
  v_add_f32 v246, v246, v189
  v_add_f32 v246, v246, v191
  v_exp_f32 v188, v172
  v_exp_f32 v189, v173
  v_exp_f32 v190, v174
  v_exp_f32 v191, v175
  v_add_f32 v245, v245, v184
  v_add_f32 v245, v245, v186
  v_cvt_pk_bf16_f32 v202, v184, v185
  v_cvt_pk_bf16_f32 v203, v186, v187
  v_add_f32 v245, v245, v185
  v_add_f32 v245, v245, v187
  s_nop 0
  v_add_f32 v246, v246, v188
  v_add_f32 v246, v246, v190
  v_cvt_pk_bf16_f32 v206, v188, v189
  v_cvt_pk_bf16_f32 v207, v190, v191
  v_add_f32 v246, v246, v189
  v_add_f32 v246, v246, v191
  s_mov_b32 s45, 1199570944
  s_mov_b32 s46, 0
  s_nop 1
L_sm_ok_B2:
  v_add_f32 v243, v243, v245
  v_add_f32 v244, v244, v246
  s_setprio 1
  ds_read_b64_tr_b16 v[208:209], v236 offset:0
  ds_read_b64_tr_b16 v[210:211], v236 offset:6144
  ds_read_b64_tr_b16 v[212:213], v237 offset:0
  ds_read_b64_tr_b16 v[214:215], v237 offset:6144
  ds_read_b64_tr_b16 v[216:217], v238 offset:0
  ds_read_b64_tr_b16 v[218:219], v238 offset:6144
  ds_read_b64_tr_b16 v[220:221], v239 offset:0
  ds_read_b64_tr_b16 v[222:223], v239 offset:6144
  ds_read_b64_tr_b16 v[224:225], v236 offset:128
  ds_read_b64_tr_b16 v[226:227], v236 offset:6272
  s_waitcnt lgkmcnt(8)
  v_mfma_f32_16x16x32_bf16 v[0:3], v[208:211], v[192:195], v[0:3]
  ds_read_b64_tr_b16 v[228:229], v237 offset:128
  v_mfma_f32_16x16x32_bf16 v[4:7], v[208:211], v[196:199], v[4:7]
  ds_read_b64_tr_b16 v[230:231], v237 offset:6272
  s_waitcnt lgkmcnt(8)
  v_mfma_f32_16x16x32_bf16 v[8:11], v[212:215], v[192:195], v[8:11]
  ds_read_b64_tr_b16 v[208:209], v238 offset:128
  v_mfma_f32_16x16x32_bf16 v[12:15], v[212:215], v[196:199], v[12:15]
  ds_read_b64_tr_b16 v[210:211], v238 offset:6272
  s_waitcnt lgkmcnt(8)
  v_mfma_f32_16x16x32_bf16 v[16:19], v[216:219], v[192:195], v[16:19]
  ds_read_b64_tr_b16 v[212:213], v239 offset:128
  v_mfma_f32_16x16x32_bf16 v[20:23], v[216:219], v[196:199], v[20:23]
  ds_read_b64_tr_b16 v[214:215], v239 offset:6272
  s_waitcnt lgkmcnt(8)
  v_mfma_f32_16x16x32_bf16 v[24:27], v[220:223], v[192:195], v[24:27]
  ds_read_b64_tr_b16 v[216:217], v236 offset:256
  v_mfma_f32_16x16x32_bf16 v[28:31], v[220:223], v[196:199], v[28:31]
  ds_read_b64_tr_b16 v[218:219], v236 offset:6400
  s_waitcnt lgkmcnt(8)
  v_mfma_f32_16x16x32_bf16 v[32:35], v[224:227], v[192:195], v[32:35]
  ds_read_b64_tr_b16 v[220:221], v237 offset:256
  v_mfma_f32_16x16x32_bf16 v[36:39], v[224:227], v[196:199], v[36:39]
  ds_read_b64_tr_b16 v[222:223], v237 offset:6400
  s_waitcnt lgkmcnt(8)
  v_mfma_f32_16x16x32_bf16 v[40:43], v[228:231], v[192:195], v[40:43]
  ds_read_b64_tr_b16 v[224:225], v238 offset:256
  v_mfma_f32_16x16x32_bf16 v[44:47], v[228:231], v[196:199], v[44:47]
  ds_read_b64_tr_b16 v[226:227], v238 offset:6400
  s_waitcnt lgkmcnt(8)
  v_mfma_f32_16x16x32_bf16 v[48:51], v[208:211], v[192:195], v[48:51]
  ds_read_b64_tr_b16 v[228:229], v239 offset:256
  v_mfma_f32_16x16x32_bf16 v[52:55], v[208:211], v[196:199], v[52:55]
  ds_read_b64_tr_b16 v[230:231], v239 offset:6400
  s_waitcnt lgkmcnt(8)
  v_mfma_f32_16x16x32_bf16 v[56:59], v[212:215], v[192:195], v[56:59]
  ds_read_b64_tr_b16 v[208:209], v236 offset:12288
  v_mfma_f32_16x16x32_bf16 v[60:63], v[212:215], v[196:199], v[60:63]
  ds_read_b64_tr_b16 v[210:211], v236 offset:18432
  s_waitcnt lgkmcnt(8)
  v_mfma_f32_16x16x32_bf16 v[64:67], v[216:219], v[192:195], v[64:67]
  ds_read_b64_tr_b16 v[212:213], v237 offset:12288
  v_mfma_f32_16x16x32_bf16 v[68:71], v[216:219], v[196:199], v[68:71]
  ds_read_b64_tr_b16 v[214:215], v237 offset:18432
  s_waitcnt lgkmcnt(8)
  v_mfma_f32_16x16x32_bf16 v[72:75], v[220:223], v[192:195], v[72:75]
  ds_read_b64_tr_b16 v[216:217], v238 offset:12288
  v_mfma_f32_16x16x32_bf16 v[76:79], v[220:223], v[196:199], v[76:79]
  ds_read_b64_tr_b16 v[218:219], v238 offset:18432
  s_waitcnt lgkmcnt(8)
  v_mfma_f32_16x16x32_bf16 v[80:83], v[224:227], v[192:195], v[80:83]
  ds_read_b64_tr_b16 v[220:221], v239 offset:12288
  v_mfma_f32_16x16x32_bf16 v[84:87], v[224:227], v[196:199], v[84:87]
  ds_read_b64_tr_b16 v[222:223], v239 offset:18432
  s_waitcnt lgkmcnt(8)
  v_mfma_f32_16x16x32_bf16 v[88:91], v[228:231], v[192:195], v[88:91]
  ds_read_b64_tr_b16 v[224:225], v236 offset:12416
  v_mfma_f32_16x16x32_bf16 v[92:95], v[228:231], v[196:199], v[92:95]
  ds_read_b64_tr_b16 v[226:227], v236 offset:18560
  s_waitcnt lgkmcnt(8)
  v_mfma_f32_16x16x32_bf16 v[0:3], v[208:211], v[200:203], v[0:3]
  ds_read_b64_tr_b16 v[228:229], v237 offset:12416
  v_mfma_f32_16x16x32_bf16 v[4:7], v[208:211], v[204:207], v[4:7]
  ds_read_b64_tr_b16 v[230:231], v237 offset:18560
  s_waitcnt lgkmcnt(8)
  v_mfma_f32_16x16x32_bf16 v[8:11], v[212:215], v[200:203], v[8:11]
  ds_read_b64_tr_b16 v[208:209], v238 offset:12416
  v_mfma_f32_16x16x32_bf16 v[12:15], v[212:215], v[204:207], v[12:15]
  ds_read_b64_tr_b16 v[210:211], v238 offset:18560
  s_waitcnt lgkmcnt(8)
  v_mfma_f32_16x16x32_bf16 v[16:19], v[216:219], v[200:203], v[16:19]
  ds_read_b64_tr_b16 v[212:213], v239 offset:12416
  v_mfma_f32_16x16x32_bf16 v[20:23], v[216:219], v[204:207], v[20:23]
  ds_read_b64_tr_b16 v[214:215], v239 offset:18560
  s_waitcnt lgkmcnt(8)
  v_mfma_f32_16x16x32_bf16 v[24:27], v[220:223], v[200:203], v[24:27]
  ds_read_b64_tr_b16 v[216:217], v236 offset:12544
  v_mfma_f32_16x16x32_bf16 v[28:31], v[220:223], v[204:207], v[28:31]
  ds_read_b64_tr_b16 v[218:219], v236 offset:18688
  s_waitcnt lgkmcnt(8)
  v_mfma_f32_16x16x32_bf16 v[32:35], v[224:227], v[200:203], v[32:35]
  ds_read_b64_tr_b16 v[220:221], v237 offset:12544
  v_mfma_f32_16x16x32_bf16 v[36:39], v[224:227], v[204:207], v[36:39]
  ds_read_b64_tr_b16 v[222:223], v237 offset:18688
  s_waitcnt lgkmcnt(8)
  v_mfma_f32_16x16x32_bf16 v[40:43], v[228:231], v[200:203], v[40:43]
  ds_read_b64_tr_b16 v[224:225], v238 offset:12544
  v_mfma_f32_16x16x32_bf16 v[44:47], v[228:231], v[204:207], v[44:47]
  ds_read_b64_tr_b16 v[226:227], v238 offset:18688
  s_waitcnt lgkmcnt(8)
  v_mfma_f32_16x16x32_bf16 v[48:51], v[208:211], v[200:203], v[48:51]
  ds_read_b64_tr_b16 v[228:229], v239 offset:12544
  v_mfma_f32_16x16x32_bf16 v[52:55], v[208:211], v[204:207], v[52:55]
  ds_read_b64_tr_b16 v[230:231], v239 offset:18688
  s_waitcnt lgkmcnt(8)
  v_mfma_f32_16x16x32_bf16 v[56:59], v[212:215], v[200:203], v[56:59]
  v_mfma_f32_16x16x32_bf16 v[60:63], v[212:215], v[204:207], v[60:63]
  s_waitcnt lgkmcnt(6)
  v_mfma_f32_16x16x32_bf16 v[64:67], v[216:219], v[200:203], v[64:67]
  v_mfma_f32_16x16x32_bf16 v[68:71], v[216:219], v[204:207], v[68:71]
  s_waitcnt lgkmcnt(4)
  v_mfma_f32_16x16x32_bf16 v[72:75], v[220:223], v[200:203], v[72:75]
  v_mfma_f32_16x16x32_bf16 v[76:79], v[220:223], v[204:207], v[76:79]
  s_waitcnt lgkmcnt(2)
  v_mfma_f32_16x16x32_bf16 v[80:83], v[224:227], v[200:203], v[80:83]
  v_mfma_f32_16x16x32_bf16 v[84:87], v[224:227], v[204:207], v[84:87]
  s_waitcnt lgkmcnt(0)
  v_mfma_f32_16x16x32_bf16 v[88:91], v[228:231], v[200:203], v[88:91]
  v_mfma_f32_16x16x32_bf16 v[92:95], v[228:231], v[204:207], v[92:95]
L_at_epi:
  s_nop 7
  s_nop 7
  ds_swizzle_b32 v253, v243 offset:0x401F
  s_waitcnt lgkmcnt(0)
  v_add_f32 v252, v243, v253
  v_mov_b32 v253, v252
  s_nop 1
  v_permlane32_swap_b32 v252, v253
  s_nop 1
  v_add_f32 v252, v252, v253
  v_rcp_f32 v253, v252
  s_nop 0
  v_fma_f32 v252, -v252, v253, 2.0
  v_mul_f32 v253, v253, v252
  s_lshl_b32 s42, s36, 10
  s_mul_i32 s62, s33, 786432
  s_add_u32 s42, s42, s62
  v_mul_f32 v0, v0, v253
  v_mul_f32 v1, v1, v253
  v_mul_f32 v2, v2, v253
  v_mul_f32 v3, v3, v253
  v_cvt_pk_bf16_f32 v96, v0, v1
  v_cvt_pk_bf16_f32 v97, v2, v3
  v_mul_f32 v8, v8, v253
  v_mul_f32 v9, v9, v253
  v_mul_f32 v10, v10, v253
  v_mul_f32 v11, v11, v253
  v_cvt_pk_bf16_f32 v98, v8, v9
  v_cvt_pk_bf16_f32 v99, v10, v11
  buffer_store_dwordx4 v[96:99], v251, s[20:23], s42 offen offset:0 sc1
  s_add_u32 s42, s42, 131072
  v_mul_f32 v16, v16, v253
  v_mul_f32 v17, v17, v253
  v_mul_f32 v18, v18, v253
  v_mul_f32 v19, v19, v253
  v_cvt_pk_bf16_f32 v100, v16, v17
  v_cvt_pk_bf16_f32 v101, v18, v19
  v_mul_f32 v24, v24, v253
  v_mul_f32 v25, v25, v253
  v_mul_f32 v26, v26, v253
  v_mul_f32 v27, v27, v253
  v_cvt_pk_bf16_f32 v102, v24, v25
  v_cvt_pk_bf16_f32 v103, v26, v27
  buffer_store_dwordx4 v[100:103], v251, s[20:23], s42 offen offset:0 sc1
  s_add_u32 s42, s42, 131072
  v_mul_f32 v32, v32, v253
  v_mul_f32 v33, v33, v253
  v_mul_f32 v34, v34, v253
  v_mul_f32 v35, v35, v253
  v_cvt_pk_bf16_f32 v104, v32, v33
  v_cvt_pk_bf16_f32 v105, v34, v35
  v_mul_f32 v40, v40, v253
  v_mul_f32 v41, v41, v253
  v_mul_f32 v42, v42, v253
  v_mul_f32 v43, v43, v253
  v_cvt_pk_bf16_f32 v106, v40, v41
  v_cvt_pk_bf16_f32 v107, v42, v43
  buffer_store_dwordx4 v[104:107], v251, s[20:23], s42 offen offset:0 sc1
  s_add_u32 s42, s42, 131072
  v_mul_f32 v48, v48, v253
  v_mul_f32 v49, v49, v253
  v_mul_f32 v50, v50, v253
  v_mul_f32 v51, v51, v253
  v_cvt_pk_bf16_f32 v108, v48, v49
  v_cvt_pk_bf16_f32 v109, v50, v51
  v_mul_f32 v56, v56, v253
  v_mul_f32 v57, v57, v253
  v_mul_f32 v58, v58, v253
  v_mul_f32 v59, v59, v253
  v_cvt_pk_bf16_f32 v110, v56, v57
  v_cvt_pk_bf16_f32 v111, v58, v59
  buffer_store_dwordx4 v[108:111], v251, s[20:23], s42 offen offset:0 sc1
  s_add_u32 s42, s42, 131072
  v_mul_f32 v64, v64, v253
  v_mul_f32 v65, v65, v253
  v_mul_f32 v66, v66, v253
  v_mul_f32 v67, v67, v253
  v_cvt_pk_bf16_f32 v112, v64, v65
  v_cvt_pk_bf16_f32 v113, v66, v67
  v_mul_f32 v72, v72, v253
  v_mul_f32 v73, v73, v253
  v_mul_f32 v74, v74, v253
  v_mul_f32 v75, v75, v253
  v_cvt_pk_bf16_f32 v114, v72, v73
  v_cvt_pk_bf16_f32 v115, v74, v75
  buffer_store_dwordx4 v[112:115], v251, s[20:23], s42 offen offset:0 sc1
  s_add_u32 s42, s42, 131072
  v_mul_f32 v80, v80, v253
  v_mul_f32 v81, v81, v253
  v_mul_f32 v82, v82, v253
  v_mul_f32 v83, v83, v253
  v_cvt_pk_bf16_f32 v116, v80, v81
  v_cvt_pk_bf16_f32 v117, v82, v83
  v_mul_f32 v88, v88, v253
  v_mul_f32 v89, v89, v253
  v_mul_f32 v90, v90, v253
  v_mul_f32 v91, v91, v253
  v_cvt_pk_bf16_f32 v118, v88, v89
  v_cvt_pk_bf16_f32 v119, v90, v91
  buffer_store_dwordx4 v[116:119], v251, s[20:23], s42 offen offset:0 sc1
  s_add_u32 s42, s42, 131072
  ds_swizzle_b32 v253, v244 offset:0x401F
  s_waitcnt lgkmcnt(0)
  v_add_f32 v252, v244, v253
  v_mov_b32 v253, v252
  s_nop 1
  v_permlane32_swap_b32 v252, v253
  s_nop 1
  v_add_f32 v252, v252, v253
  v_rcp_f32 v253, v252
  s_nop 0
  v_fma_f32 v252, -v252, v253, 2.0
  v_mul_f32 v253, v253, v252
  s_lshl_b32 s42, s36, 10
  s_mul_i32 s62, s33, 786432
  s_add_u32 s42, s42, s62
  v_mul_f32 v4, v4, v253
  v_mul_f32 v5, v5, v253
  v_mul_f32 v6, v6, v253
  v_mul_f32 v7, v7, v253
  v_cvt_pk_bf16_f32 v120, v4, v5
  v_cvt_pk_bf16_f32 v121, v6, v7
  v_mul_f32 v12, v12, v253
  v_mul_f32 v13, v13, v253
  v_mul_f32 v14, v14, v253
  v_mul_f32 v15, v15, v253
  v_cvt_pk_bf16_f32 v122, v12, v13
  v_cvt_pk_bf16_f32 v123, v14, v15
  buffer_store_dwordx4 v[120:123], v251, s[20:23], s42 offen offset:1024 sc1
  s_add_u32 s42, s42, 131072
  v_mul_f32 v20, v20, v253
  v_mul_f32 v21, v21, v253
  v_mul_f32 v22, v22, v253
  v_mul_f32 v23, v23, v253
  v_cvt_pk_bf16_f32 v124, v20, v21
  v_cvt_pk_bf16_f32 v125, v22, v23
  v_mul_f32 v28, v28, v253
  v_mul_f32 v29, v29, v253
  v_mul_f32 v30, v30, v253
  v_mul_f32 v31, v31, v253
  v_cvt_pk_bf16_f32 v126, v28, v29
  v_cvt_pk_bf16_f32 v127, v30, v31
  buffer_store_dwordx4 v[124:127], v251, s[20:23], s42 offen offset:1024 sc1
  s_add_u32 s42, s42, 131072
  v_mul_f32 v36, v36, v253
  v_mul_f32 v37, v37, v253
  v_mul_f32 v38, v38, v253
  v_mul_f32 v39, v39, v253
  v_cvt_pk_bf16_f32 v128, v36, v37
  v_cvt_pk_bf16_f32 v129, v38, v39
  v_mul_f32 v44, v44, v253
  v_mul_f32 v45, v45, v253
  v_mul_f32 v46, v46, v253
  v_mul_f32 v47, v47, v253
  v_cvt_pk_bf16_f32 v130, v44, v45
  v_cvt_pk_bf16_f32 v131, v46, v47
  buffer_store_dwordx4 v[128:131], v251, s[20:23], s42 offen offset:1024 sc1
  s_add_u32 s42, s42, 131072
  v_mul_f32 v52, v52, v253
  v_mul_f32 v53, v53, v253
  v_mul_f32 v54, v54, v253
  v_mul_f32 v55, v55, v253
  v_cvt_pk_bf16_f32 v132, v52, v53
  v_cvt_pk_bf16_f32 v133, v54, v55
  v_mul_f32 v60, v60, v253
  v_mul_f32 v61, v61, v253
  v_mul_f32 v62, v62, v253
  v_mul_f32 v63, v63, v253
  v_cvt_pk_bf16_f32 v134, v60, v61
  v_cvt_pk_bf16_f32 v135, v62, v63
  buffer_store_dwordx4 v[132:135], v251, s[20:23], s42 offen offset:1024 sc1
  s_add_u32 s42, s42, 131072
  v_mul_f32 v68, v68, v253
  v_mul_f32 v69, v69, v253
  v_mul_f32 v70, v70, v253
  v_mul_f32 v71, v71, v253
  v_cvt_pk_bf16_f32 v136, v68, v69
  v_cvt_pk_bf16_f32 v137, v70, v71
  v_mul_f32 v76, v76, v253
  v_mul_f32 v77, v77, v253
  v_mul_f32 v78, v78, v253
  v_mul_f32 v79, v79, v253
  v_cvt_pk_bf16_f32 v138, v76, v77
  v_cvt_pk_bf16_f32 v139, v78, v79
  buffer_store_dwordx4 v[136:139], v251, s[20:23], s42 offen offset:1024 sc1
  s_add_u32 s42, s42, 131072
  v_mul_f32 v84, v84, v253
  v_mul_f32 v85, v85, v253
  v_mul_f32 v86, v86, v253
  v_mul_f32 v87, v87, v253
  v_cvt_pk_bf16_f32 v140, v84, v85
  v_cvt_pk_bf16_f32 v141, v86, v87
  v_mul_f32 v92, v92, v253
  v_mul_f32 v93, v93, v253
  v_mul_f32 v94, v94, v253
  v_mul_f32 v95, v95, v253
  v_cvt_pk_bf16_f32 v142, v92, v93
  v_cvt_pk_bf16_f32 v143, v94, v95
  buffer_store_dwordx4 v[140:143], v251, s[20:23], s42 offen offset:1024 sc1
  s_add_u32 s42, s42, 131072
L_at_end:
  s_endpgm
.section .rodata,"a"
.p2align 6
.amdhsa_kernel attn_kernel
  .amdhsa_next_free_vgpr 256
  .amdhsa_next_free_sgpr 102
  .amdhsa_accum_offset 256
  .amdhsa_group_segment_fixed_size 0
  .amdhsa_kernarg_size 104
  .amdhsa_user_sgpr_count 2
  .amdhsa_user_sgpr_kernarg_segment_ptr 1
  .amdhsa_system_sgpr_workgroup_id_x 1
.end_amdhsa_kernel
.text

.globl gemm_kernel
.p2align 8
.type gemm_kernel,@function
gemm_kernel:
  s_cmp_ge_u32 s2, 256
  s_cbranch_scc1 L_gm_end
  s_load_dwordx2 s[48:49], s[0:1], 32
  s_load_dwordx2 s[50:51], s[0:1], 64
  s_load_dwordx2 s[60:61], s[0:1], 96
  v_lshrrev_b32 v160, 6, v0
  s_nop 0
  v_readfirstlane_b32 s32, v160
  s_and_b32 s35, s2, 7
  s_lshr_b32 s35, s35, 1
  s_and_b32 s33, s2, 1
  s_lshl_b32 s33, s33, 3
  s_lshr_b32 s34, s2, 3
  s_and_b32 s34, s34, 7
  s_add_u32 s33, s33, s34
  s_lshr_b32 s34, s2, 6
  s_lshr_b32 s36, s32, 2
  s_and_b32 s37, s32, 3
  s_mov_b32 s38, s36
  v_and_b32 v160, 63, v0
  v_lshrrev_b32 v161, 4, v160
  v_bfe_u32 v162, v160, 2, 2
  v_and_b32 v163, 3, v160
  v_lshlrev_b32 v159, 4, v160
  v_lshl_add_u32 v164, v161, 2, v162
  s_movk_i32 s42, 320
  v_mul_lo_u32 v164, v164, s42
  v_lshl_add_u32 v164, v163, 3, v164
  s_mul_i32 s42, s38, 160
  v_add_u32 v164, s42, v164
  v_and_b32 v165, 1, v161
  v_lshlrev_b32 v165, 5, v165
  v_add_u32 v166, v164, v165
  v_sub_u32 v164, v164, v165
  s_cmp_eq_u32 s38, 0
  s_cselect_b64 vcc, -1, 0
  v_cndmask_b32 v152, v164, v166, vcc
  v_cndmask_b32 v153, v166, v164, vcc
  s_lshl_b32 s42, s37, 12
  s_add_u32 s42, s42, 20480
  v_add_u32 v154, s42, v159
  v_add_u32 v168, 73728, v152
  v_add_u32 v169, 73728, v153
  v_add_u32 v170, 73728, v154
  s_sub_u32 s42, s32, 4
  s_mul_i32 s42, s42, 3
  s_lshl_b32 s43, s32, 1
  s_add_u32 s43, s43, 12
  s_cmp_ge_u32 s32, 4
  s_cselect_b32 s63, s42, s43
  s_lshl_b32 s44, s63, 10
  s_lshl_b32 s42, s63, 6
  s_movk_i32 s62, 3277
  s_movk_i32 s64, 1280
  s_mul_i32 s65, s34, 320
  v_add_u32 v164, s42, v160
  v_add_u32 v164, 0, v164
  v_mul_lo_u32 v165, v164, s62
  v_lshrrev_b32 v165, 16, v165
  v_mul_u32_u24 v166, 20, v165
  v_sub_u32 v164, v164, v166
  v_bfe_u32 v166, v165, 2, 1
  v_lshlrev_b32 v166, 1, v166
  v_xor_b32 v164, v164, v166
  v_mul_lo_u32 v165, v165, s64
  v_lshl_add_u32 v165, v164, 4, v165
  v_add_u32 v155, s65, v165
  v_add_u32 v164, s42, v160
  v_add_u32 v164, 64, v164
  v_mul_lo_u32 v165, v164, s62
  v_lshrrev_b32 v165, 16, v165
  v_mul_u32_u24 v166, 20, v165
  v_sub_u32 v164, v164, v166
  v_bfe_u32 v166, v165, 2, 1
  v_lshlrev_b32 v166, 1, v166
  v_xor_b32 v164, v164, v166
  v_mul_lo_u32 v165, v165, s64
  v_lshl_add_u32 v165, v164, 4, v165
  v_add_u32 v156, s65, v165
  v_add_u32 v164, s42, v160
  v_add_u32 v164, 128, v164
  v_mul_lo_u32 v165, v164, s62
  v_lshrrev_b32 v165, 16, v165
  v_mul_u32_u24 v166, 20, v165
  v_sub_u32 v164, v164, v166
  v_bfe_u32 v166, v165, 2, 1
  v_lshlrev_b32 v166, 1, v166
  v_xor_b32 v164, v164, v166
  v_mul_lo_u32 v165, v165, s64
  v_lshl_add_u32 v165, v164, 4, v165
  v_add_u32 v157, s65, v165
  s_lshl_b32 s65, s32, 11
  s_add_u32 s65, s65, 20480
  s_waitcnt lgkmcnt(0)
  s_cmp_eq_u32 s35, 3
  s_cselect_b32 s48, s50, s48
  s_cselect_b32 s49, s51, s49
  s_cselect_b32 s42, 0, s35
  s_cselect_b32 s46, 24, 32
  s_cselect_b32 s47, 6, 8
  s_mul_i32 s42, s42, 2621440
  s_add_u32 s4, s48, s42
  s_addc_u32 s5, s49, 0
  s_and_b32 s5, s5, 0xffff
  s_mov_b32 s6, 0
  s_mov_b32 s7, 0x00020000
  s_mul_i32 s6, s46, 81920
  s_add_u32 s16, s60, 4194304
  s_addc_u32 s17, s61, 0
  s_and_b32 s17, s17, 0xffff
  s_mov_b32 s18, 31457280
  s_mov_b32 s19, 0x00020000
  s_add_u32 s20, s60, 41943040
  s_addc_u32 s21, s61, 0
  s_and_b32 s21, s21, 0xffff
  s_mov_b32 s22, 31457280
  s_mov_b32 s23, 0x00020000
  s_lshl_b32 s66, s33, 3
  s_add_u32 s66, s66, s32
  s_lshl_b32 s66, s66, 10
  s_mul_i32 s42, s35, 8388608
  s_add_u32 s66, s66, s42
  s_mov_b32 s67, 0
  v_mov_b64 v[0:1], 0
  v_mov_b64 v[2:3], 0
  v_mov_b64 v[4:5], 0
  v_mov_b64 v[6:7], 0
  v_mov_b64 v[8:9], 0
  v_mov_b64 v[10:11], 0
  v_mov_b64 v[12:13], 0
  v_mov_b64 v[14:15], 0
  v_mov_b64 v[16:17], 0
  v_mov_b64 v[18:19], 0
  v_mov_b64 v[20:21], 0
  v_mov_b64 v[22:23], 0
  v_mov_b64 v[24:25], 0
  v_mov_b64 v[26:27], 0
  v_mov_b64 v[28:29], 0
  v_mov_b64 v[30:31], 0
  v_mov_b64 v[32:33], 0
  v_mov_b64 v[34:35], 0
  v_mov_b64 v[36:37], 0
  v_mov_b64 v[38:39], 0
  s_cmp_eq_u32 s36, 1
  s_cbranch_scc1 L_gm_g1
  s_add_u32 s43, s44, 0
  s_add_u32 s45, s66, 131072
  s_add_u32 m0, s65, 0
  s_nop 0
  buffer_load_dwordx4 v159, s[16:19], s66 offen lds
  s_add_u32 m0, s65, 1024
  s_nop 0
  buffer_load_dwordx4 v159, s[16:19], s45 offen lds
  s_add_u32 m0, s43, 0
  s_nop 0
  buffer_load_dwordx4 v155, s[4:7], s67 offen lds
  s_add_u32 m0, s43, 1024
  s_nop 0
  buffer_load_dwordx4 v156, s[4:7], s67 offen lds
  s_add_u32 s66, s66, 262144
  s_add_u32 s67, s67, 81920
  s_add_u32 s43, s44, 36864
  s_add_u32 s45, s66, 131072
  s_add_u32 m0, s65, 36864
  s_nop 0
  buffer_load_dwordx4 v159, s[16:19], s66 offen lds
  s_add_u32 m0, s65, 37888
  s_nop 0
  buffer_load_dwordx4 v159, s[16:19], s45 offen lds
  s_add_u32 m0, s43, 0
  s_nop 0
  buffer_load_dwordx4 v155, s[4:7], s67 offen lds
  s_add_u32 m0, s43, 1024
  s_nop 0
  buffer_load_dwordx4 v156, s[4:7], s67 offen lds
  s_add_u32 s66, s66, 262144
  s_add_u32 s67, s67, 81920
  s_add_u32 s43, s44, 73728
  s_add_u32 s45, s66, 131072
  s_add_u32 m0, s65, 73728
  s_nop 0
  buffer_load_dwordx4 v159, s[16:19], s66 offen lds
  s_add_u32 m0, s65, 74752
  s_nop 0
  buffer_load_dwordx4 v159, s[16:19], s45 offen lds
  s_add_u32 m0, s43, 0
  s_nop 0
  buffer_load_dwordx4 v155, s[4:7], s67 offen lds
  s_add_u32 m0, s43, 1024
  s_nop 0
  buffer_load_dwordx4 v156, s[4:7], s67 offen lds
  s_add_u32 s66, s66, 262144
  s_add_u32 s67, s67, 81920
  s_add_u32 s43, s44, 110592
  s_add_u32 s45, s66, 131072
  s_add_u32 m0, s65, 110592
  s_nop 0
  buffer_load_dwordx4 v159, s[16:19], s66 offen lds
  s_add_u32 m0, s65, 111616
  s_nop 0
  buffer_load_dwordx4 v159, s[16:19], s45 offen lds
  s_add_u32 m0, s43, 0
  s_nop 0
  buffer_load_dwordx4 v155, s[4:7], s67 offen lds
  s_add_u32 m0, s43, 1024
  s_nop 0
  buffer_load_dwordx4 v156, s[4:7], s67 offen lds
  s_add_u32 s66, s66, 262144
  s_add_u32 s67, s67, 81920
  s_waitcnt vmcnt(12)
  s_barrier
  ds_read_b128 v[60:63], v154 offset:0
  ds_read_b128 v[64:67], v154 offset:2048
  ds_read_b64_tr_b16 v[40:41], v152 offset:0
  ds_read_b64_tr_b16 v[42:43], v152 offset:5120
  ds_read_b64_tr_b16 v[44:45], v153 offset:32
  ds_read_b64_tr_b16 v[46:47], v153 offset:5152
  ds_read_b64_tr_b16 v[48:49], v152 offset:64
  ds_read_b64_tr_b16 v[50:51], v152 offset:5184
  ds_read_b64_tr_b16 v[52:53], v153 offset:96
  ds_read_b64_tr_b16 v[54:55], v153 offset:5216
  ds_read_b64_tr_b16 v[56:57], v152 offset:128
  ds_read_b64_tr_b16 v[58:59], v152 offset:5248
  ds_read_b128 v[88:91], v154 offset:1024
  ds_read_b128 v[92:95], v154 offset:3072
  ds_read_b64_tr_b16 v[68:69], v152 offset:10240
  ds_read_b64_tr_b16 v[70:71], v152 offset:15360
  ds_read_b64_tr_b16 v[72:73], v153 offset:10272
  ds_read_b64_tr_b16 v[74:75], v153 offset:15392
  ds_read_b64_tr_b16 v[76:77], v152 offset:10304
  ds_read_b64_tr_b16 v[78:79], v152 offset:15424
  ds_read_b64_tr_b16 v[80:81], v153 offset:10336
  ds_read_b64_tr_b16 v[82:83], v153 offset:15456
  ds_read_b64_tr_b16 v[84:85], v152 offset:10368
  ds_read_b64_tr_b16 v[86:87], v152 offset:15488
  s_waitcnt lgkmcnt(0)
  s_mov_b32 s39, 1
L_gm_loop0:
  s_waitcnt vmcnt(8)
  s_barrier
  v_mfma_f32_16x16x32_bf16 v[0:3], v[40:43], v[60:63], v[0:3]
  ds_read_b128 v[116:119], v154 offset:36864
  ds_read_b128 v[120:123], v154 offset:38912
  v_mfma_f32_16x16x32_bf16 v[20:23], v[40:43], v[64:67], v[20:23]
  ds_read_b64_tr_b16 v[96:97], v152 offset:36864
  ds_read_b64_tr_b16 v[98:99], v152 offset:41984
  v_mfma_f32_16x16x32_bf16 v[4:7], v[44:47], v[60:63], v[4:7]
  ds_read_b64_tr_b16 v[100:101], v153 offset:36896
  ds_read_b64_tr_b16 v[102:103], v153 offset:42016
  v_mfma_f32_16x16x32_bf16 v[24:27], v[44:47], v[64:67], v[24:27]
  ds_read_b64_tr_b16 v[104:105], v152 offset:36928
  ds_read_b64_tr_b16 v[106:107], v152 offset:42048
  v_mfma_f32_16x16x32_bf16 v[8:11], v[48:51], v[60:63], v[8:11]
  ds_read_b64_tr_b16 v[108:109], v153 offset:36960
  v_mfma_f32_16x16x32_bf16 v[28:31], v[48:51], v[64:67], v[28:31]
  ds_read_b64_tr_b16 v[110:111], v153 offset:42080
  v_mfma_f32_16x16x32_bf16 v[12:15], v[52:55], v[60:63], v[12:15]
  ds_read_b64_tr_b16 v[112:113], v152 offset:36992
  v_mfma_f32_16x16x32_bf16 v[32:35], v[52:55], v[64:67], v[32:35]
  ds_read_b64_tr_b16 v[114:115], v152 offset:42112
  v_mfma_f32_16x16x32_bf16 v[16:19], v[56:59], v[60:63], v[16:19]
  ds_read_b128 v[144:147], v154 offset:37888
  v_mfma_f32_16x16x32_bf16 v[36:39], v[56:59], v[64:67], v[36:39]
  ds_read_b128 v[148:151], v154 offset:39936
  v_mfma_f32_16x16x32_bf16 v[0:3], v[68:71], v[88:91], v[0:3]
  ds_read_b64_tr_b16 v[124:125], v152 offset:47104
  v_mfma_f32_16x16x32_bf16 v[20:23], v[68:71], v[92:95], v[20:23]
  ds_read_b64_tr_b16 v[126:127], v152 offset:52224
  v_mfma_f32_16x16x32_bf16 v[4:7], v[72:75], v[88:91], v[4:7]
  ds_read_b64_tr_b16 v[128:129], v153 offset:47136
  v_mfma_f32_16x16x32_bf16 v[24:27], v[72:75], v[92:95], v[24:27]
  ds_read_b64_tr_b16 v[130:131], v153 offset:52256
  v_mfma_f32_16x16x32_bf16 v[8:11], v[76:79], v[88:91], v[8:11]
  ds_read_b64_tr_b16 v[132:133], v152 offset:47168
  v_mfma_f32_16x16x32_bf16 v[28:31], v[76:79], v[92:95], v[28:31]
  ds_read_b64_tr_b16 v[134:135], v152 offset:52288
  v_mfma_f32_16x16x32_bf16 v[12:15], v[80:83], v[88:91], v[12:15]
  ds_read_b64_tr_b16 v[136:137], v153 offset:47200
  v_mfma_f32_16x16x32_bf16 v[32:35], v[80:83], v[92:95], v[32:35]
  ds_read_b64_tr_b16 v[138:139], v153 offset:52320
  v_mfma_f32_16x16x32_bf16 v[16:19], v[84:87], v[88:91], v[16:19]
  ds_read_b64_tr_b16 v[140:141], v152 offset:47232
  v_mfma_f32_16x16x32_bf16 v[36:39], v[84:87], v[92:95], v[36:39]
  ds_read_b64_tr_b16 v[142:143], v152 offset:52352
  s_add_u32 s43, s44, 0
  s_add_u32 s45, s66, 131072
  s_add_u32 m0, s65, 0
  s_nop 0
  buffer_load_dwordx4 v159, s[16:19], s66 offen lds
  s_add_u32 m0, s65, 1024
  s_nop 0
  buffer_load_dwordx4 v159, s[16:19], s45 offen lds
  s_add_u32 m0, s43, 0
  s_nop 0
  buffer_load_dwordx4 v155, s[4:7], s67 offen lds
  s_add_u32 m0, s43, 1024
  s_nop 0
  buffer_load_dwordx4 v156, s[4:7], s67 offen lds
  s_add_u32 s66, s66, 262144
  s_add_u32 s67, s67, 81920
  s_waitcnt lgkmcnt(0)
  s_waitcnt vmcnt(8)
  s_barrier
  v_mfma_f32_16x16x32_bf16 v[0:3], v[96:99], v[116:119], v[0:3]
  ds_read_b128 v[60:63], v170 offset:0
  ds_read_b128 v[64:67], v170 offset:2048
  v_mfma_f32_16x16x32_bf16 v[20:23], v[96:99], v[120:123], v[20:23]
  ds_read_b64_tr_b16 v[40:41], v168 offset:0
  ds_read_b64_tr_b16 v[42:43], v168 offset:5120
  v_mfma_f32_16x16x32_bf16 v[4:7], v[100:103], v[116:119], v[4:7]
  ds_read_b64_tr_b16 v[44:45], v169 offset:32
  ds_read_b64_tr_b16 v[46:47], v169 offset:5152
  v_mfma_f32_16x16x32_bf16 v[24:27], v[100:103], v[120:123], v[24:27]
  ds_read_b64_tr_b16 v[48:49], v168 offset:64
  ds_read_b64_tr_b16 v[50:51], v168 offset:5184
  v_mfma_f32_16x16x32_bf16 v[8:11], v[104:107], v[116:119], v[8:11]
  ds_read_b64_tr_b16 v[52:53], v169 offset:96
  v_mfma_f32_16x16x32_bf16 v[28:31], v[104:107], v[120:123], v[28:31]
  ds_read_b64_tr_b16 v[54:55], v169 offset:5216
  v_mfma_f32_16x16x32_bf16 v[12:15], v[108:111], v[116:119], v[12:15]
  ds_read_b64_tr_b16 v[56:57], v168 offset:128
  v_mfma_f32_16x16x32_bf16 v[32:35], v[108:111], v[120:123], v[32:35]
  ds_read_b64_tr_b16 v[58:59], v168 offset:5248
  v_mfma_f32_16x16x32_bf16 v[16:19], v[112:115], v[116:119], v[16:19]
  ds_read_b128 v[88:91], v170 offset:1024
  v_mfma_f32_16x16x32_bf16 v[36:39], v[112:115], v[120:123], v[36:39]
  ds_read_b128 v[92:95], v170 offset:3072
  v_mfma_f32_16x16x32_bf16 v[0:3], v[124:127], v[144:147], v[0:3]
  ds_read_b64_tr_b16 v[68:69], v168 offset:10240
  v_mfma_f32_16x16x32_bf16 v[20:23], v[124:127], v[148:151], v[20:23]
  ds_read_b64_tr_b16 v[70:71], v168 offset:15360
  v_mfma_f32_16x16x32_bf16 v[4:7], v[128:131], v[144:147], v[4:7]
  ds_read_b64_tr_b16 v[72:73], v169 offset:10272
  v_mfma_f32_16x16x32_bf16 v[24:27], v[128:131], v[148:151], v[24:27]
  ds_read_b64_tr_b16 v[74:75], v169 offset:15392
  v_mfma_f32_16x16x32_bf16 v[8:11], v[132:135], v[144:147], v[8:11]
  ds_read_b64_tr_b16 v[76:77], v168 offset:10304
  v_mfma_f32_16x16x32_bf16 v[28:31], v[132:135], v[148:151], v[28:31]
  ds_read_b64_tr_b16 v[78:79], v168 offset:15424
  v_mfma_f32_16x16x32_bf16 v[12:15], v[136:139], v[144:147], v[12:15]
  ds_read_b64_tr_b16 v[80:81], v169 offset:10336
  v_mfma_f32_16x16x32_bf16 v[32:35], v[136:139], v[148:151], v[32:35]
  ds_read_b64_tr_b16 v[82:83], v169 offset:15456
  v_mfma_f32_16x16x32_bf16 v[16:19], v[140:143], v[144:147], v[16:19]
  ds_read_b64_tr_b16 v[84:85], v168 offset:10368
  v_mfma_f32_16x16x32_bf16 v[36:39], v[140:143], v[148:151], v[36:39]
  ds_read_b64_tr_b16 v[86:87], v168 offset:15488
  s_add_u32 s43, s44, 36864
  s_add_u32 s45, s66, 131072
  s_add_u32 m0, s65, 36864
  s_nop 0
  buffer_load_dwordx4 v159, s[16:19], s66 offen lds
  s_add_u32 m0, s65, 37888
  s_nop 0
  buffer_load_dwordx4 v159, s[16:19], s45 offen lds
  s_add_u32 m0, s43, 0
  s_nop 0
  buffer_load_dwordx4 v155, s[4:7], s67 offen lds
  s_add_u32 m0, s43, 1024
  s_nop 0
  buffer_load_dwordx4 v156, s[4:7], s67 offen lds
  s_add_u32 s66, s66, 262144
  s_add_u32 s67, s67, 81920
  s_waitcnt lgkmcnt(0)
  s_waitcnt vmcnt(8)
  s_barrier
  v_mfma_f32_16x16x32_bf16 v[0:3], v[40:43], v[60:63], v[0:3]
  ds_read_b128 v[116:119], v170 offset:36864
  ds_read_b128 v[120:123], v170 offset:38912
  v_mfma_f32_16x16x32_bf16 v[20:23], v[40:43], v[64:67], v[20:23]
  ds_read_b64_tr_b16 v[96:97], v168 offset:36864
  ds_read_b64_tr_b16 v[98:99], v168 offset:41984
  v_mfma_f32_16x16x32_bf16 v[4:7], v[44:47], v[60:63], v[4:7]
  ds_read_b64_tr_b16 v[100:101], v169 offset:36896
  ds_read_b64_tr_b16 v[102:103], v169 offset:42016
  v_mfma_f32_16x16x32_bf16 v[24:27], v[44:47], v[64:67], v[24:27]
  ds_read_b64_tr_b16 v[104:105], v168 offset:36928
  ds_read_b64_tr_b16 v[106:107], v168 offset:42048
  v_mfma_f32_16x16x32_bf16 v[8:11], v[48:51], v[60:63], v[8:11]
  ds_read_b64_tr_b16 v[108:109], v169 offset:36960
  v_mfma_f32_16x16x32_bf16 v[28:31], v[48:51], v[64:67], v[28:31]
  ds_read_b64_tr_b16 v[110:111], v169 offset:42080
  v_mfma_f32_16x16x32_bf16 v[12:15], v[52:55], v[60:63], v[12:15]
  ds_read_b64_tr_b16 v[112:113], v168 offset:36992
  v_mfma_f32_16x16x32_bf16 v[32:35], v[52:55], v[64:67], v[32:35]
  ds_read_b64_tr_b16 v[114:115], v168 offset:42112
  v_mfma_f32_16x16x32_bf16 v[16:19], v[56:59], v[60:63], v[16:19]
  ds_read_b128 v[144:147], v170 offset:37888
  v_mfma_f32_16x16x32_bf16 v[36:39], v[56:59], v[64:67], v[36:39]
  ds_read_b128 v[148:151], v170 offset:39936
  v_mfma_f32_16x16x32_bf16 v[0:3], v[68:71], v[88:91], v[0:3]
  ds_read_b64_tr_b16 v[124:125], v168 offset:47104
  v_mfma_f32_16x16x32_bf16 v[20:23], v[68:71], v[92:95], v[20:23]
  ds_read_b64_tr_b16 v[126:127], v168 offset:52224
  v_mfma_f32_16x16x32_bf16 v[4:7], v[72:75], v[88:91], v[4:7]
  ds_read_b64_tr_b16 v[128:129], v169 offset:47136
  v_mfma_f32_16x16x32_bf16 v[24:27], v[72:75], v[92:95], v[24:27]
  ds_read_b64_tr_b16 v[130:131], v169 offset:52256
  v_mfma_f32_16x16x32_bf16 v[8:11], v[76:79], v[88:91], v[8:11]
  ds_read_b64_tr_b16 v[132:133], v168 offset:47168
  v_mfma_f32_16x16x32_bf16 v[28:31], v[76:79], v[92:95], v[28:31]
  ds_read_b64_tr_b16 v[134:135], v168 offset:52288
  v_mfma_f32_16x16x32_bf16 v[12:15], v[80:83], v[88:91], v[12:15]
  ds_read_b64_tr_b16 v[136:137], v169 offset:47200
  v_mfma_f32_16x16x32_bf16 v[32:35], v[80:83], v[92:95], v[32:35]
  ds_read_b64_tr_b16 v[138:139], v169 offset:52320
  v_mfma_f32_16x16x32_bf16 v[16:19], v[84:87], v[88:91], v[16:19]
  ds_read_b64_tr_b16 v[140:141], v168 offset:47232
  v_mfma_f32_16x16x32_bf16 v[36:39], v[84:87], v[92:95], v[36:39]
  ds_read_b64_tr_b16 v[142:143], v168 offset:52352
  s_add_u32 s43, s44, 73728
  s_add_u32 s45, s66, 131072
  s_add_u32 m0, s65, 73728
  s_nop 0
  buffer_load_dwordx4 v159, s[16:19], s66 offen lds
  s_add_u32 m0, s65, 74752
  s_nop 0
  buffer_load_dwordx4 v159, s[16:19], s45 offen lds
  s_add_u32 m0, s43, 0
  s_nop 0
  buffer_load_dwordx4 v155, s[4:7], s67 offen lds
  s_add_u32 m0, s43, 1024
  s_nop 0
  buffer_load_dwordx4 v156, s[4:7], s67 offen lds
  s_add_u32 s66, s66, 262144
  s_add_u32 s67, s67, 81920
  s_waitcnt lgkmcnt(0)
  s_waitcnt vmcnt(8)
  s_barrier
  v_mfma_f32_16x16x32_bf16 v[0:3], v[96:99], v[116:119], v[0:3]
  ds_read_b128 v[60:63], v154 offset:0
  ds_read_b128 v[64:67], v154 offset:2048
  v_mfma_f32_16x16x32_bf16 v[20:23], v[96:99], v[120:123], v[20:23]
  ds_read_b64_tr_b16 v[40:41], v152 offset:0
  ds_read_b64_tr_b16 v[42:43], v152 offset:5120
  v_mfma_f32_16x16x32_bf16 v[4:7], v[100:103], v[116:119], v[4:7]
  ds_read_b64_tr_b16 v[44:45], v153 offset:32
  ds_read_b64_tr_b16 v[46:47], v153 offset:5152
  v_mfma_f32_16x16x32_bf16 v[24:27], v[100:103], v[120:123], v[24:27]
  ds_read_b64_tr_b16 v[48:49], v152 offset:64
  ds_read_b64_tr_b16 v[50:51], v152 offset:5184
  v_mfma_f32_16x16x32_bf16 v[8:11], v[104:107], v[116:119], v[8:11]
  ds_read_b64_tr_b16 v[52:53], v153 offset:96
  v_mfma_f32_16x16x32_bf16 v[28:31], v[104:107], v[120:123], v[28:31]
  ds_read_b64_tr_b16 v[54:55], v153 offset:5216
  v_mfma_f32_16x16x32_bf16 v[12:15], v[108:111], v[116:119], v[12:15]
  ds_read_b64_tr_b16 v[56:57], v152 offset:128
  v_mfma_f32_16x16x32_bf16 v[32:35], v[108:111], v[120:123], v[32:35]
  ds_read_b64_tr_b16 v[58:59], v152 offset:5248
  v_mfma_f32_16x16x32_bf16 v[16:19], v[112:115], v[116:119], v[16:19]
  ds_read_b128 v[88:91], v154 offset:1024
  v_mfma_f32_16x16x32_bf16 v[36:39], v[112:115], v[120:123], v[36:39]
  ds_read_b128 v[92:95], v154 offset:3072
  v_mfma_f32_16x16x32_bf16 v[0:3], v[124:127], v[144:147], v[0:3]
  ds_read_b64_tr_b16 v[68:69], v152 offset:10240
  v_mfma_f32_16x16x32_bf16 v[20:23], v[124:127], v[148:151], v[20:23]
  ds_read_b64_tr_b16 v[70:71], v152 offset:15360
  v_mfma_f32_16x16x32_bf16 v[4:7], v[128:131], v[144:147], v[4:7]
  ds_read_b64_tr_b16 v[72:73], v153 offset:10272
  v_mfma_f32_16x16x32_bf16 v[24:27], v[128:131], v[148:151], v[24:27]
  ds_read_b64_tr_b16 v[74:75], v153 offset:15392
  v_mfma_f32_16x16x32_bf16 v[8:11], v[132:135], v[144:147], v[8:11]
  ds_read_b64_tr_b16 v[76:77], v152 offset:10304
  v_mfma_f32_16x16x32_bf16 v[28:31], v[132:135], v[148:151], v[28:31]
  ds_read_b64_tr_b16 v[78:79], v152 offset:15424
  v_mfma_f32_16x16x32_bf16 v[12:15], v[136:139], v[144:147], v[12:15]
  ds_read_b64_tr_b16 v[80:81], v153 offset:10336
  v_mfma_f32_16x16x32_bf16 v[32:35], v[136:139], v[148:151], v[32:35]
  ds_read_b64_tr_b16 v[82:83], v153 offset:15456
  v_mfma_f32_16x16x32_bf16 v[16:19], v[140:143], v[144:147], v[16:19]
  ds_read_b64_tr_b16 v[84:85], v152 offset:10368
  v_mfma_f32_16x16x32_bf16 v[36:39], v[140:143], v[148:151], v[36:39]
  ds_read_b64_tr_b16 v[86:87], v152 offset:15488
  s_add_u32 s43, s44, 110592
  s_add_u32 s45, s66, 131072
  s_add_u32 m0, s65, 110592
  s_nop 0
  buffer_load_dwordx4 v159, s[16:19], s66 offen lds
  s_add_u32 m0, s65, 111616
  s_nop 0
  buffer_load_dwordx4 v159, s[16:19], s45 offen lds
  s_add_u32 m0, s43, 0
  s_nop 0
  buffer_load_dwordx4 v155, s[4:7], s67 offen lds
  s_add_u32 m0, s43, 1024
  s_nop 0
  buffer_load_dwordx4 v156, s[4:7], s67 offen lds
  s_add_u32 s66, s66, 262144
  s_add_u32 s67, s67, 81920
  s_waitcnt lgkmcnt(0)
  s_add_u32 s39, s39, 1
  s_cmp_lt_u32 s39, s47
  s_cbranch_scc1 L_gm_loop0
  s_waitcnt vmcnt(8)
  s_barrier
  v_mfma_f32_16x16x32_bf16 v[0:3], v[40:43], v[60:63], v[0:3]
  ds_read_b128 v[116:119], v154 offset:36864
  ds_read_b128 v[120:123], v154 offset:38912
  v_mfma_f32_16x16x32_bf16 v[20:23], v[40:43], v[64:67], v[20:23]
  ds_read_b64_tr_b16 v[96:97], v152 offset:36864
  ds_read_b64_tr_b16 v[98:99], v152 offset:41984
  v_mfma_f32_16x16x32_bf16 v[4:7], v[44:47], v[60:63], v[4:7]
  ds_read_b64_tr_b16 v[100:101], v153 offset:36896
  ds_read_b64_tr_b16 v[102:103], v153 offset:42016
  v_mfma_f32_16x16x32_bf16 v[24:27], v[44:47], v[64:67], v[24:27]
  ds_read_b64_tr_b16 v[104:105], v152 offset:36928
  ds_read_b64_tr_b16 v[106:107], v152 offset:42048
  v_mfma_f32_16x16x32_bf16 v[8:11], v[48:51], v[60:63], v[8:11]
  ds_read_b64_tr_b16 v[108:109], v153 offset:36960
  v_mfma_f32_16x16x32_bf16 v[28:31], v[48:51], v[64:67], v[28:31]
  ds_read_b64_tr_b16 v[110:111], v153 offset:42080
  v_mfma_f32_16x16x32_bf16 v[12:15], v[52:55], v[60:63], v[12:15]
  ds_read_b64_tr_b16 v[112:113], v152 offset:36992
  v_mfma_f32_16x16x32_bf16 v[32:35], v[52:55], v[64:67], v[32:35]
  ds_read_b64_tr_b16 v[114:115], v152 offset:42112
  v_mfma_f32_16x16x32_bf16 v[16:19], v[56:59], v[60:63], v[16:19]
  ds_read_b128 v[144:147], v154 offset:37888
  v_mfma_f32_16x16x32_bf16 v[36:39], v[56:59], v[64:67], v[36:39]
  ds_read_b128 v[148:151], v154 offset:39936
  v_mfma_f32_16x16x32_bf16 v[0:3], v[68:71], v[88:91], v[0:3]
  ds_read_b64_tr_b16 v[124:125], v152 offset:47104
  v_mfma_f32_16x16x32_bf16 v[20:23], v[68:71], v[92:95], v[20:23]
  ds_read_b64_tr_b16 v[126:127], v152 offset:52224
  v_mfma_f32_16x16x32_bf16 v[4:7], v[72:75], v[88:91], v[4:7]
  ds_read_b64_tr_b16 v[128:129], v153 offset:47136
  v_mfma_f32_16x16x32_bf16 v[24:27], v[72:75], v[92:95], v[24:27]
  ds_read_b64_tr_b16 v[130:131], v153 offset:52256
  v_mfma_f32_16x16x32_bf16 v[8:11], v[76:79], v[88:91], v[8:11]
  ds_read_b64_tr_b16 v[132:133], v152 offset:47168
  v_mfma_f32_16x16x32_bf16 v[28:31], v[76:79], v[92:95], v[28:31]
  ds_read_b64_tr_b16 v[134:135], v152 offset:52288
  v_mfma_f32_16x16x32_bf16 v[12:15], v[80:83], v[88:91], v[12:15]
  ds_read_b64_tr_b16 v[136:137], v153 offset:47200
  v_mfma_f32_16x16x32_bf16 v[32:35], v[80:83], v[92:95], v[32:35]
  ds_read_b64_tr_b16 v[138:139], v153 offset:52320
  v_mfma_f32_16x16x32_bf16 v[16:19], v[84:87], v[88:91], v[16:19]
  ds_read_b64_tr_b16 v[140:141], v152 offset:47232
  v_mfma_f32_16x16x32_bf16 v[36:39], v[84:87], v[92:95], v[36:39]
  ds_read_b64_tr_b16 v[142:143], v152 offset:52352
  s_add_u32 s43, s44, 0
  s_add_u32 s45, s66, 131072
  s_add_u32 m0, s65, 0
  s_nop 0
  buffer_load_dwordx4 v159, s[16:19], s66 offen lds
  s_add_u32 m0, s65, 1024
  s_nop 0
  buffer_load_dwordx4 v159, s[16:19], s45 offen lds
  s_add_u32 m0, s43, 0
  s_nop 0
  buffer_load_dwordx4 v155, s[4:7], s67 offen lds
  s_add_u32 m0, s43, 1024
  s_nop 0
  buffer_load_dwordx4 v156, s[4:7], s67 offen lds
  s_add_u32 s66, s66, 262144
  s_add_u32 s67, s67, 81920
  s_waitcnt lgkmcnt(0)
  s_waitcnt vmcnt(8)
  s_barrier
  v_mfma_f32_16x16x32_bf16 v[0:3], v[96:99], v[116:119], v[0:3]
  ds_read_b128 v[60:63], v170 offset:0
  ds_read_b128 v[64:67], v170 offset:2048
  v_mfma_f32_16x16x32_bf16 v[20:23], v[96:99], v[120:123], v[20:23]
  ds_read_b64_tr_b16 v[40:41], v168 offset:0
  ds_read_b64_tr_b16 v[42:43], v168 offset:5120
  v_mfma_f32_16x16x32_bf16 v[4:7], v[100:103], v[116:119], v[4:7]
  ds_read_b64_tr_b16 v[44:45], v169 offset:32
  ds_read_b64_tr_b16 v[46:47], v169 offset:5152
  v_mfma_f32_16x16x32_bf16 v[24:27], v[100:103], v[120:123], v[24:27]
  ds_read_b64_tr_b16 v[48:49], v168 offset:64
  ds_read_b64_tr_b16 v[50:51], v168 offset:5184
  v_mfma_f32_16x16x32_bf16 v[8:11], v[104:107], v[116:119], v[8:11]
  ds_read_b64_tr_b16 v[52:53], v169 offset:96
  v_mfma_f32_16x16x32_bf16 v[28:31], v[104:107], v[120:123], v[28:31]
  ds_read_b64_tr_b16 v[54:55], v169 offset:5216
  v_mfma_f32_16x16x32_bf16 v[12:15], v[108:111], v[116:119], v[12:15]
  ds_read_b64_tr_b16 v[56:57], v168 offset:128
  v_mfma_f32_16x16x32_bf16 v[32:35], v[108:111], v[120:123], v[32:35]
  ds_read_b64_tr_b16 v[58:59], v168 offset:5248
  v_mfma_f32_16x16x32_bf16 v[16:19], v[112:115], v[116:119], v[16:19]
  ds_read_b128 v[88:91], v170 offset:1024
  v_mfma_f32_16x16x32_bf16 v[36:39], v[112:115], v[120:123], v[36:39]
  ds_read_b128 v[92:95], v170 offset:3072
  v_mfma_f32_16x16x32_bf16 v[0:3], v[124:127], v[144:147], v[0:3]
  ds_read_b64_tr_b16 v[68:69], v168 offset:10240
  v_mfma_f32_16x16x32_bf16 v[20:23], v[124:127], v[148:151], v[20:23]
  ds_read_b64_tr_b16 v[70:71], v168 offset:15360
  v_mfma_f32_16x16x32_bf16 v[4:7], v[128:131], v[144:147], v[4:7]
  ds_read_b64_tr_b16 v[72:73], v169 offset:10272
  v_mfma_f32_16x16x32_bf16 v[24:27], v[128:131], v[148:151], v[24:27]
  ds_read_b64_tr_b16 v[74:75], v169 offset:15392
  v_mfma_f32_16x16x32_bf16 v[8:11], v[132:135], v[144:147], v[8:11]
  ds_read_b64_tr_b16 v[76:77], v168 offset:10304
  v_mfma_f32_16x16x32_bf16 v[28:31], v[132:135], v[148:151], v[28:31]
  ds_read_b64_tr_b16 v[78:79], v168 offset:15424
  v_mfma_f32_16x16x32_bf16 v[12:15], v[136:139], v[144:147], v[12:15]
  ds_read_b64_tr_b16 v[80:81], v169 offset:10336
  v_mfma_f32_16x16x32_bf16 v[32:35], v[136:139], v[148:151], v[32:35]
  ds_read_b64_tr_b16 v[82:83], v169 offset:15456
  v_mfma_f32_16x16x32_bf16 v[16:19], v[140:143], v[144:147], v[16:19]
  ds_read_b64_tr_b16 v[84:85], v168 offset:10368
  v_mfma_f32_16x16x32_bf16 v[36:39], v[140:143], v[148:151], v[36:39]
  ds_read_b64_tr_b16 v[86:87], v168 offset:15488
  s_add_u32 s43, s44, 36864
  s_add_u32 s45, s66, 131072
  s_add_u32 m0, s65, 36864
  s_nop 0
  buffer_load_dwordx4 v159, s[16:19], s66 offen lds
  s_add_u32 m0, s65, 37888
  s_nop 0
  buffer_load_dwordx4 v159, s[16:19], s45 offen lds
  s_add_u32 m0, s43, 0
  s_nop 0
  buffer_load_dwordx4 v155, s[4:7], s67 offen lds
  s_add_u32 m0, s43, 1024
  s_nop 0
  buffer_load_dwordx4 v156, s[4:7], s67 offen lds
  s_add_u32 s66, s66, 262144
  s_add_u32 s67, s67, 81920
  s_waitcnt lgkmcnt(0)
  s_waitcnt vmcnt(8)
  s_barrier
  v_mfma_f32_16x16x32_bf16 v[0:3], v[40:43], v[60:63], v[0:3]
  ds_read_b128 v[116:119], v170 offset:36864
  ds_read_b128 v[120:123], v170 offset:38912
  v_mfma_f32_16x16x32_bf16 v[20:23], v[40:43], v[64:67], v[20:23]
  ds_read_b64_tr_b16 v[96:97], v168 offset:36864
  ds_read_b64_tr_b16 v[98:99], v168 offset:41984
  v_mfma_f32_16x16x32_bf16 v[4:7], v[44:47], v[60:63], v[4:7]
  ds_read_b64_tr_b16 v[100:101], v169 offset:36896
  ds_read_b64_tr_b16 v[102:103], v169 offset:42016
  v_mfma_f32_16x16x32_bf16 v[24:27], v[44:47], v[64:67], v[24:27]
  ds_read_b64_tr_b16 v[104:105], v168 offset:36928
  ds_read_b64_tr_b16 v[106:107], v168 offset:42048
  v_mfma_f32_16x16x32_bf16 v[8:11], v[48:51], v[60:63], v[8:11]
  ds_read_b64_tr_b16 v[108:109], v169 offset:36960
  v_mfma_f32_16x16x32_bf16 v[28:31], v[48:51], v[64:67], v[28:31]
  ds_read_b64_tr_b16 v[110:111], v169 offset:42080
  v_mfma_f32_16x16x32_bf16 v[12:15], v[52:55], v[60:63], v[12:15]
  ds_read_b64_tr_b16 v[112:113], v168 offset:36992
  v_mfma_f32_16x16x32_bf16 v[32:35], v[52:55], v[64:67], v[32:35]
  ds_read_b64_tr_b16 v[114:115], v168 offset:42112
  v_mfma_f32_16x16x32_bf16 v[16:19], v[56:59], v[60:63], v[16:19]
  ds_read_b128 v[144:147], v170 offset:37888
  v_mfma_f32_16x16x32_bf16 v[36:39], v[56:59], v[64:67], v[36:39]
  ds_read_b128 v[148:151], v170 offset:39936
  v_mfma_f32_16x16x32_bf16 v[0:3], v[68:71], v[88:91], v[0:3]
  ds_read_b64_tr_b16 v[124:125], v168 offset:47104
  v_mfma_f32_16x16x32_bf16 v[20:23], v[68:71], v[92:95], v[20:23]
  ds_read_b64_tr_b16 v[126:127], v168 offset:52224
  v_mfma_f32_16x16x32_bf16 v[4:7], v[72:75], v[88:91], v[4:7]
  ds_read_b64_tr_b16 v[128:129], v169 offset:47136
  v_mfma_f32_16x16x32_bf16 v[24:27], v[72:75], v[92:95], v[24:27]
  ds_read_b64_tr_b16 v[130:131], v169 offset:52256
  v_mfma_f32_16x16x32_bf16 v[8:11], v[76:79], v[88:91], v[8:11]
  ds_read_b64_tr_b16 v[132:133], v168 offset:47168
  v_mfma_f32_16x16x32_bf16 v[28:31], v[76:79], v[92:95], v[28:31]
  ds_read_b64_tr_b16 v[134:135], v168 offset:52288
  v_mfma_f32_16x16x32_bf16 v[12:15], v[80:83], v[88:91], v[12:15]
  ds_read_b64_tr_b16 v[136:137], v169 offset:47200
  v_mfma_f32_16x16x32_bf16 v[32:35], v[80:83], v[92:95], v[32:35]
  ds_read_b64_tr_b16 v[138:139], v169 offset:52320
  v_mfma_f32_16x16x32_bf16 v[16:19], v[84:87], v[88:91], v[16:19]
  ds_read_b64_tr_b16 v[140:141], v168 offset:47232
  v_mfma_f32_16x16x32_bf16 v[36:39], v[84:87], v[92:95], v[36:39]
  ds_read_b64_tr_b16 v[142:143], v168 offset:52352
  s_add_u32 s43, s44, 73728
  s_add_u32 s45, s66, 131072
  s_add_u32 m0, s65, 73728
  s_nop 0
  buffer_load_dwordx4 v159, s[16:19], s66 offen lds
  s_add_u32 m0, s65, 74752
  s_nop 0
  buffer_load_dwordx4 v159, s[16:19], s45 offen lds
  s_add_u32 m0, s43, 0
  s_nop 0
  buffer_load_dwordx4 v155, s[4:7], s67 offen lds
  s_add_u32 m0, s43, 1024
  s_nop 0
  buffer_load_dwordx4 v156, s[4:7], s67 offen lds
  s_add_u32 s66, s66, 262144
  s_add_u32 s67, s67, 81920
  s_waitcnt lgkmcnt(0)
  v_mfma_f32_16x16x32_bf16 v[0:3], v[96:99], v[116:119], v[0:3]
  v_mfma_f32_16x16x32_bf16 v[20:23], v[96:99], v[120:123], v[20:23]
  v_mfma_f32_16x16x32_bf16 v[4:7], v[100:103], v[116:119], v[4:7]
  v_mfma_f32_16x16x32_bf16 v[24:27], v[100:103], v[120:123], v[24:27]
  v_mfma_f32_16x16x32_bf16 v[8:11], v[104:107], v[116:119], v[8:11]
  v_mfma_f32_16x16x32_bf16 v[28:31], v[104:107], v[120:123], v[28:31]
  v_mfma_f32_16x16x32_bf16 v[12:15], v[108:111], v[116:119], v[12:15]
  v_mfma_f32_16x16x32_bf16 v[32:35], v[108:111], v[120:123], v[32:35]
  v_mfma_f32_16x16x32_bf16 v[16:19], v[112:115], v[116:119], v[16:19]
  v_mfma_f32_16x16x32_bf16 v[36:39], v[112:115], v[120:123], v[36:39]
  v_mfma_f32_16x16x32_bf16 v[0:3], v[124:127], v[144:147], v[0:3]
  v_mfma_f32_16x16x32_bf16 v[20:23], v[124:127], v[148:151], v[20:23]
  v_mfma_f32_16x16x32_bf16 v[4:7], v[128:131], v[144:147], v[4:7]
  v_mfma_f32_16x16x32_bf16 v[24:27], v[128:131], v[148:151], v[24:27]
  v_mfma_f32_16x16x32_bf16 v[8:11], v[132:135], v[144:147], v[8:11]
  v_mfma_f32_16x16x32_bf16 v[28:31], v[132:135], v[148:151], v[28:31]
  v_mfma_f32_16x16x32_bf16 v[12:15], v[136:139], v[144:147], v[12:15]
  v_mfma_f32_16x16x32_bf16 v[32:35], v[136:139], v[148:151], v[32:35]
  v_mfma_f32_16x16x32_bf16 v[16:19], v[140:143], v[144:147], v[16:19]
  v_mfma_f32_16x16x32_bf16 v[36:39], v[140:143], v[148:151], v[36:39]
  s_waitcnt lgkmcnt(0)
  s_branch L_gm_fin
L_gm_g1:
  s_add_u32 s43, s44, 0
  s_add_u32 s45, s66, 131072
  s_add_u32 m0, s65, 0
  s_nop 0
  buffer_load_dwordx4 v159, s[16:19], s66 offen lds
  s_add_u32 m0, s65, 1024
  s_nop 0
  buffer_load_dwordx4 v159, s[16:19], s45 offen lds
  s_add_u32 m0, s43, 0
  s_nop 0
  buffer_load_dwordx4 v155, s[4:7], s67 offen lds
  s_add_u32 m0, s43, 1024
  s_nop 0
  buffer_load_dwordx4 v156, s[4:7], s67 offen lds
  s_add_u32 m0, s43, 2048
  s_nop 0
  buffer_load_dwordx4 v157, s[4:7], s67 offen lds
  s_add_u32 s66, s66, 262144
  s_add_u32 s67, s67, 81920
  s_add_u32 s43, s44, 36864
  s_add_u32 s45, s66, 131072
  s_add_u32 m0, s65, 36864
  s_nop 0
  buffer_load_dwordx4 v159, s[16:19], s66 offen lds
  s_add_u32 m0, s65, 37888
  s_nop 0
  buffer_load_dwordx4 v159, s[16:19], s45 offen lds
  s_add_u32 m0, s43, 0
  s_nop 0
  buffer_load_dwordx4 v155, s[4:7], s67 offen lds
  s_add_u32 m0, s43, 1024
  s_nop 0
  buffer_load_dwordx4 v156, s[4:7], s67 offen lds
  s_add_u32 m0, s43, 2048
  s_nop 0
  buffer_load_dwordx4 v157, s[4:7], s67 offen lds
  s_add_u32 s66, s66, 262144
  s_add_u32 s67, s67, 81920
  s_add_u32 s43, s44, 73728
  s_add_u32 s45, s66, 131072
  s_add_u32 m0, s65, 73728
  s_nop 0
  buffer_load_dwordx4 v159, s[16:19], s66 offen lds
  s_add_u32 m0, s65, 74752
  s_nop 0
  buffer_load_dwordx4 v159, s[16:19], s45 offen lds
  s_add_u32 m0, s43, 0
  s_nop 0
  buffer_load_dwordx4 v155, s[4:7], s67 offen lds
  s_add_u32 m0, s43, 1024
  s_nop 0
  buffer_load_dwordx4 v156, s[4:7], s67 offen lds
  s_add_u32 m0, s43, 2048
  s_nop 0
  buffer_load_dwordx4 v157, s[4:7], s67 offen lds
  s_add_u32 s66, s66, 262144
  s_add_u32 s67, s67, 81920
  s_add_u32 s43, s44, 110592
  s_add_u32 s45, s66, 131072
  s_add_u32 m0, s65, 110592
  s_nop 0
  buffer_load_dwordx4 v159, s[16:19], s66 offen lds
  s_add_u32 m0, s65, 111616
  s_nop 0
  buffer_load_dwordx4 v159, s[16:19], s45 offen lds
  s_add_u32 m0, s43, 0
  s_nop 0
  buffer_load_dwordx4 v155, s[4:7], s67 offen lds
  s_add_u32 m0, s43, 1024
  s_nop 0
  buffer_load_dwordx4 v156, s[4:7], s67 offen lds
  s_add_u32 m0, s43, 2048
  s_nop 0
  buffer_load_dwordx4 v157, s[4:7], s67 offen lds
  s_add_u32 s66, s66, 262144
  s_add_u32 s67, s67, 81920
  s_waitcnt vmcnt(15)
  s_barrier
  ds_read_b128 v[60:63], v154 offset:0
  ds_read_b128 v[64:67], v154 offset:2048
  ds_read_b64_tr_b16 v[40:41], v152 offset:0
  ds_read_b64_tr_b16 v[42:43], v152 offset:5120
  ds_read_b64_tr_b16 v[44:45], v153 offset:32
  ds_read_b64_tr_b16 v[46:47], v153 offset:5152
  ds_read_b64_tr_b16 v[48:49], v152 offset:64
  ds_read_b64_tr_b16 v[50:51], v152 offset:5184
  ds_read_b64_tr_b16 v[52:53], v153 offset:96
  ds_read_b64_tr_b16 v[54:55], v153 offset:5216
  ds_read_b64_tr_b16 v[56:57], v152 offset:128
  ds_read_b64_tr_b16 v[58:59], v152 offset:5248
  ds_read_b128 v[88:91], v154 offset:1024
  ds_read_b128 v[92:95], v154 offset:3072
  ds_read_b64_tr_b16 v[68:69], v152 offset:10240
  ds_read_b64_tr_b16 v[70:71], v152 offset:15360
  ds_read_b64_tr_b16 v[72:73], v153 offset:10272
  ds_read_b64_tr_b16 v[74:75], v153 offset:15392
  ds_read_b64_tr_b16 v[76:77], v152 offset:10304
  ds_read_b64_tr_b16 v[78:79], v152 offset:15424
  ds_read_b64_tr_b16 v[80:81], v153 offset:10336
  ds_read_b64_tr_b16 v[82:83], v153 offset:15456
  ds_read_b64_tr_b16 v[84:85], v152 offset:10368
  ds_read_b64_tr_b16 v[86:87], v152 offset:15488
  s_waitcnt lgkmcnt(0)
  s_mov_b32 s39, 1
L_gm_loop1:
  s_waitcnt vmcnt(10)
  s_barrier
  s_add_u32 s43, s44, 0
  s_add_u32 s45, s66, 131072
  s_add_u32 m0, s65, 0
  s_nop 0
  buffer_load_dwordx4 v159, s[16:19], s66 offen lds
  s_add_u32 m0, s65, 1024
  s_nop 0
  buffer_load_dwordx4 v159, s[16:19], s45 offen lds
  s_add_u32 m0, s43, 0
  s_nop 0
  buffer_load_dwordx4 v155, s[4:7], s67 offen lds
  s_add_u32 m0, s43, 1024
  s_nop 0
  buffer_load_dwordx4 v156, s[4:7], s67 offen lds
  s_add_u32 m0, s43, 2048
  s_nop 0
  buffer_load_dwordx4 v157, s[4:7], s67 offen lds
  s_add_u32 s66, s66, 262144
  s_add_u32 s67, s67, 81920
  v_mfma_f32_16x16x32_bf16 v[0:3], v[40:43], v[60:63], v[0:3]
  ds_read_b128 v[116:119], v154 offset:36864
  ds_read_b128 v[120:123], v154 offset:38912
  v_mfma_f32_16x16x32_bf16 v[20:23], v[40:43], v[64:67], v[20:23]
  ds_read_b64_tr_b16 v[96:97], v152 offset:36864
  ds_read_b64_tr_b16 v[98:99], v152 offset:41984
  v_mfma_f32_16x16x32_bf16 v[4:7], v[44:47], v[60:63], v[4:7]
  ds_read_b64_tr_b16 v[100:101], v153 offset:36896
  ds_read_b64_tr_b16 v[102:103], v153 offset:42016
  v_mfma_f32_16x16x32_bf16 v[24:27], v[44:47], v[64:67], v[24:27]
  ds_read_b64_tr_b16 v[104:105], v152 offset:36928
  ds_read_b64_tr_b16 v[106:107], v152 offset:42048
  v_mfma_f32_16x16x32_bf16 v[8:11], v[48:51], v[60:63], v[8:11]
  ds_read_b64_tr_b16 v[108:109], v153 offset:36960
  v_mfma_f32_16x16x32_bf16 v[28:31], v[48:51], v[64:67], v[28:31]
  ds_read_b64_tr_b16 v[110:111], v153 offset:42080
  v_mfma_f32_16x16x32_bf16 v[12:15], v[52:55], v[60:63], v[12:15]
  ds_read_b64_tr_b16 v[112:113], v152 offset:36992
  v_mfma_f32_16x16x32_bf16 v[32:35], v[52:55], v[64:67], v[32:35]
  ds_read_b64_tr_b16 v[114:115], v152 offset:42112
  v_mfma_f32_16x16x32_bf16 v[16:19], v[56:59], v[60:63], v[16:19]
  ds_read_b128 v[144:147], v154 offset:37888
  v_mfma_f32_16x16x32_bf16 v[36:39], v[56:59], v[64:67], v[36:39]
  ds_read_b128 v[148:151], v154 offset:39936
  v_mfma_f32_16x16x32_bf16 v[0:3], v[68:71], v[88:91], v[0:3]
  ds_read_b64_tr_b16 v[124:125], v152 offset:47104
  v_mfma_f32_16x16x32_bf16 v[20:23], v[68:71], v[92:95], v[20:23]
  ds_read_b64_tr_b16 v[126:127], v152 offset:52224
  v_mfma_f32_16x16x32_bf16 v[4:7], v[72:75], v[88:91], v[4:7]
  ds_read_b64_tr_b16 v[128:129], v153 offset:47136
  v_mfma_f32_16x16x32_bf16 v[24:27], v[72:75], v[92:95], v[24:27]
  ds_read_b64_tr_b16 v[130:131], v153 offset:52256
  v_mfma_f32_16x16x32_bf16 v[8:11], v[76:79], v[88:91], v[8:11]
  ds_read_b64_tr_b16 v[132:133], v152 offset:47168
  v_mfma_f32_16x16x32_bf16 v[28:31], v[76:79], v[92:95], v[28:31]
  ds_read_b64_tr_b16 v[134:135], v152 offset:52288
  v_mfma_f32_16x16x32_bf16 v[12:15], v[80:83], v[88:91], v[12:15]
  ds_read_b64_tr_b16 v[136:137], v153 offset:47200
  v_mfma_f32_16x16x32_bf16 v[32:35], v[80:83], v[92:95], v[32:35]
  ds_read_b64_tr_b16 v[138:139], v153 offset:52320
  v_mfma_f32_16x16x32_bf16 v[16:19], v[84:87], v[88:91], v[16:19]
  ds_read_b64_tr_b16 v[140:141], v152 offset:47232
  v_mfma_f32_16x16x32_bf16 v[36:39], v[84:87], v[92:95], v[36:39]
  ds_read_b64_tr_b16 v[142:143], v152 offset:52352
  s_waitcnt lgkmcnt(0)
  s_waitcnt vmcnt(10)
  s_barrier
  s_add_u32 s43, s44, 36864
  s_add_u32 s45, s66, 131072
  s_add_u32 m0, s65, 36864
  s_nop 0
  buffer_load_dwordx4 v159, s[16:19], s66 offen lds
  s_add_u32 m0, s65, 37888
  s_nop 0
  buffer_load_dwordx4 v159, s[16:19], s45 offen lds
  s_add_u32 m0, s43, 0
  s_nop 0
  buffer_load_dwordx4 v155, s[4:7], s67 offen lds
  s_add_u32 m0, s43, 1024
  s_nop 0
  buffer_load_dwordx4 v156, s[4:7], s67 offen lds
  s_add_u32 m0, s43, 2048
  s_nop 0
  buffer_load_dwordx4 v157, s[4:7], s67 offen lds
  s_add_u32 s66, s66, 262144
  s_add_u32 s67, s67, 81920
  v_mfma_f32_16x16x32_bf16 v[0:3], v[96:99], v[116:119], v[0:3]
  ds_read_b128 v[60:63], v170 offset:0
  ds_read_b128 v[64:67], v170 offset:2048
  v_mfma_f32_16x16x32_bf16 v[20:23], v[96:99], v[120:123], v[20:23]
  ds_read_b64_tr_b16 v[40:41], v168 offset:0
  ds_read_b64_tr_b16 v[42:43], v168 offset:5120
  v_mfma_f32_16x16x32_bf16 v[4:7], v[100:103], v[116:119], v[4:7]
  ds_read_b64_tr_b16 v[44:45], v169 offset:32
  ds_read_b64_tr_b16 v[46:47], v169 offset:5152
  v_mfma_f32_16x16x32_bf16 v[24:27], v[100:103], v[120:123], v[24:27]
  ds_read_b64_tr_b16 v[48:49], v168 offset:64
  ds_read_b64_tr_b16 v[50:51], v168 offset:5184
  v_mfma_f32_16x16x32_bf16 v[8:11], v[104:107], v[116:119], v[8:11]
  ds_read_b64_tr_b16 v[52:53], v169 offset:96
  v_mfma_f32_16x16x32_bf16 v[28:31], v[104:107], v[120:123], v[28:31]
  ds_read_b64_tr_b16 v[54:55], v169 offset:5216
  v_mfma_f32_16x16x32_bf16 v[12:15], v[108:111], v[116:119], v[12:15]
  ds_read_b64_tr_b16 v[56:57], v168 offset:128
  v_mfma_f32_16x16x32_bf16 v[32:35], v[108:111], v[120:123], v[32:35]
  ds_read_b64_tr_b16 v[58:59], v168 offset:5248
  v_mfma_f32_16x16x32_bf16 v[16:19], v[112:115], v[116:119], v[16:19]
  ds_read_b128 v[88:91], v170 offset:1024
  v_mfma_f32_16x16x32_bf16 v[36:39], v[112:115], v[120:123], v[36:39]
  ds_read_b128 v[92:95], v170 offset:3072
  v_mfma_f32_16x16x32_bf16 v[0:3], v[124:127], v[144:147], v[0:3]
  ds_read_b64_tr_b16 v[68:69], v168 offset:10240
  v_mfma_f32_16x16x32_bf16 v[20:23], v[124:127], v[148:151], v[20:23]
  ds_read_b64_tr_b16 v[70:71], v168 offset:15360
  v_mfma_f32_16x16x32_bf16 v[4:7], v[128:131], v[144:147], v[4:7]
  ds_read_b64_tr_b16 v[72:73], v169 offset:10272
  v_mfma_f32_16x16x32_bf16 v[24:27], v[128:131], v[148:151], v[24:27]
  ds_read_b64_tr_b16 v[74:75], v169 offset:15392
  v_mfma_f32_16x16x32_bf16 v[8:11], v[132:135], v[144:147], v[8:11]
  ds_read_b64_tr_b16 v[76:77], v168 offset:10304
  v_mfma_f32_16x16x32_bf16 v[28:31], v[132:135], v[148:151], v[28:31]
  ds_read_b64_tr_b16 v[78:79], v168 offset:15424
  v_mfma_f32_16x16x32_bf16 v[12:15], v[136:139], v[144:147], v[12:15]
  ds_read_b64_tr_b16 v[80:81], v169 offset:10336
  v_mfma_f32_16x16x32_bf16 v[32:35], v[136:139], v[148:151], v[32:35]
  ds_read_b64_tr_b16 v[82:83], v169 offset:15456
  v_mfma_f32_16x16x32_bf16 v[16:19], v[140:143], v[144:147], v[16:19]
  ds_read_b64_tr_b16 v[84:85], v168 offset:10368
  v_mfma_f32_16x16x32_bf16 v[36:39], v[140:143], v[148:151], v[36:39]
  ds_read_b64_tr_b16 v[86:87], v168 offset:15488
  s_waitcnt lgkmcnt(0)
  s_waitcnt vmcnt(10)
  s_barrier
  s_add_u32 s43, s44, 73728
  s_add_u32 s45, s66, 131072
  s_add_u32 m0, s65, 73728
  s_nop 0
  buffer_load_dwordx4 v159, s[16:19], s66 offen lds
  s_add_u32 m0, s65, 74752
  s_nop 0
  buffer_load_dwordx4 v159, s[16:19], s45 offen lds
  s_add_u32 m0, s43, 0
  s_nop 0
  buffer_load_dwordx4 v155, s[4:7], s67 offen lds
  s_add_u32 m0, s43, 1024
  s_nop 0
  buffer_load_dwordx4 v156, s[4:7], s67 offen lds
  s_add_u32 m0, s43, 2048
  s_nop 0
  buffer_load_dwordx4 v157, s[4:7], s67 offen lds
  s_add_u32 s66, s66, 262144
  s_add_u32 s67, s67, 81920
  v_mfma_f32_16x16x32_bf16 v[0:3], v[40:43], v[60:63], v[0:3]
  ds_read_b128 v[116:119], v170 offset:36864
  ds_read_b128 v[120:123], v170 offset:38912
  v_mfma_f32_16x16x32_bf16 v[20:23], v[40:43], v[64:67], v[20:23]
  ds_read_b64_tr_b16 v[96:97], v168 offset:36864
  ds_read_b64_tr_b16 v[98:99], v168 offset:41984
  v_mfma_f32_16x16x32_bf16 v[4:7], v[44:47], v[60:63], v[4:7]
  ds_read_b64_tr_b16 v[100:101], v169 offset:36896
  ds_read_b64_tr_b16 v[102:103], v169 offset:42016
  v_mfma_f32_16x16x32_bf16 v[24:27], v[44:47], v[64:67], v[24:27]
  ds_read_b64_tr_b16 v[104:105], v168 offset:36928
  ds_read_b64_tr_b16 v[106:107], v168 offset:42048
  v_mfma_f32_16x16x32_bf16 v[8:11], v[48:51], v[60:63], v[8:11]
  ds_read_b64_tr_b16 v[108:109], v169 offset:36960
  v_mfma_f32_16x16x32_bf16 v[28:31], v[48:51], v[64:67], v[28:31]
  ds_read_b64_tr_b16 v[110:111], v169 offset:42080
  v_mfma_f32_16x16x32_bf16 v[12:15], v[52:55], v[60:63], v[12:15]
  ds_read_b64_tr_b16 v[112:113], v168 offset:36992
  v_mfma_f32_16x16x32_bf16 v[32:35], v[52:55], v[64:67], v[32:35]
  ds_read_b64_tr_b16 v[114:115], v168 offset:42112
  v_mfma_f32_16x16x32_bf16 v[16:19], v[56:59], v[60:63], v[16:19]
  ds_read_b128 v[144:147], v170 offset:37888
  v_mfma_f32_16x16x32_bf16 v[36:39], v[56:59], v[64:67], v[36:39]
  ds_read_b128 v[148:151], v170 offset:39936
  v_mfma_f32_16x16x32_bf16 v[0:3], v[68:71], v[88:91], v[0:3]
  ds_read_b64_tr_b16 v[124:125], v168 offset:47104
  v_mfma_f32_16x16x32_bf16 v[20:23], v[68:71], v[92:95], v[20:23]
  ds_read_b64_tr_b16 v[126:127], v168 offset:52224
  v_mfma_f32_16x16x32_bf16 v[4:7], v[72:75], v[88:91], v[4:7]
  ds_read_b64_tr_b16 v[128:129], v169 offset:47136
  v_mfma_f32_16x16x32_bf16 v[24:27], v[72:75], v[92:95], v[24:27]
  ds_read_b64_tr_b16 v[130:131], v169 offset:52256
  v_mfma_f32_16x16x32_bf16 v[8:11], v[76:79], v[88:91], v[8:11]
  ds_read_b64_tr_b16 v[132:133], v168 offset:47168
  v_mfma_f32_16x16x32_bf16 v[28:31], v[76:79], v[92:95], v[28:31]
  ds_read_b64_tr_b16 v[134:135], v168 offset:52288
  v_mfma_f32_16x16x32_bf16 v[12:15], v[80:83], v[88:91], v[12:15]
  ds_read_b64_tr_b16 v[136:137], v169 offset:47200
  v_mfma_f32_16x16x32_bf16 v[32:35], v[80:83], v[92:95], v[32:35]
  ds_read_b64_tr_b16 v[138:139], v169 offset:52320
  v_mfma_f32_16x16x32_bf16 v[16:19], v[84:87], v[88:91], v[16:19]
  ds_read_b64_tr_b16 v[140:141], v168 offset:47232
  v_mfma_f32_16x16x32_bf16 v[36:39], v[84:87], v[92:95], v[36:39]
  ds_read_b64_tr_b16 v[142:143], v168 offset:52352
  s_waitcnt lgkmcnt(0)
  s_waitcnt vmcnt(10)
  s_barrier
  s_add_u32 s43, s44, 110592
  s_add_u32 s45, s66, 131072
  s_add_u32 m0, s65, 110592
  s_nop 0
  buffer_load_dwordx4 v159, s[16:19], s66 offen lds
  s_add_u32 m0, s65, 111616
  s_nop 0
  buffer_load_dwordx4 v159, s[16:19], s45 offen lds
  s_add_u32 m0, s43, 0
  s_nop 0
  buffer_load_dwordx4 v155, s[4:7], s67 offen lds
  s_add_u32 m0, s43, 1024
  s_nop 0
  buffer_load_dwordx4 v156, s[4:7], s67 offen lds
  s_add_u32 m0, s43, 2048
  s_nop 0
  buffer_load_dwordx4 v157, s[4:7], s67 offen lds
  s_add_u32 s66, s66, 262144
  s_add_u32 s67, s67, 81920
  v_mfma_f32_16x16x32_bf16 v[0:3], v[96:99], v[116:119], v[0:3]
  ds_read_b128 v[60:63], v154 offset:0
  ds_read_b128 v[64:67], v154 offset:2048
  v_mfma_f32_16x16x32_bf16 v[20:23], v[96:99], v[120:123], v[20:23]
  ds_read_b64_tr_b16 v[40:41], v152 offset:0
  ds_read_b64_tr_b16 v[42:43], v152 offset:5120
  v_mfma_f32_16x16x32_bf16 v[4:7], v[100:103], v[116:119], v[4:7]
  ds_read_b64_tr_b16 v[44:45], v153 offset:32
  ds_read_b64_tr_b16 v[46:47], v153 offset:5152
  v_mfma_f32_16x16x32_bf16 v[24:27], v[100:103], v[120:123], v[24:27]
  ds_read_b64_tr_b16 v[48:49], v152 offset:64
  ds_read_b64_tr_b16 v[50:51], v152 offset:5184
  v_mfma_f32_16x16x32_bf16 v[8:11], v[104:107], v[116:119], v[8:11]
  ds_read_b64_tr_b16 v[52:53], v153 offset:96
  v_mfma_f32_16x16x32_bf16 v[28:31], v[104:107], v[120:123], v[28:31]
  ds_read_b64_tr_b16 v[54:55], v153 offset:5216
  v_mfma_f32_16x16x32_bf16 v[12:15], v[108:111], v[116:119], v[12:15]
  ds_read_b64_tr_b16 v[56:57], v152 offset:128
  v_mfma_f32_16x16x32_bf16 v[32:35], v[108:111], v[120:123], v[32:35]
  ds_read_b64_tr_b16 v[58:59], v152 offset:5248
  v_mfma_f32_16x16x32_bf16 v[16:19], v[112:115], v[116:119], v[16:19]
  ds_read_b128 v[88:91], v154 offset:1024
  v_mfma_f32_16x16x32_bf16 v[36:39], v[112:115], v[120:123], v[36:39]
  ds_read_b128 v[92:95], v154 offset:3072
  v_mfma_f32_16x16x32_bf16 v[0:3], v[124:127], v[144:147], v[0:3]
  ds_read_b64_tr_b16 v[68:69], v152 offset:10240
  v_mfma_f32_16x16x32_bf16 v[20:23], v[124:127], v[148:151], v[20:23]
  ds_read_b64_tr_b16 v[70:71], v152 offset:15360
  v_mfma_f32_16x16x32_bf16 v[4:7], v[128:131], v[144:147], v[4:7]
  ds_read_b64_tr_b16 v[72:73], v153 offset:10272
  v_mfma_f32_16x16x32_bf16 v[24:27], v[128:131], v[148:151], v[24:27]
  ds_read_b64_tr_b16 v[74:75], v153 offset:15392
  v_mfma_f32_16x16x32_bf16 v[8:11], v[132:135], v[144:147], v[8:11]
  ds_read_b64_tr_b16 v[76:77], v152 offset:10304
  v_mfma_f32_16x16x32_bf16 v[28:31], v[132:135], v[148:151], v[28:31]
  ds_read_b64_tr_b16 v[78:79], v152 offset:15424
  v_mfma_f32_16x16x32_bf16 v[12:15], v[136:139], v[144:147], v[12:15]
  ds_read_b64_tr_b16 v[80:81], v153 offset:10336
  v_mfma_f32_16x16x32_bf16 v[32:35], v[136:139], v[148:151], v[32:35]
  ds_read_b64_tr_b16 v[82:83], v153 offset:15456
  v_mfma_f32_16x16x32_bf16 v[16:19], v[140:143], v[144:147], v[16:19]
  ds_read_b64_tr_b16 v[84:85], v152 offset:10368
  v_mfma_f32_16x16x32_bf16 v[36:39], v[140:143], v[148:151], v[36:39]
  ds_read_b64_tr_b16 v[86:87], v152 offset:15488
  s_waitcnt lgkmcnt(0)
  s_add_u32 s39, s39, 1
  s_cmp_lt_u32 s39, s47
  s_cbranch_scc1 L_gm_loop1
  s_waitcnt vmcnt(10)
  s_barrier
  s_add_u32 s43, s44, 0
  s_add_u32 s45, s66, 131072
  s_add_u32 m0, s65, 0
  s_nop 0
  buffer_load_dwordx4 v159, s[16:19], s66 offen lds
  s_add_u32 m0, s65, 1024
  s_nop 0
  buffer_load_dwordx4 v159, s[16:19], s45 offen lds
  s_add_u32 m0, s43, 0
  s_nop 0
  buffer_load_dwordx4 v155, s[4:7], s67 offen lds
  s_add_u32 m0, s43, 1024
  s_nop 0
  buffer_load_dwordx4 v156, s[4:7], s67 offen lds
  s_add_u32 m0, s43, 2048
  s_nop 0
  buffer_load_dwordx4 v157, s[4:7], s67 offen lds
  s_add_u32 s66, s66, 262144
  s_add_u32 s67, s67, 81920
  v_mfma_f32_16x16x32_bf16 v[0:3], v[40:43], v[60:63], v[0:3]
  ds_read_b128 v[116:119], v154 offset:36864
  ds_read_b128 v[120:123], v154 offset:38912
  v_mfma_f32_16x16x32_bf16 v[20:23], v[40:43], v[64:67], v[20:23]
  ds_read_b64_tr_b16 v[96:97], v152 offset:36864
  ds_read_b64_tr_b16 v[98:99], v152 offset:41984
  v_mfma_f32_16x16x32_bf16 v[4:7], v[44:47], v[60:63], v[4:7]
  ds_read_b64_tr_b16 v[100:101], v153 offset:36896
  ds_read_b64_tr_b16 v[102:103], v153 offset:42016
  v_mfma_f32_16x16x32_bf16 v[24:27], v[44:47], v[64:67], v[24:27]
  ds_read_b64_tr_b16 v[104:105], v152 offset:36928
  ds_read_b64_tr_b16 v[106:107], v152 offset:42048
  v_mfma_f32_16x16x32_bf16 v[8:11], v[48:51], v[60:63], v[8:11]
  ds_read_b64_tr_b16 v[108:109], v153 offset:36960
  v_mfma_f32_16x16x32_bf16 v[28:31], v[48:51], v[64:67], v[28:31]
  ds_read_b64_tr_b16 v[110:111], v153 offset:42080
  v_mfma_f32_16x16x32_bf16 v[12:15], v[52:55], v[60:63], v[12:15]
  ds_read_b64_tr_b16 v[112:113], v152 offset:36992
  v_mfma_f32_16x16x32_bf16 v[32:35], v[52:55], v[64:67], v[32:35]
  ds_read_b64_tr_b16 v[114:115], v152 offset:42112
  v_mfma_f32_16x16x32_bf16 v[16:19], v[56:59], v[60:63], v[16:19]
  ds_read_b128 v[144:147], v154 offset:37888
  v_mfma_f32_16x16x32_bf16 v[36:39], v[56:59], v[64:67], v[36:39]
  ds_read_b128 v[148:151], v154 offset:39936
  v_mfma_f32_16x16x32_bf16 v[0:3], v[68:71], v[88:91], v[0:3]
  ds_read_b64_tr_b16 v[124:125], v152 offset:47104
  v_mfma_f32_16x16x32_bf16 v[20:23], v[68:71], v[92:95], v[20:23]
  ds_read_b64_tr_b16 v[126:127], v152 offset:52224
  v_mfma_f32_16x16x32_bf16 v[4:7], v[72:75], v[88:91], v[4:7]
  ds_read_b64_tr_b16 v[128:129], v153 offset:47136
  v_mfma_f32_16x16x32_bf16 v[24:27], v[72:75], v[92:95], v[24:27]
  ds_read_b64_tr_b16 v[130:131], v153 offset:52256
  v_mfma_f32_16x16x32_bf16 v[8:11], v[76:79], v[88:91], v[8:11]
  ds_read_b64_tr_b16 v[132:133], v152 offset:47168
  v_mfma_f32_16x16x32_bf16 v[28:31], v[76:79], v[92:95], v[28:31]
  ds_read_b64_tr_b16 v[134:135], v152 offset:52288
  v_mfma_f32_16x16x32_bf16 v[12:15], v[80:83], v[88:91], v[12:15]
  ds_read_b64_tr_b16 v[136:137], v153 offset:47200
  v_mfma_f32_16x16x32_bf16 v[32:35], v[80:83], v[92:95], v[32:35]
  ds_read_b64_tr_b16 v[138:139], v153 offset:52320
  v_mfma_f32_16x16x32_bf16 v[16:19], v[84:87], v[88:91], v[16:19]
  ds_read_b64_tr_b16 v[140:141], v152 offset:47232
  v_mfma_f32_16x16x32_bf16 v[36:39], v[84:87], v[92:95], v[36:39]
  ds_read_b64_tr_b16 v[142:143], v152 offset:52352
  s_waitcnt lgkmcnt(0)
  s_waitcnt vmcnt(10)
  s_barrier
  s_add_u32 s43, s44, 36864
  s_add_u32 s45, s66, 131072
  s_add_u32 m0, s65, 36864
  s_nop 0
  buffer_load_dwordx4 v159, s[16:19], s66 offen lds
  s_add_u32 m0, s65, 37888
  s_nop 0
  buffer_load_dwordx4 v159, s[16:19], s45 offen lds
  s_add_u32 m0, s43, 0
  s_nop 0
  buffer_load_dwordx4 v155, s[4:7], s67 offen lds
  s_add_u32 m0, s43, 1024
  s_nop 0
  buffer_load_dwordx4 v156, s[4:7], s67 offen lds
  s_add_u32 m0, s43, 2048
  s_nop 0
  buffer_load_dwordx4 v157, s[4:7], s67 offen lds
  s_add_u32 s66, s66, 262144
  s_add_u32 s67, s67, 81920
  v_mfma_f32_16x16x32_bf16 v[0:3], v[96:99], v[116:119], v[0:3]
  ds_read_b128 v[60:63], v170 offset:0
  ds_read_b128 v[64:67], v170 offset:2048
  v_mfma_f32_16x16x32_bf16 v[20:23], v[96:99], v[120:123], v[20:23]
  ds_read_b64_tr_b16 v[40:41], v168 offset:0
  ds_read_b64_tr_b16 v[42:43], v168 offset:5120
  v_mfma_f32_16x16x32_bf16 v[4:7], v[100:103], v[116:119], v[4:7]
  ds_read_b64_tr_b16 v[44:45], v169 offset:32
  ds_read_b64_tr_b16 v[46:47], v169 offset:5152
  v_mfma_f32_16x16x32_bf16 v[24:27], v[100:103], v[120:123], v[24:27]
  ds_read_b64_tr_b16 v[48:49], v168 offset:64
  ds_read_b64_tr_b16 v[50:51], v168 offset:5184
  v_mfma_f32_16x16x32_bf16 v[8:11], v[104:107], v[116:119], v[8:11]
  ds_read_b64_tr_b16 v[52:53], v169 offset:96
  v_mfma_f32_16x16x32_bf16 v[28:31], v[104:107], v[120:123], v[28:31]
  ds_read_b64_tr_b16 v[54:55], v169 offset:5216
  v_mfma_f32_16x16x32_bf16 v[12:15], v[108:111], v[116:119], v[12:15]
  ds_read_b64_tr_b16 v[56:57], v168 offset:128
  v_mfma_f32_16x16x32_bf16 v[32:35], v[108:111], v[120:123], v[32:35]
  ds_read_b64_tr_b16 v[58:59], v168 offset:5248
  v_mfma_f32_16x16x32_bf16 v[16:19], v[112:115], v[116:119], v[16:19]
  ds_read_b128 v[88:91], v170 offset:1024
  v_mfma_f32_16x16x32_bf16 v[36:39], v[112:115], v[120:123], v[36:39]
  ds_read_b128 v[92:95], v170 offset:3072
  v_mfma_f32_16x16x32_bf16 v[0:3], v[124:127], v[144:147], v[0:3]
  ds_read_b64_tr_b16 v[68:69], v168 offset:10240
  v_mfma_f32_16x16x32_bf16 v[20:23], v[124:127], v[148:151], v[20:23]
  ds_read_b64_tr_b16 v[70:71], v168 offset:15360
  v_mfma_f32_16x16x32_bf16 v[4:7], v[128:131], v[144:147], v[4:7]
  ds_read_b64_tr_b16 v[72:73], v169 offset:10272
  v_mfma_f32_16x16x32_bf16 v[24:27], v[128:131], v[148:151], v[24:27]
  ds_read_b64_tr_b16 v[74:75], v169 offset:15392
  v_mfma_f32_16x16x32_bf16 v[8:11], v[132:135], v[144:147], v[8:11]
  ds_read_b64_tr_b16 v[76:77], v168 offset:10304
  v_mfma_f32_16x16x32_bf16 v[28:31], v[132:135], v[148:151], v[28:31]
  ds_read_b64_tr_b16 v[78:79], v168 offset:15424
  v_mfma_f32_16x16x32_bf16 v[12:15], v[136:139], v[144:147], v[12:15]
  ds_read_b64_tr_b16 v[80:81], v169 offset:10336
  v_mfma_f32_16x16x32_bf16 v[32:35], v[136:139], v[148:151], v[32:35]
  ds_read_b64_tr_b16 v[82:83], v169 offset:15456
  v_mfma_f32_16x16x32_bf16 v[16:19], v[140:143], v[144:147], v[16:19]
  ds_read_b64_tr_b16 v[84:85], v168 offset:10368
  v_mfma_f32_16x16x32_bf16 v[36:39], v[140:143], v[148:151], v[36:39]
  ds_read_b64_tr_b16 v[86:87], v168 offset:15488
  s_waitcnt lgkmcnt(0)
  s_waitcnt vmcnt(10)
  s_barrier
  s_add_u32 s43, s44, 73728
  s_add_u32 s45, s66, 131072
  s_add_u32 m0, s65, 73728
  s_nop 0
  buffer_load_dwordx4 v159, s[16:19], s66 offen lds
  s_add_u32 m0, s65, 74752
  s_nop 0
  buffer_load_dwordx4 v159, s[16:19], s45 offen lds
  s_add_u32 m0, s43, 0
  s_nop 0
  buffer_load_dwordx4 v155, s[4:7], s67 offen lds
  s_add_u32 m0, s43, 1024
  s_nop 0
  buffer_load_dwordx4 v156, s[4:7], s67 offen lds
  s_add_u32 m0, s43, 2048
  s_nop 0
  buffer_load_dwordx4 v157, s[4:7], s67 offen lds
  s_add_u32 s66, s66, 262144
  s_add_u32 s67, s67, 81920
  v_mfma_f32_16x16x32_bf16 v[0:3], v[40:43], v[60:63], v[0:3]
  ds_read_b128 v[116:119], v170 offset:36864
  ds_read_b128 v[120:123], v170 offset:38912
  v_mfma_f32_16x16x32_bf16 v[20:23], v[40:43], v[64:67], v[20:23]
  ds_read_b64_tr_b16 v[96:97], v168 offset:36864
  ds_read_b64_tr_b16 v[98:99], v168 offset:41984
  v_mfma_f32_16x16x32_bf16 v[4:7], v[44:47], v[60:63], v[4:7]
  ds_read_b64_tr_b16 v[100:101], v169 offset:36896
  ds_read_b64_tr_b16 v[102:103], v169 offset:42016
  v_mfma_f32_16x16x32_bf16 v[24:27], v[44:47], v[64:67], v[24:27]
  ds_read_b64_tr_b16 v[104:105], v168 offset:36928
  ds_read_b64_tr_b16 v[106:107], v168 offset:42048
  v_mfma_f32_16x16x32_bf16 v[8:11], v[48:51], v[60:63], v[8:11]
  ds_read_b64_tr_b16 v[108:109], v169 offset:36960
  v_mfma_f32_16x16x32_bf16 v[28:31], v[48:51], v[64:67], v[28:31]
  ds_read_b64_tr_b16 v[110:111], v169 offset:42080
  v_mfma_f32_16x16x32_bf16 v[12:15], v[52:55], v[60:63], v[12:15]
  ds_read_b64_tr_b16 v[112:113], v168 offset:36992
  v_mfma_f32_16x16x32_bf16 v[32:35], v[52:55], v[64:67], v[32:35]
  ds_read_b64_tr_b16 v[114:115], v168 offset:42112
  v_mfma_f32_16x16x32_bf16 v[16:19], v[56:59], v[60:63], v[16:19]
  ds_read_b128 v[144:147], v170 offset:37888
  v_mfma_f32_16x16x32_bf16 v[36:39], v[56:59], v[64:67], v[36:39]
  ds_read_b128 v[148:151], v170 offset:39936
  v_mfma_f32_16x16x32_bf16 v[0:3], v[68:71], v[88:91], v[0:3]
  ds_read_b64_tr_b16 v[124:125], v168 offset:47104
  v_mfma_f32_16x16x32_bf16 v[20:23], v[68:71], v[92:95], v[20:23]
  ds_read_b64_tr_b16 v[126:127], v168 offset:52224
  v_mfma_f32_16x16x32_bf16 v[4:7], v[72:75], v[88:91], v[4:7]
  ds_read_b64_tr_b16 v[128:129], v169 offset:47136
  v_mfma_f32_16x16x32_bf16 v[24:27], v[72:75], v[92:95], v[24:27]
  ds_read_b64_tr_b16 v[130:131], v169 offset:52256
  v_mfma_f32_16x16x32_bf16 v[8:11], v[76:79], v[88:91], v[8:11]
  ds_read_b64_tr_b16 v[132:133], v168 offset:47168
  v_mfma_f32_16x16x32_bf16 v[28:31], v[76:79], v[92:95], v[28:31]
  ds_read_b64_tr_b16 v[134:135], v168 offset:52288
  v_mfma_f32_16x16x32_bf16 v[12:15], v[80:83], v[88:91], v[12:15]
  ds_read_b64_tr_b16 v[136:137], v169 offset:47200
  v_mfma_f32_16x16x32_bf16 v[32:35], v[80:83], v[92:95], v[32:35]
  ds_read_b64_tr_b16 v[138:139], v169 offset:52320
  v_mfma_f32_16x16x32_bf16 v[16:19], v[84:87], v[88:91], v[16:19]
  ds_read_b64_tr_b16 v[140:141], v168 offset:47232
  v_mfma_f32_16x16x32_bf16 v[36:39], v[84:87], v[92:95], v[36:39]
  ds_read_b64_tr_b16 v[142:143], v168 offset:52352
  s_waitcnt lgkmcnt(0)
  v_mfma_f32_16x16x32_bf16 v[0:3], v[96:99], v[116:119], v[0:3]
  v_mfma_f32_16x16x32_bf16 v[20:23], v[96:99], v[120:123], v[20:23]
  v_mfma_f32_16x16x32_bf16 v[4:7], v[100:103], v[116:119], v[4:7]
  v_mfma_f32_16x16x32_bf16 v[24:27], v[100:103], v[120:123], v[24:27]
  v_mfma_f32_16x16x32_bf16 v[8:11], v[104:107], v[116:119], v[8:11]
  v_mfma_f32_16x16x32_bf16 v[28:31], v[104:107], v[120:123], v[28:31]
  v_mfma_f32_16x16x32_bf16 v[12:15], v[108:111], v[116:119], v[12:15]
  v_mfma_f32_16x16x32_bf16 v[32:35], v[108:111], v[120:123], v[32:35]
  v_mfma_f32_16x16x32_bf16 v[16:19], v[112:115], v[116:119], v[16:19]
  v_mfma_f32_16x16x32_bf16 v[36:39], v[112:115], v[120:123], v[36:39]
  v_mfma_f32_16x16x32_bf16 v[0:3], v[124:127], v[144:147], v[0:3]
  v_mfma_f32_16x16x32_bf16 v[20:23], v[124:127], v[148:151], v[20:23]
  v_mfma_f32_16x16x32_bf16 v[4:7], v[128:131], v[144:147], v[4:7]
  v_mfma_f32_16x16x32_bf16 v[24:27], v[128:131], v[148:151], v[24:27]
  v_mfma_f32_16x16x32_bf16 v[8:11], v[132:135], v[144:147], v[8:11]
  v_mfma_f32_16x16x32_bf16 v[28:31], v[132:135], v[148:151], v[28:31]
  v_mfma_f32_16x16x32_bf16 v[12:15], v[136:139], v[144:147], v[12:15]
  v_mfma_f32_16x16x32_bf16 v[32:35], v[136:139], v[148:151], v[32:35]
  v_mfma_f32_16x16x32_bf16 v[16:19], v[140:143], v[144:147], v[16:19]
  v_mfma_f32_16x16x32_bf16 v[36:39], v[140:143], v[148:151], v[36:39]
  s_waitcnt lgkmcnt(0)
L_gm_fin:
  s_lshl_b32 s42, s33, 2
  s_add_u32 s42, s42, s34
  s_lshl_b32 s42, s42, 3
  s_add_u32 s42, s42, s32
  s_mul_i32 s42, s42, 10240
  s_mul_i32 s46, s35, 5242880
  s_add_u32 s42, s42, s46
  s_nop 7
  buffer_store_dwordx4 v[0:3], v159, s[20:23], s42 offen offset:0 sc1
  buffer_store_dwordx4 v[4:7], v159, s[20:23], s42 offen offset:1024 sc1
  buffer_store_dwordx4 v[8:11], v159, s[20:23], s42 offen offset:2048 sc1
  buffer_store_dwordx4 v[12:15], v159, s[20:23], s42 offen offset:3072 sc1
  s_add_u32 s42, s42, 4096
  buffer_store_dwordx4 v[16:19], v159, s[20:23], s42 offen offset:0 sc1
  buffer_store_dwordx4 v[20:23], v159, s[20:23], s42 offen offset:1024 sc1
  buffer_store_dwordx4 v[24:27], v159, s[20:23], s42 offen offset:2048 sc1
  buffer_store_dwordx4 v[28:31], v159, s[20:23], s42 offen offset:3072 sc1
  s_add_u32 s42, s42, 4096
  buffer_store_dwordx4 v[32:35], v159, s[20:23], s42 offen offset:0 sc1
  buffer_store_dwordx4 v[36:39], v159, s[20:23], s42 offen offset:1024 sc1
L_gm_end:
  s_endpgm
.section .rodata,"a"
.p2align 6
.amdhsa_kernel gemm_kernel
  .amdhsa_next_free_vgpr 176
  .amdhsa_next_free_sgpr 102
  .amdhsa_accum_offset 176
  .amdhsa_group_segment_fixed_size 0
  .amdhsa_kernarg_size 104
  .amdhsa_user_sgpr_count 2
  .amdhsa_user_sgpr_kernarg_segment_ptr 1
  .amdhsa_system_sgpr_workgroup_id_x 1
.end_amdhsa_kernel
.text

.globl recurrent_scan__mha_block_cached__dense_activation_squared_relu__prompt_kernel
.p2align 8
.type recurrent_scan__mha_block_cached__dense_activation_squared_relu__prompt_kernel,@function
recurrent_scan__mha_block_cached__dense_activation_squared_relu__prompt_kernel:
  s_cmp_ge_u32 s2, 640
  s_cbranch_scc1 L_fin_end
  s_load_dwordx2 s[4:5], s[0:1], 0
  s_load_dwordx2 s[6:7], s[0:1], 72
  s_load_dwordx2 s[8:9], s[0:1], 80
  s_load_dwordx2 s[10:11], s[0:1], 96
  v_lshrrev_b32 v1, 6, v0
  s_nop 0
  v_readfirstlane_b32 s32, v1
  s_lshl_b32 s33, s2, 2
  s_add_u32 s33, s33, s32
  s_mul_hi_u32 s36, s33, 0x33333334
  s_mul_i32 s37, s36, 5
  s_sub_u32 s35, s33, s37
  s_and_b32 s38, s36, 7
  s_lshr_b32 s39, s36, 3
  s_and_b32 s40, s39, 3
  s_lshr_b32 s41, s39, 2
  v_and_b32 v1, 63, v0
  v_lshlrev_b32 v2, 4, v1
  s_mul_i32 s42, s36, 10240
  s_lshl_b32 s43, s35, 10
  s_add_u32 s42, s42, s43
  s_lshl_b32 s44, s41, 7
  s_and_b32 s45, s38, 3
  s_lshl_b32 s45, s45, 5
  s_add_u32 s44, s44, s45
  s_mul_i32 s45, s40, 160
  s_lshr_b32 s46, s38, 2
  s_mul_i32 s46, s46, 80
  s_add_u32 s45, s45, s46
  s_lshl_b32 s46, s35, 4
  s_add_u32 s45, s45, s46
  v_and_b32 v3, 15, v1
  v_add_u32 v3, s44, v3
  s_movk_i32 s46, 1280
  v_mul_lo_u32 v3, v3, s46
  v_lshrrev_b32 v4, 4, v1
  v_lshlrev_b32 v4, 3, v4
  s_lshl_b32 s45, s45, 1
  v_add_u32 v4, s45, v4
  v_add_u32 v3, v3, v4
  s_waitcnt lgkmcnt(0)
  s_mov_b32 s12, s4
  s_and_b32 s13, s5, 0xffff
  s_mov_b32 s14, 2621440
  s_mov_b32 s15, 0x00020000
  s_mov_b32 s16, s6
  s_and_b32 s17, s7, 0xffff
  s_mov_b32 s18, 1280
  s_mov_b32 s19, 0x00020000
  s_mov_b32 s20, s8
  s_and_b32 s21, s9, 0xffff
  s_mov_b32 s22, 2621440
  s_mov_b32 s23, 0x00020000
  s_add_u32 s24, s10, 41943040
  s_addc_u32 s25, s11, 0
  s_and_b32 s25, s25, 0xffff
  s_mov_b32 s26, 31457280
  s_mov_b32 s27, 0x00020000
  s_movk_i32 s49, 20480
  s_add_u32 s43, s42, 0
  buffer_load_dwordx4 v[8:11], v2, s[24:27], s43 offen sc1
  s_add_u32 s43, s42, 5242880
  buffer_load_dwordx4 v[12:15], v2, s[24:27], s43 offen sc1
  s_add_u32 s43, s42, 10485760
  buffer_load_dwordx4 v[16:19], v2, s[24:27], s43 offen sc1
  s_add_u32 s43, s42, 15728640
  buffer_load_dwordx4 v[20:23], v2, s[24:27], s43 offen sc1
  buffer_load_dwordx2 v[40:41], v3, s[12:15], 0 offen
  s_add_u32 s43, s42, 5120
  buffer_load_dwordx4 v[24:27], v2, s[24:27], s43 offen sc1
  s_add_u32 s43, s42, 5248000
  buffer_load_dwordx4 v[28:31], v2, s[24:27], s43 offen sc1
  s_add_u32 s43, s42, 10490880
  buffer_load_dwordx4 v[32:35], v2, s[24:27], s43 offen sc1
  s_add_u32 s43, s42, 15733760
  buffer_load_dwordx4 v[36:39], v2, s[24:27], s43 offen sc1
  buffer_load_dwordx2 v[42:43], v3, s[12:15], s49 offen
  buffer_load_dwordx2 v[44:45], v4, s[16:19], 0 offen
  s_mov_b32 s47, 0xffff0000
  s_mov_b32 s48, 0xbfb8aa3b
  s_waitcnt vmcnt(0)
  v_add_f32 v8, v8, v12
  v_add_f32 v9, v9, v13
  v_add_f32 v8, v8, v16
  v_add_f32 v9, v9, v17
  v_cvt_pk_bf16_f32 v56, v8, v9
  v_lshlrev_b32 v8, 16, v56
  v_and_b32 v9, s47, v56
  v_cvt_pk_bf16_f32 v56, v20, v21
  v_lshlrev_b32 v20, 16, v56
  v_and_b32 v21, s47, v56
  v_lshlrev_b32 v57, 16, v44
  v_and_b32 v58, s47, v44
  v_add_f32 v20, v20, v57
  v_add_f32 v21, v21, v58
  v_cvt_pk_bf16_f32 v56, v20, v21
  v_lshlrev_b32 v20, 16, v56
  v_and_b32 v21, s47, v56
  v_mul_f32 v57, s48, v20
  v_mul_f32 v58, s48, v21
  v_exp_f32 v57, v57
  v_exp_f32 v58, v58
  s_nop 0
  v_add_f32 v57, 1.0, v57
  v_add_f32 v58, 1.0, v58
  v_rcp_f32 v57, v57
  v_rcp_f32 v58, v58
  s_nop 0
  v_mul_f32 v20, v20, v57
  v_mul_f32 v21, v21, v58
  v_cvt_pk_bf16_f32 v56, v20, v21
  v_lshlrev_b32 v20, 16, v56
  v_and_b32 v21, s47, v56
  v_mul_f32 v8, v8, v20
  v_mul_f32 v9, v9, v21
  v_cvt_pk_bf16_f32 v56, v8, v9
  v_lshlrev_b32 v8, 16, v56
  v_and_b32 v9, s47, v56
  v_lshlrev_b32 v57, 16, v40
  v_and_b32 v58, s47, v40
  v_add_f32 v8, v8, v57
  v_add_f32 v9, v9, v58
  v_cvt_pk_bf16_f32 v60, v8, v9
  v_add_f32 v10, v10, v14
  v_add_f32 v11, v11, v15
  v_add_f32 v10, v10, v18
  v_add_f32 v11, v11, v19
  v_cvt_pk_bf16_f32 v56, v10, v11
  v_lshlrev_b32 v10, 16, v56
  v_and_b32 v11, s47, v56
  v_cvt_pk_bf16_f32 v56, v22, v23
  v_lshlrev_b32 v22, 16, v56
  v_and_b32 v23, s47, v56
  v_lshlrev_b32 v57, 16, v45
  v_and_b32 v58, s47, v45
  v_add_f32 v22, v22, v57
  v_add_f32 v23, v23, v58
  v_cvt_pk_bf16_f32 v56, v22, v23
  v_lshlrev_b32 v22, 16, v56
  v_and_b32 v23, s47, v56
  v_mul_f32 v57, s48, v22
  v_mul_f32 v58, s48, v23
  v_exp_f32 v57, v57
  v_exp_f32 v58, v58
  s_nop 0
  v_add_f32 v57, 1.0, v57
  v_add_f32 v58, 1.0, v58
  v_rcp_f32 v57, v57
  v_rcp_f32 v58, v58
  s_nop 0
  v_mul_f32 v22, v22, v57
  v_mul_f32 v23, v23, v58
  v_cvt_pk_bf16_f32 v56, v22, v23
  v_lshlrev_b32 v22, 16, v56
  v_and_b32 v23, s47, v56
  v_mul_f32 v10, v10, v22
  v_mul_f32 v11, v11, v23
  v_cvt_pk_bf16_f32 v56, v10, v11
  v_lshlrev_b32 v10, 16, v56
  v_and_b32 v11, s47, v56
  v_lshlrev_b32 v57, 16, v41
  v_and_b32 v58, s47, v41
  v_add_f32 v10, v10, v57
  v_add_f32 v11, v11, v58
  v_cvt_pk_bf16_f32 v61, v10, v11
  buffer_store_dwordx2 v[60:61], v3, s[20:23], 0 offen
  s_waitcnt vmcnt(0)
  v_add_f32 v24, v24, v28
  v_add_f32 v25, v25, v29
  v_add_f32 v24, v24, v32
  v_add_f32 v25, v25, v33
  v_cvt_pk_bf16_f32 v56, v24, v25
  v_lshlrev_b32 v24, 16, v56
  v_and_b32 v25, s47, v56
  v_cvt_pk_bf16_f32 v56, v36, v37
  v_lshlrev_b32 v36, 16, v56
  v_and_b32 v37, s47, v56
  v_lshlrev_b32 v57, 16, v44
  v_and_b32 v58, s47, v44
  v_add_f32 v36, v36, v57
  v_add_f32 v37, v37, v58
  v_cvt_pk_bf16_f32 v56, v36, v37
  v_lshlrev_b32 v36, 16, v56
  v_and_b32 v37, s47, v56
  v_mul_f32 v57, s48, v36
  v_mul_f32 v58, s48, v37
  v_exp_f32 v57, v57
  v_exp_f32 v58, v58
  s_nop 0
  v_add_f32 v57, 1.0, v57
  v_add_f32 v58, 1.0, v58
  v_rcp_f32 v57, v57
  v_rcp_f32 v58, v58
  s_nop 0
  v_mul_f32 v36, v36, v57
  v_mul_f32 v37, v37, v58
  v_cvt_pk_bf16_f32 v56, v36, v37
  v_lshlrev_b32 v36, 16, v56
  v_and_b32 v37, s47, v56
  v_mul_f32 v24, v24, v36
  v_mul_f32 v25, v25, v37
  v_cvt_pk_bf16_f32 v56, v24, v25
  v_lshlrev_b32 v24, 16, v56
  v_and_b32 v25, s47, v56
  v_lshlrev_b32 v57, 16, v42
  v_and_b32 v58, s47, v42
  v_add_f32 v24, v24, v57
  v_add_f32 v25, v25, v58
  v_cvt_pk_bf16_f32 v62, v24, v25
  v_add_f32 v26, v26, v30
  v_add_f32 v27, v27, v31
  v_add_f32 v26, v26, v34
  v_add_f32 v27, v27, v35
  v_cvt_pk_bf16_f32 v56, v26, v27
  v_lshlrev_b32 v26, 16, v56
  v_and_b32 v27, s47, v56
  v_cvt_pk_bf16_f32 v56, v38, v39
  v_lshlrev_b32 v38, 16, v56
  v_and_b32 v39, s47, v56
  v_lshlrev_b32 v57, 16, v45
  v_and_b32 v58, s47, v45
  v_add_f32 v38, v38, v57
  v_add_f32 v39, v39, v58
  v_cvt_pk_bf16_f32 v56, v38, v39
  v_lshlrev_b32 v38, 16, v56
  v_and_b32 v39, s47, v56
  v_mul_f32 v57, s48, v38
  v_mul_f32 v58, s48, v39
  v_exp_f32 v57, v57
  v_exp_f32 v58, v58
  s_nop 0
  v_add_f32 v57, 1.0, v57
  v_add_f32 v58, 1.0, v58
  v_rcp_f32 v57, v57
  v_rcp_f32 v58, v58
  s_nop 0
  v_mul_f32 v38, v38, v57
  v_mul_f32 v39, v39, v58
  v_cvt_pk_bf16_f32 v56, v38, v39
  v_lshlrev_b32 v38, 16, v56
  v_and_b32 v39, s47, v56
  v_mul_f32 v26, v26, v38
  v_mul_f32 v27, v27, v39
  v_cvt_pk_bf16_f32 v56, v26, v27
  v_lshlrev_b32 v26, 16, v56
  v_and_b32 v27, s47, v56
  v_lshlrev_b32 v57, 16, v43
  v_and_b32 v58, s47, v43
  v_add_f32 v26, v26, v57
  v_add_f32 v27, v27, v58
  v_cvt_pk_bf16_f32 v63, v26, v27
  buffer_store_dwordx2 v[62:63], v3, s[20:23], s49 offen
L_fin_end:
  s_endpgm
.section .rodata,"a"
.p2align 6
.amdhsa_kernel recurrent_scan__mha_block_cached__dense_activation_squared_relu__prompt_kernel
  .amdhsa_next_free_vgpr 64
  .amdhsa_next_free_sgpr 102
  .amdhsa_accum_offset 64
  .amdhsa_group_segment_fixed_size 0
  .amdhsa_kernarg_size 104
  .amdhsa_user_sgpr_count 2
  .amdhsa_user_sgpr_kernarg_segment_ptr 1
  .amdhsa_system_sgpr_workgroup_id_x 1
.end_amdhsa_kernel
.text
```
